```python
import torch

def _softmax(x, axis=-1):
    return torch.softmax(x, dim=axis)
def _gelu(x):
    return torch.nn.functional.gelu(x, approximate="tanh")
def _silu(x):
    return torch.nn.functional.silu(x)
def _sigmoid(x):
    return torch.sigmoid(x)
def _layernorm(x, axis=-1, eps=1e-5):
    m = x.mean(dim=axis, keepdim=True)
    v = x.var(dim=axis, keepdim=True, unbiased=False)
    return (x - m) / torch.sqrt(v + eps)
def _scatter_add(tgt, idx, src, axis=0):
    return tgt.clone().index_add_(axis, idx, src)
def _segment_sum(src, seg, n):
    out = torch.zeros((n,) + src.shape[1:], dtype=src.dtype)
    return out.index_add_(0, seg, src)
def _pad(x, pw):
    flat = tuple(v for pair in reversed(pw) for v in pair)
    return torch.nn.functional.pad(x, flat)

kernel_name = 'concat_heads__mha_block__spectral_fnet__prompt'

def setup_inputs():

    _w = (lambda a: (lambda t: t.to(torch.bfloat16) if t.is_floating_point() else t)(torch.as_tensor(a)))
    def _A_setup():
        B, S, D, H = 1, 2048, 640, 32
        return {
            "x": _w((lambda *s: torch.randn(*s, dtype=torch.bfloat16) * 0.2)(B, S, D)),
            "wqkv": _w((lambda *s: torch.randn(*s, dtype=torch.bfloat16) * 0.8)(D, 3 * D)),
            "wo": _w((lambda *s: torch.randn(*s, dtype=torch.bfloat16) * 0.2)(D, D)),
        }
    _A_in = _A_setup()

    def _B_setup():
        B, S, D = 1, 2048, 640
        ns = torch.arange(S)[:, None] * torch.arange(S)[None, :]
        nd = torch.arange(D)[:, None] * torch.arange(D)[None, :]
        Ws_re = torch.cos(-2.0 * torch.pi * ns / S).to(float)
        Ws_im = torch.sin(-2.0 * torch.pi * ns / S).to(float)
        Wd_re = torch.cos(-2.0 * torch.pi * nd / D).to(float)
        Wd_im = torch.sin(-2.0 * torch.pi * nd / D).to(float)
        return {
            "x": _w((lambda *s: torch.randn(*s, dtype=torch.bfloat16) * 0.05)(B, S, D)),
            "dft_seq_re": _w(Ws_re),
            "dft_seq_im": _w(Ws_im),
            "dft_hid_re": _w(Wd_re),
            "dft_hid_im": _w(Wd_im),
        }
    _B_in = _B_setup()

    return {
        "A_x": _A_in["x"],
        "A_wqkv": _A_in["wqkv"],
        "A_wo": _A_in["wo"],
        "B_x": _B_in["x"],
        "B_dft_seq_re": _B_in["dft_seq_re"],
        "B_dft_seq_im": _B_in["dft_seq_im"],
        "B_dft_hid_re": _B_in["dft_hid_re"],
        "B_dft_hid_im": _B_in["dft_hid_im"],
    }

def reference(A_x, A_wqkv, A_wo, B_x, B_dft_seq_re, B_dft_seq_im, B_dft_hid_re, B_dft_hid_im):
    def _A_ref(x, wqkv, wo):
        B, S, D = x.shape
        H = 32
        Dh = D // H
        qkv = (lambda x, *d: x.permute(*d))((x @ wqkv).reshape(B, S, 3, H, Dh), 2, 0, 3, 1, 4)
        q, k, v = qkv[0], qkv[1], qkv[2]
        scores = torch.einsum("bhqd,bhkd->bhqk", q, k) * (Dh ** -0.5)
        p = _softmax(scores, axis=-1)
        o = torch.einsum("bhqk,bhkd->bhqd", p, v)
        return (lambda x, *d: x.permute(*d))(o, 0, 2, 1, 3).reshape(B, S, D) @ wo

    def _B_ref(x, dft_seq_re, dft_seq_im, dft_hid_re, dft_hid_im):
        a = torch.einsum("bsd,ed->bse", x, dft_hid_re)
        b = torch.einsum("bsd,ed->bse", x, dft_hid_im)
        y = torch.einsum("ts,bse->bte", dft_seq_re, a) - torch.einsum("ts,bse->bte", dft_seq_im, b)
        return y

    a = _A_ref(A_x, A_wqkv, A_wo)
    b = _B_ref(B_x, B_dft_seq_re, B_dft_seq_im, B_dft_hid_re, B_dft_hid_im)
    return torch.concatenate([a, b], axis=-1)
```

```asm
; @launch kernel=concat_heads__mha_block__spectral_fnet__prompt_kernel grid=(256,1,1) block=(512,1,1) lds=163840
.amdgcn_target "amdgcn-amd-amdhsa--gfx950"
.text
.globl concat_heads__mha_block__spectral_fnet__prompt_kernel
.p2align 8
.type concat_heads__mha_block__spectral_fnet__prompt_kernel,@function
concat_heads__mha_block__spectral_fnet__prompt_kernel:
    s_cmp_ge_u32 s2, 256
    s_cbranch_scc1 concat_heads__mha_block__spectral_fnet__prompt_kernel_exit
    s_load_dwordx4 s[16:19], s[0:1], 0
    s_load_dwordx4 s[48:51], s[0:1], 72
    s_load_dwordx2 s[44:45], s[0:1], 24
    s_load_dwordx2 s[32:33], s[0:1], 16
    v_lshrrev_b32 v1, 6, v0
    v_and_b32 v0, 63, v0
    v_readfirstlane_b32 s3, v1
    s_and_b32 s23, s2, 7
    s_lshr_b32 s24, s2, 3
    s_lshr_b32 s31, s23, 1
    s_lshl_b32 s31, s31, 2
    s_and_b32 s25, s24, 3
    s_add_u32 s31, s31, s25
    s_and_b32 s30, s23, 1
    s_lshl_b32 s30, s30, 3
    s_lshr_b32 s26, s24, 2
    s_add_u32 s30, s30, s26
    s_mov_b32 s14, 0x10000000
    s_mov_b32 s15, 0x00020000
    v_mov_b32 v205, 0x80000000
    v_mov_b32 v206, 0x80000000
    s_cmp_lt_u32 s3, 4
    s_cbranch_scc1 concat_heads__mha_block__spectral_fnet__prompt_kernel_comp
    s_setprio 3
    s_mov_b32 s97, 0
    s_sub_u32 s36, s3, 4
    s_mul_i32 s37, s25, 3
    s_add_u32 s37, s37, s26
    s_cmp_ge_u32 s37, 10
    s_cselect_b32 s27, 10, 0
    s_sub_u32 s37, s37, s27
    s_mov_b32 s6, 2621440
    s_mov_b32 s7, 0x00020000
    s_mov_b32 s10, 2457600
    s_mov_b32 s11, 0x00020000
    s_lshl_b32 s20, s31, 2
    s_add_u32 s20, s20, s36
    s_mul_i32 s20, s20, 40960
    s_mul_i32 s21, s36, 61440
    s_lshl_b32 s23, s30, 8
    s_add_u32 s21, s21, s23
    s_lshl_b32 s22, s36, 12
    s_lshl_b32 s23, s37, 7
    s_add_u32 s20, s20, s23
    s_mul_i32 s23, s37, 245760
    s_add_u32 s21, s21, s23
    v_lshrrev_b32 v1, 3, v0
    v_mul_u32_u24 v1, 1280, v1
    v_lshrrev_b32 v2, 4, v0
    v_and_b32 v3, 7, v0
    v_xor_b32 v4, v3, v2
    v_xor_b32 v5, 4, v4
    v_lshl_add_u32 v9, v4, 4, v1
    v_lshl_add_u32 v10, v5, 4, v1
    v_add_u32 v11, 18432, v9
    v_add_u32 v12, 27648, v10
    v_add_u32 v10, 9216, v10
    v_and_b32 v3, 15, v0
    v_lshlrev_b32 v4, 2, v2
    v_xor_b32 v3, v3, v4
    v_mul_u32_u24 v2, 3840, v2
    v_lshl_add_u32 v13, v3, 4, v2
    v_add_u32 v14, 14336, v13
    v_add_u32 v15, 28672, v13
    v_add_u32 v16, 43008, v13
    s_waitcnt lgkmcnt(0)
    s_add_u32 s12, s50, 0x0
    s_addc_u32 s13, s51, 0
    s_mov_b32 s4, s16
    s_mov_b32 s5, s17
    s_mov_b32 s8, s18
    s_mov_b32 s9, s19
    s_mov_b32 s50, 256
    s_mov_b32 s51, 0x00020000
    s_cmp_ge_u32 s30, 15
    s_cbranch_scc1 concat_heads__mha_block__spectral_fnet__prompt_kernel_idle
    s_add_u32 m0, s22, 0
    s_add_u32 s37, s37, 1
    buffer_load_dwordx4 v9, s[4:7], s20 offen offset:0 lds
    buffer_load_dwordx4 v10, s[4:7], s20 offen offset:1024 lds
    buffer_load_dwordx4 v11, s[4:7], s20 offen offset:2048 lds
    buffer_load_dwordx4 v12, s[4:7], s20 offen offset:3072 lds
    s_add_u32 m0, s22, 16384
    s_cmp_eq_u32 s37, 10
    buffer_load_dwordx4 v13, s[8:11], s21 offen offset:0 lds
    buffer_load_dwordx4 v14, s[8:11], s21 offen offset:1024 lds
    buffer_load_dwordx4 v15, s[8:11], s21 offen offset:2048 lds
    buffer_load_dwordx4 v16, s[8:11], s21 offen offset:3072 lds
    s_cselect_b32 s23, -9, 1
    s_mul_i32 s24, s23, 245760
    s_lshl_b32 s23, s23, 7
    s_add_u32 s20, s20, s23
    s_add_u32 s21, s21, s24
    s_add_u32 m0, s22, 32768
    s_add_u32 s37, s37, 1
    buffer_load_dwordx4 v9, s[4:7], s20 offen offset:0 lds
    buffer_load_dwordx4 v10, s[4:7], s20 offen offset:1024 lds
    buffer_load_dwordx4 v11, s[4:7], s20 offen offset:2048 lds
    buffer_load_dwordx4 v12, s[4:7], s20 offen offset:3072 lds
    s_add_u32 m0, s22, 49152
    s_cmp_eq_u32 s37, 10
    buffer_load_dwordx4 v13, s[8:11], s21 offen offset:0 lds
    buffer_load_dwordx4 v14, s[8:11], s21 offen offset:1024 lds
    buffer_load_dwordx4 v15, s[8:11], s21 offen offset:2048 lds
    buffer_load_dwordx4 v16, s[8:11], s21 offen offset:3072 lds
    s_cselect_b32 s23, -9, 1
    s_mul_i32 s24, s23, 245760
    s_lshl_b32 s23, s23, 7
    s_add_u32 s20, s20, s23
    s_add_u32 s21, s21, s24
    s_lshl_b32 s52, s36, 8
    s_add_u32 s52, s52, s2
    s_mul_i32 s23, s52, 1986
    s_lshr_b32 s23, s23, 16
    s_mul_i32 s24, s23, 33
    s_sub_u32 s24, s52, s24
    s_cmp_ge_u32 s23, 17
    s_cselect_b32 s25, 1087, 0
    s_lshl_b32 s23, s23, 6
    s_sub_u32 s23, s23, s25
    s_mov_b32 s25, 0x3a000000
    s_lshl_b32 s53, s52, 11
    s_add_u32 s53, s53, 0x1800000
    v_and_b32 v1, 31, v0
    v_lshl_add_u32 v1, v1, 1, s23
    v_lshrrev_b32 v2, 5, v0
    v_lshlrev_b32 v2, 3, v2
    s_lshl_b32 s24, s24, 4
    v_add_u32 v2, s24, v2
    v_mul_u32_u24 v2, v1, v2
    v_cvt_f32_u32 v1, v1
    v_cvt_f32_u32 v2, v2
    v_mul_f32 v36, s25, v2
    v_fract_f32 v36, v36
    v_add_f32 v2, v2, v1
    v_mul_f32 v37, s25, v2
    v_fract_f32 v37, v37
    v_add_f32 v2, v2, v1
    v_mul_f32 v38, s25, v2
    v_fract_f32 v38, v38
    v_add_f32 v2, v2, v1
    v_mul_f32 v39, s25, v2
    v_fract_f32 v39, v39
    v_add_f32 v2, v2, v1
    v_mul_f32 v40, s25, v2
    v_fract_f32 v40, v40
    v_add_f32 v2, v2, v1
    v_mul_f32 v41, s25, v2
    v_fract_f32 v41, v41
    v_add_f32 v2, v2, v1
    v_mul_f32 v42, s25, v2
    v_fract_f32 v42, v42
    v_add_f32 v2, v2, v1
    v_mul_f32 v43, s25, v2
    v_fract_f32 v43, v43
    v_cos_f32 v44, v36
    v_sin_f32 v36, -v36
    v_cos_f32 v45, v37
    v_sin_f32 v37, -v37
    v_cos_f32 v46, v38
    v_sin_f32 v38, -v38
    v_cos_f32 v47, v39
    v_sin_f32 v39, -v39
    v_cos_f32 v48, v40
    v_sin_f32 v40, -v40
    v_cos_f32 v49, v41
    v_sin_f32 v41, -v41
    v_cos_f32 v50, v42
    v_sin_f32 v42, -v42
    v_cos_f32 v51, v43
    v_sin_f32 v43, -v43
    v_cvt_pk_bf16_f32 v208, v44, v45
    v_cvt_pk_bf16_f32 v212, v36, v37
    v_cvt_pk_bf16_f32 v209, v46, v47
    v_cvt_pk_bf16_f32 v213, v38, v39
    v_cvt_pk_bf16_f32 v210, v48, v49
    v_cvt_pk_bf16_f32 v214, v40, v41
    v_cvt_pk_bf16_f32 v211, v50, v51
    v_cvt_pk_bf16_f32 v215, v42, v43
    s_mul_i32 s38, s31, 10
    s_add_u32 s38, s38, s30
    s_sub_u32 s38, s38, 5
    s_mul_i32 s23, s36, 80
    s_add_u32 s38, s38, s23
    s_cmp_ge_u32 s38, 212
    s_cselect_b32 s38, 0x4000, s38
    s_bitcmp1_b32 s36, 0
    s_cselect_b32 s38, 0x4000, s38
    s_cmp_lt_u32 s30, 5
    s_cselect_b32 s38, 0x4000, s38
    s_cmp_eq_u32 s36, 0
    s_mov_b32 s56, 4096
    s_cselect_b32 s56, s56, 32768
    s_cmp_ge_u32 s38, 340
    s_cbranch_scc1 concat_heads__mha_block__spectral_fnet__prompt_kernel_nof0p
    s_mov_b32 s46, 2621440
    s_mov_b32 s47, 0x00020000
    v_lshrrev_b32 v1, 3, v0
    v_and_b32 v2, 7, v0
    v_xor_b32 v3, v1, v2
    v_lshlrev_b32 v6, 4, v3
    v_lshl_add_u32 v204, v2, 7, v6
    v_add_u32 v204, s56, v204
    v_lshlrev_b32 v205, 9, v1
    v_lshl_add_u32 v205, v2, 4, v205
    v_and_b32 v7, 3, v1
    v_and_b32 v3, 4, v1
    v_lshl_add_u32 v7, v3, 1, v7
    s_mul_i32 s23, s38, 3277
    s_lshr_b32 s23, s23, 16
    s_mul_i32 s24, s23, 20
    s_sub_u32 s24, s38, s24
    s_mul_i32 s25, s24, 52
    s_lshr_b32 s25, s25, 8
    s_mul_i32 s26, s25, 5
    s_sub_u32 s26, s24, s26
    s_lshl_b32 s27, s23, 5
    s_lshr_b32 s28, s25, 1
    s_lshl_b32 s28, s28, 4
    s_add_u32 s27, s27, s28
    s_and_b32 s28, s25, 1
    s_lshl_b32 s28, s28, 2
    s_add_u32 s27, s27, s28
    v_add_u32 v1, s27, v7
    v_mul_u32_u24 v3, 1280, v1
    v_add_u32 v200, v3, v6
    v_sub_u32 v201, v6, v3
    v_add_u32 v202, 1310720, v201
    v_add_u32 v201, 2621440, v201
    v_add_u32 v203, 1310720, v200
    v_mov_b32 v4, 0x80000000
    v_cmp_lt_u32 vcc, 512, v1
    s_mul_i32 s55, s23, 20
    s_lshl_b32 s28, s26, 2
    v_cndmask_b32 v200, v200, v4, vcc
    v_cndmask_b32 v201, v201, v4, vcc
    v_cmp_lt_u32 vcc, 511, v1
    s_add_u32 s55, s55, s28
    s_lshl_b32 s55, s55, 10
    v_cndmask_b32 v202, v202, v4, vcc
    v_cndmask_b32 v203, v203, v4, vcc
    v_cmp_eq_u32 vcc, 0, v1
    s_lshl_b32 s28, s25, 7
    s_add_u32 s55, s55, s28
    v_cndmask_b32 v203, v203, v4, vcc
    s_add_u32 s55, s55, 0xc00000
    s_lshl_b32 s40, s26, 7
    s_add_u32 s41, s40, 640
    s_lshl_b32 s54, s23, 6
    s_add_u32 s54, s54, s24
    s_lshl_b32 s54, s54, 7
    s_add_u32 s54, s54, 0x2060000
concat_heads__mha_block__spectral_fnet__prompt_kernel_nof0p:
    s_waitcnt vmcnt(8)
    s_barrier
    s_add_u32 m0, s22, 65536
    s_add_u32 s37, s37, 1
    buffer_load_dwordx4 v9, s[4:7], s20 offen offset:0 lds
    buffer_load_dwordx4 v10, s[4:7], s20 offen offset:1024 lds
    buffer_load_dwordx4 v11, s[4:7], s20 offen offset:2048 lds
    buffer_load_dwordx4 v12, s[4:7], s20 offen offset:3072 lds
    s_add_u32 m0, s22, 81920
    s_cmp_eq_u32 s37, 10
    buffer_load_dwordx4 v13, s[8:11], s21 offen offset:0 lds
    buffer_load_dwordx4 v14, s[8:11], s21 offen offset:1024 lds
    buffer_load_dwordx4 v15, s[8:11], s21 offen offset:2048 lds
    buffer_load_dwordx4 v16, s[8:11], s21 offen offset:3072 lds
    s_cselect_b32 s23, -9, 1
    s_mul_i32 s24, s23, 245760
    s_lshl_b32 s23, s23, 7
    s_add_u32 s20, s20, s23
    s_add_u32 s21, s21, s24
    s_waitcnt vmcnt(8)
    s_barrier
    s_add_u32 m0, s22, 98304
    s_add_u32 s37, s37, 1
    buffer_load_dwordx4 v9, s[4:7], s20 offen offset:0 lds
    buffer_load_dwordx4 v10, s[4:7], s20 offen offset:1024 lds
    buffer_load_dwordx4 v11, s[4:7], s20 offen offset:2048 lds
    buffer_load_dwordx4 v12, s[4:7], s20 offen offset:3072 lds
    s_add_u32 m0, s22, 114688
    s_cmp_eq_u32 s37, 10
    buffer_load_dwordx4 v13, s[8:11], s21 offen offset:0 lds
    buffer_load_dwordx4 v14, s[8:11], s21 offen offset:1024 lds
    buffer_load_dwordx4 v15, s[8:11], s21 offen offset:2048 lds
    buffer_load_dwordx4 v16, s[8:11], s21 offen offset:3072 lds
    s_cselect_b32 s23, -9, 1
    s_mul_i32 s24, s23, 245760
    s_lshl_b32 s23, s23, 7
    s_add_u32 s20, s20, s23
    s_add_u32 s21, s21, s24
    s_waitcnt vmcnt(8)
    s_barrier
    s_add_u32 m0, s22, 131072
    s_add_u32 s37, s37, 1
    buffer_load_dwordx4 v9, s[4:7], s20 offen offset:0 lds
    buffer_load_dwordx4 v10, s[4:7], s20 offen offset:1024 lds
    buffer_load_dwordx4 v11, s[4:7], s20 offen offset:2048 lds
    buffer_load_dwordx4 v12, s[4:7], s20 offen offset:3072 lds
    s_add_u32 m0, s22, 147456
    s_cmp_eq_u32 s37, 10
    buffer_load_dwordx4 v13, s[8:11], s21 offen offset:0 lds
    buffer_load_dwordx4 v14, s[8:11], s21 offen offset:1024 lds
    buffer_load_dwordx4 v15, s[8:11], s21 offen offset:2048 lds
    buffer_load_dwordx4 v16, s[8:11], s21 offen offset:3072 lds
    s_cselect_b32 s23, -9, 1
    s_mul_i32 s24, s23, 245760
    s_lshl_b32 s23, s23, 7
    s_add_u32 s20, s20, s23
    s_add_u32 s21, s21, s24
    s_add_u32 m0, s22, 0
    s_add_u32 s37, s37, 1
    buffer_load_dwordx4 v9, s[4:7], s20 offen offset:0 lds
    buffer_load_dwordx4 v10, s[4:7], s20 offen offset:1024 lds
    buffer_load_dwordx4 v11, s[4:7], s20 offen offset:2048 lds
    buffer_load_dwordx4 v12, s[4:7], s20 offen offset:3072 lds
    s_add_u32 m0, s22, 16384
    s_cmp_eq_u32 s37, 10
    buffer_load_dwordx4 v13, s[8:11], s21 offen offset:0 lds
    buffer_load_dwordx4 v14, s[8:11], s21 offen offset:1024 lds
    buffer_load_dwordx4 v15, s[8:11], s21 offen offset:2048 lds
    buffer_load_dwordx4 v16, s[8:11], s21 offen offset:3072 lds
    s_cselect_b32 s23, -9, 1
    s_mul_i32 s24, s23, 245760
    s_lshl_b32 s23, s23, 7
    s_add_u32 s20, s20, s23
    s_add_u32 s21, s21, s24
    s_waitcnt vmcnt(16)
    s_barrier
    s_add_u32 m0, s22, 32768
    s_add_u32 s37, s37, 1
    buffer_load_dwordx4 v9, s[4:7], s20 offen offset:0 lds
    buffer_load_dwordx4 v10, s[4:7], s20 offen offset:1024 lds
    buffer_load_dwordx4 v11, s[4:7], s20 offen offset:2048 lds
    buffer_load_dwordx4 v12, s[4:7], s20 offen offset:3072 lds
    s_add_u32 m0, s22, 49152
    s_cmp_eq_u32 s37, 10
    buffer_load_dwordx4 v13, s[8:11], s21 offen offset:0 lds
    buffer_load_dwordx4 v14, s[8:11], s21 offen offset:1024 lds
    buffer_load_dwordx4 v15, s[8:11], s21 offen offset:2048 lds
    buffer_load_dwordx4 v16, s[8:11], s21 offen offset:3072 lds
    s_cselect_b32 s23, -9, 1
    s_mul_i32 s24, s23, 245760
    s_lshl_b32 s23, s23, 7
    s_add_u32 s20, s20, s23
    s_add_u32 s21, s21, s24
    s_waitcnt vmcnt(16)
    s_barrier
    s_add_u32 m0, s22, 65536
    s_add_u32 s37, s37, 1
    buffer_load_dwordx4 v9, s[4:7], s20 offen offset:0 lds
    buffer_load_dwordx4 v10, s[4:7], s20 offen offset:1024 lds
    buffer_load_dwordx4 v11, s[4:7], s20 offen offset:2048 lds
    buffer_load_dwordx4 v12, s[4:7], s20 offen offset:3072 lds
    s_add_u32 m0, s22, 81920
    s_cmp_eq_u32 s37, 10
    buffer_load_dwordx4 v13, s[8:11], s21 offen offset:0 lds
    buffer_load_dwordx4 v14, s[8:11], s21 offen offset:1024 lds
    buffer_load_dwordx4 v15, s[8:11], s21 offen offset:2048 lds
    buffer_load_dwordx4 v16, s[8:11], s21 offen offset:3072 lds
    s_cselect_b32 s23, -9, 1
    s_mul_i32 s24, s23, 245760
    s_lshl_b32 s23, s23, 7
    s_add_u32 s20, s20, s23
    s_add_u32 s21, s21, s24
    s_waitcnt vmcnt(16)
    s_barrier
    s_add_u32 m0, s22, 98304
    s_add_u32 s37, s37, 1
    buffer_load_dwordx4 v9, s[4:7], s20 offen offset:0 lds
    buffer_load_dwordx4 v10, s[4:7], s20 offen offset:1024 lds
    buffer_load_dwordx4 v11, s[4:7], s20 offen offset:2048 lds
    buffer_load_dwordx4 v12, s[4:7], s20 offen offset:3072 lds
    s_add_u32 m0, s22, 114688
    s_cmp_eq_u32 s37, 10
    buffer_load_dwordx4 v13, s[8:11], s21 offen offset:0 lds
    buffer_load_dwordx4 v14, s[8:11], s21 offen offset:1024 lds
    buffer_load_dwordx4 v15, s[8:11], s21 offen offset:2048 lds
    buffer_load_dwordx4 v16, s[8:11], s21 offen offset:3072 lds
    s_cselect_b32 s23, -9, 1
    s_mul_i32 s24, s23, 245760
    s_lshl_b32 s23, s23, 7
    s_add_u32 s20, s20, s23
    s_add_u32 s21, s21, s24
    s_waitcnt vmcnt(16)
    s_barrier
    s_add_u32 m0, s22, 131072
    s_add_u32 s37, s37, 1
    buffer_load_dwordx4 v9, s[4:7], s20 offen offset:0 lds
    buffer_load_dwordx4 v10, s[4:7], s20 offen offset:1024 lds
    buffer_load_dwordx4 v11, s[4:7], s20 offen offset:2048 lds
    buffer_load_dwordx4 v12, s[4:7], s20 offen offset:3072 lds
    s_add_u32 m0, s22, 147456
    s_cmp_eq_u32 s37, 10
    buffer_load_dwordx4 v13, s[8:11], s21 offen offset:0 lds
    buffer_load_dwordx4 v14, s[8:11], s21 offen offset:1024 lds
    buffer_load_dwordx4 v15, s[8:11], s21 offen offset:2048 lds
    buffer_load_dwordx4 v16, s[8:11], s21 offen offset:3072 lds
    s_cselect_b32 s23, -9, 1
    s_mul_i32 s24, s23, 245760
    s_lshl_b32 s23, s23, 7
    s_add_u32 s20, s20, s23
    s_add_u32 s21, s21, s24
    s_waitcnt vmcnt(16)
    s_barrier
    s_waitcnt vmcnt(8)
    s_barrier
    s_cmp_ge_u32 s38, 340
    s_cbranch_scc1 concat_heads__mha_block__spectral_fnet__prompt_kernel_nof0d
    s_add_u32 m0, s56, 0
    s_nop 0
    buffer_load_dwordx4 v200, s[44:47], s40 offen lds
    s_add_u32 m0, s56, 1024
    s_nop 0
    buffer_load_dwordx4 v200, s[44:47], s41 offen lds
    s_add_u32 m0, s56, 2048
    s_nop 0
    buffer_load_dwordx4 v201, s[44:47], s40 offen lds
    s_add_u32 m0, s56, 3072
    s_nop 0
    buffer_load_dwordx4 v201, s[44:47], s41 offen lds
    s_add_u32 m0, s56, 4096
    s_nop 0
    buffer_load_dwordx4 v202, s[44:47], s40 offen lds
    s_add_u32 m0, s56, 5120
    s_nop 0
    buffer_load_dwordx4 v202, s[44:47], s41 offen lds
    s_add_u32 m0, s56, 6144
    s_nop 0
    buffer_load_dwordx4 v203, s[44:47], s40 offen lds
    s_add_u32 m0, s56, 7168
    s_nop 0
    buffer_load_dwordx4 v203, s[44:47], s41 offen lds
concat_heads__mha_block__spectral_fnet__prompt_kernel_nof0d:
    s_cmp_ge_u32 s38, 340
    s_cbranch_scc1 concat_heads__mha_block__spectral_fnet__prompt_kernel_w9a
    s_waitcnt vmcnt(8)
    s_branch concat_heads__mha_block__spectral_fnet__prompt_kernel_w9b
concat_heads__mha_block__spectral_fnet__prompt_kernel_w9a:
    s_waitcnt vmcnt(0)
concat_heads__mha_block__spectral_fnet__prompt_kernel_w9b:
    s_barrier
concat_heads__mha_block__spectral_fnet__prompt_kernel_tagget:
    s_setprio 0
    s_cmp_lg_u32 s3, 7
    s_cbranch_scc1 concat_heads__mha_block__spectral_fnet__prompt_kernel_l_s1
    s_mov_b32 s58, 0x4000
    v_mov_b32 v1, 0
    v_lshlrev_b32 v3, 2, v0
    ds_write_b32 v3, v1 offset:1024
concat_heads__mha_block__spectral_fnet__prompt_kernel_tagpoll:
    buffer_load_dword v2, v1, s[48:51], 0 offen sc1
    s_waitcnt vmcnt(0)
    v_cmp_ne_u32 vcc, 0, v2
    s_sub_u32 s58, s58, 1
    s_cbranch_scc1 concat_heads__mha_block__spectral_fnet__prompt_kernel_tagx
    s_cbranch_vccnz concat_heads__mha_block__spectral_fnet__prompt_kernel_tagx
    s_sleep 8
    s_branch concat_heads__mha_block__spectral_fnet__prompt_kernel_tagpoll
concat_heads__mha_block__spectral_fnet__prompt_kernel_tagx:
    ds_write_b32 v1, v2 offset:1024
concat_heads__mha_block__spectral_fnet__prompt_kernel_l_s1:
    s_branch concat_heads__mha_block__spectral_fnet__prompt_kernel_s1b
concat_heads__mha_block__spectral_fnet__prompt_kernel_idle:
    s_setprio 0
    s_lshl_b32 s40, s31, 3
    s_add_u32 s40, s40, s3
    s_cmp_lg_u32 s40, 120
    s_cbranch_scc1 concat_heads__mha_block__spectral_fnet__prompt_kernel_notag
    s_mov_b32 s23, 0x1400000
    v_mov_b32 v1, 0
    buffer_load_dword v2, v1, s[12:15], s23 offen sc1
    v_lshrrev_b32 v3, 3, v0
    v_mul_u32_u24 v3, 82048, v3
    v_and_b32 v4, 7, v0
    v_lshl_add_u32 v3, v4, 4, v3
    s_mov_b32 s24, 0x314000
    v_mov_b32 v36, 0x3f803f80
    v_mov_b32 v37, 0x3f803f80
    v_mov_b32 v38, 0x3f803f80
    v_mov_b32 v39, 0x3f803f80
    buffer_store_dwordx4 v[36:39], v3, s[12:15], s24 offen sc1
    s_add_u32 s24, s24, 656384
    buffer_store_dwordx4 v[36:39], v3, s[12:15], s24 offen sc1
    s_add_u32 s24, s24, 656384
    buffer_store_dwordx4 v[36:39], v3, s[12:15], s24 offen sc1
    s_add_u32 s24, s24, 656384
    buffer_store_dwordx4 v[36:39], v3, s[12:15], s24 offen sc1
    s_add_u32 s24, s24, 656384
    buffer_store_dwordx4 v[36:39], v3, s[12:15], s24 offen sc1
    s_add_u32 s24, s24, 656384
    buffer_store_dwordx4 v[36:39], v3, s[12:15], s24 offen sc1
    s_add_u32 s24, s24, 656384
    buffer_store_dwordx4 v[36:39], v3, s[12:15], s24 offen sc1
    s_add_u32 s24, s24, 656384
    buffer_store_dwordx4 v[36:39], v3, s[12:15], s24 offen sc1
    s_add_u32 s24, s24, 656384
    s_waitcnt vmcnt(8)
    v_add_u32 v2, 1, v2
    v_or_b32 v2, 0x80000000, v2
    s_mov_b64 exec, 1
    buffer_store_dword v2, v1, s[48:51], 0 offen sc1
    buffer_store_dword v2, v1, s[12:15], s23 offen sc1
    s_mov_b64 exec, -1
    v_lshrrev_b32 v4, 4, v0
    v_and_b32 v5, 15, v0
    v_lshlrev_b32 v4, 14, v4
    v_lshl_add_u32 v4, v5, 4, v4
    s_mov_b32 s23, 0x2003000
    v_mov_b32 v40, v2
    v_mov_b32 v41, v2
    v_mov_b32 v42, v2
    v_mov_b32 v43, v2
    s_waitcnt vmcnt(0)
    buffer_store_dwordx4 v[40:43], v4, s[12:15], s23 offen sc1
    s_add_u32 s23, s23, 0x10000
    buffer_store_dwordx4 v[40:43], v4, s[12:15], s23 offen sc1
    s_add_u32 s23, s23, 0x10000
    buffer_store_dwordx4 v[40:43], v4, s[12:15], s23 offen sc1
    s_add_u32 s23, s23, 0x10000
    buffer_store_dwordx4 v[40:43], v4, s[12:15], s23 offen sc1
    s_add_u32 s23, s23, 0x10000
concat_heads__mha_block__spectral_fnet__prompt_kernel_notag:
    s_mov_b32 s22, s40
    s_add_u32 s38, s40, 212
    s_lshl_b32 s56, s3, 13
    s_add_u32 s56, s56, 4096
    s_mov_b32 s46, 2621440
    s_mov_b32 s47, 0x00020000
    v_lshrrev_b32 v1, 3, v0
    v_and_b32 v2, 7, v0
    v_xor_b32 v3, v1, v2
    v_lshlrev_b32 v6, 4, v3
    v_lshl_add_u32 v204, v2, 7, v6
    v_add_u32 v204, s56, v204
    v_lshlrev_b32 v205, 9, v1
    v_lshl_add_u32 v205, v2, 4, v205
    v_and_b32 v7, 3, v1
    v_and_b32 v3, 4, v1
    v_lshl_add_u32 v7, v3, 1, v7
    s_mul_i32 s23, s38, 3277
    s_lshr_b32 s23, s23, 16
    s_mul_i32 s24, s23, 20
    s_sub_u32 s24, s38, s24
    s_mul_i32 s25, s24, 52
    s_lshr_b32 s25, s25, 8
    s_mul_i32 s26, s25, 5
    s_sub_u32 s26, s24, s26
    s_lshl_b32 s27, s23, 5
    s_lshr_b32 s28, s25, 1
    s_lshl_b32 s28, s28, 4
    s_add_u32 s27, s27, s28
    s_and_b32 s28, s25, 1
    s_lshl_b32 s28, s28, 2
    s_add_u32 s27, s27, s28
    v_add_u32 v1, s27, v7
    v_mul_u32_u24 v3, 1280, v1
    v_add_u32 v200, v3, v6
    v_sub_u32 v201, v6, v3
    v_add_u32 v202, 1310720, v201
    v_add_u32 v201, 2621440, v201
    v_add_u32 v203, 1310720, v200
    v_mov_b32 v4, 0x80000000
    v_cmp_lt_u32 vcc, 512, v1
    s_mul_i32 s55, s23, 20
    s_lshl_b32 s28, s26, 2
    v_cndmask_b32 v200, v200, v4, vcc
    v_cndmask_b32 v201, v201, v4, vcc
    v_cmp_lt_u32 vcc, 511, v1
    s_add_u32 s55, s55, s28
    s_lshl_b32 s55, s55, 10
    v_cndmask_b32 v202, v202, v4, vcc
    v_cndmask_b32 v203, v203, v4, vcc
    v_cmp_eq_u32 vcc, 0, v1
    s_lshl_b32 s28, s25, 7
    s_add_u32 s55, s55, s28
    v_cndmask_b32 v203, v203, v4, vcc
    s_add_u32 s55, s55, 0xc00000
    s_lshl_b32 s40, s26, 7
    s_add_u32 s41, s40, 640
    s_lshl_b32 s54, s23, 6
    s_add_u32 s54, s54, s24
    s_lshl_b32 s54, s54, 7
    s_add_u32 s54, s54, 0x2060000
    s_add_u32 m0, s56, 0
    s_nop 0
    buffer_load_dwordx4 v200, s[44:47], s40 offen lds
    s_add_u32 m0, s56, 1024
    s_nop 0
    buffer_load_dwordx4 v200, s[44:47], s41 offen lds
    s_add_u32 m0, s56, 2048
    s_nop 0
    buffer_load_dwordx4 v201, s[44:47], s40 offen lds
    s_add_u32 m0, s56, 3072
    s_nop 0
    buffer_load_dwordx4 v201, s[44:47], s41 offen lds
    s_add_u32 m0, s56, 4096
    s_nop 0
    buffer_load_dwordx4 v202, s[44:47], s40 offen lds
    s_add_u32 m0, s56, 5120
    s_nop 0
    buffer_load_dwordx4 v202, s[44:47], s41 offen lds
    s_add_u32 m0, s56, 6144
    s_nop 0
    buffer_load_dwordx4 v203, s[44:47], s40 offen lds
    s_add_u32 m0, s56, 7168
    s_nop 0
    buffer_load_dwordx4 v203, s[44:47], s41 offen lds
    v_lshlrev_b32 v8, 4, v0
concat_heads__mha_block__spectral_fnet__prompt_kernel_tabloop:
    s_mul_i32 s23, s22, 3277
    s_lshr_b32 s23, s23, 16
    s_mul_i32 s24, s23, 20
    s_sub_u32 s24, s22, s24
    s_cmp_ge_u32 s23, 6
    s_cselect_b32 s25, 383, 0
    s_lshl_b32 s23, s23, 6
    s_sub_u32 s23, s23, s25
    s_mov_b32 s25, 0x3acccccd
    s_lshl_b32 s20, s22, 11
    s_add_u32 s20, s20, 0x1c00000
    v_and_b32 v1, 31, v0
    v_lshl_add_u32 v1, v1, 1, s23
    v_lshrrev_b32 v2, 5, v0
    v_lshlrev_b32 v2, 3, v2
    s_lshl_b32 s24, s24, 4
    v_add_u32 v2, s24, v2
    v_mul_u32_u24 v2, v1, v2
    v_cvt_f32_u32 v1, v1
    v_cvt_f32_u32 v2, v2
    v_mul_f32 v36, s25, v2
    v_fract_f32 v36, v36
    v_add_f32 v2, v2, v1
    v_mul_f32 v37, s25, v2
    v_fract_f32 v37, v37
    v_add_f32 v2, v2, v1
    v_mul_f32 v38, s25, v2
    v_fract_f32 v38, v38
    v_add_f32 v2, v2, v1
    v_mul_f32 v39, s25, v2
    v_fract_f32 v39, v39
    v_add_f32 v2, v2, v1
    v_mul_f32 v40, s25, v2
    v_fract_f32 v40, v40
    v_add_f32 v2, v2, v1
    v_mul_f32 v41, s25, v2
    v_fract_f32 v41, v41
    v_add_f32 v2, v2, v1
    v_mul_f32 v42, s25, v2
    v_fract_f32 v42, v42
    v_add_f32 v2, v2, v1
    v_mul_f32 v43, s25, v2
    v_fract_f32 v43, v43
    v_cos_f32 v44, v36
    v_sin_f32 v36, -v36
    v_cos_f32 v45, v37
    v_sin_f32 v37, -v37
    v_cos_f32 v46, v38
    v_sin_f32 v38, -v38
    v_cos_f32 v47, v39
    v_sin_f32 v39, -v39
    v_cos_f32 v48, v40
    v_sin_f32 v40, -v40
    v_cos_f32 v49, v41
    v_sin_f32 v41, -v41
    v_cos_f32 v50, v42
    v_sin_f32 v42, -v42
    v_cos_f32 v51, v43
    v_sin_f32 v43, -v43
    v_cvt_pk_bf16_f32 v52, v44, v45
    v_cvt_pk_bf16_f32 v56, v36, v37
    v_cvt_pk_bf16_f32 v53, v46, v47
    v_cvt_pk_bf16_f32 v57, v38, v39
    v_cvt_pk_bf16_f32 v54, v48, v49
    v_cvt_pk_bf16_f32 v58, v40, v41
    v_cvt_pk_bf16_f32 v55, v50, v51
    v_cvt_pk_bf16_f32 v59, v42, v43
    buffer_store_dwordx4 v[52:55], v8, s[12:15], s20 offen sc1
    buffer_store_dwordx4 v[56:59], v8, s[12:15], s20 offen offset:1024 sc1
    s_add_u32 s22, s22, 128
    s_cmp_lt_u32 s22, 240
    s_cbranch_scc1 concat_heads__mha_block__spectral_fnet__prompt_kernel_tabloop
    s_sub_u32 s52, s3, 4
    s_lshl_b32 s52, s52, 8
    s_add_u32 s52, s52, s2
    s_lshl_b32 s23, s31, 2
    s_add_u32 s23, s23, s3
    s_add_u32 s23, s23, 1024
    s_cmp_lt_u32 s3, 4
    s_cselect_b32 s52, s23, s52
    s_mov_b32 s22, s52
concat_heads__mha_block__spectral_fnet__prompt_kernel_cfloop:
    s_mul_i32 s23, s22, 1986
    s_lshr_b32 s23, s23, 16
    s_mul_i32 s24, s23, 33
    s_sub_u32 s24, s22, s24
    s_cmp_ge_u32 s23, 17
    s_cselect_b32 s25, 1087, 0
    s_lshl_b32 s23, s23, 6
    s_sub_u32 s23, s23, s25
    s_mov_b32 s25, 0x3a000000
    s_lshl_b32 s20, s22, 11
    s_add_u32 s20, s20, 0x1800000
    v_and_b32 v1, 31, v0
    v_lshl_add_u32 v1, v1, 1, s23
    v_lshrrev_b32 v2, 5, v0
    v_lshlrev_b32 v2, 3, v2
    s_lshl_b32 s24, s24, 4
    v_add_u32 v2, s24, v2
    v_mul_u32_u24 v2, v1, v2
    v_cvt_f32_u32 v1, v1
    v_cvt_f32_u32 v2, v2
    v_mul_f32 v36, s25, v2
    v_fract_f32 v36, v36
    v_add_f32 v2, v2, v1
    v_mul_f32 v37, s25, v2
    v_fract_f32 v37, v37
    v_add_f32 v2, v2, v1
    v_mul_f32 v38, s25, v2
    v_fract_f32 v38, v38
    v_add_f32 v2, v2, v1
    v_mul_f32 v39, s25, v2
    v_fract_f32 v39, v39
    v_add_f32 v2, v2, v1
    v_mul_f32 v40, s25, v2
    v_fract_f32 v40, v40
    v_add_f32 v2, v2, v1
    v_mul_f32 v41, s25, v2
    v_fract_f32 v41, v41
    v_add_f32 v2, v2, v1
    v_mul_f32 v42, s25, v2
    v_fract_f32 v42, v42
    v_add_f32 v2, v2, v1
    v_mul_f32 v43, s25, v2
    v_fract_f32 v43, v43
    v_cos_f32 v44, v36
    v_sin_f32 v36, -v36
    v_cos_f32 v45, v37
    v_sin_f32 v37, -v37
    v_cos_f32 v46, v38
    v_sin_f32 v38, -v38
    v_cos_f32 v47, v39
    v_sin_f32 v39, -v39
    v_cos_f32 v48, v40
    v_sin_f32 v40, -v40
    v_cos_f32 v49, v41
    v_sin_f32 v41, -v41
    v_cos_f32 v50, v42
    v_sin_f32 v42, -v42
    v_cos_f32 v51, v43
    v_sin_f32 v43, -v43
    v_cvt_pk_bf16_f32 v52, v44, v45
    v_cvt_pk_bf16_f32 v56, v36, v37
    v_cvt_pk_bf16_f32 v53, v46, v47
    v_cvt_pk_bf16_f32 v57, v38, v39
    v_cvt_pk_bf16_f32 v54, v48, v49
    v_cvt_pk_bf16_f32 v58, v40, v41
    v_cvt_pk_bf16_f32 v55, v50, v51
    v_cvt_pk_bf16_f32 v59, v42, v43
    buffer_store_dwordx4 v[52:55], v8, s[12:15], s20 offen sc1
    buffer_store_dwordx4 v[56:59], v8, s[12:15], s20 offen offset:1024 sc1
    s_add_u32 s22, s22, 1
    s_cmp_eq_u32 s22, 1088
    s_cbranch_scc1 concat_heads__mha_block__spectral_fnet__prompt_kernel_cfloop
    s_waitcnt vmcnt(0)
    s_mov_b32 s34, 819200
    s_mov_b32 s35, 0x00020000
    s_lshl_b32 s36, s31, 3
    s_add_u32 s36, s36, s3
    s_mul_i32 s37, s36, 20480
    s_mul_i32 s36, s36, 6400
    v_min_u32 v1, 49, v0
    v_lshlrev_b32 v1, 7, v1
    v_lshlrev_b32 v2, 7, v0
    v_min_u32 v3, 3968, v2
    buffer_load_dword v203, v1, s[32:35], s36 offen
    ds_read_b128 v[16:19], v204 offset:0
    ds_read_b128 v[20:23], v204 offset:1024
    ds_read_b128 v[24:27], v204 offset:2048
    ds_read_b128 v[28:31], v204 offset:3072
    ds_read_b128 v[32:35], v204 offset:4096
    ds_read_b128 v[36:39], v204 offset:5120
    ds_read_b128 v[40:43], v204 offset:6144
    ds_read_b128 v[44:47], v204 offset:7168
    s_waitcnt lgkmcnt(0)
    v_lshlrev_b32 v48, 16, v16
    v_and_b32 v49, 0xffff0000, v16
    v_lshlrev_b32 v50, 16, v20
    v_and_b32 v51, 0xffff0000, v20
    v_lshlrev_b32 v52, 16, v24
    v_and_b32 v53, 0xffff0000, v24
    v_lshlrev_b32 v54, 16, v28
    v_and_b32 v55, 0xffff0000, v28
    v_lshlrev_b32 v56, 16, v32
    v_and_b32 v57, 0xffff0000, v32
    v_lshlrev_b32 v58, 16, v36
    v_and_b32 v59, 0xffff0000, v36
    v_lshlrev_b32 v60, 16, v40
    v_and_b32 v61, 0xffff0000, v40
    v_lshlrev_b32 v62, 16, v44
    v_and_b32 v63, 0xffff0000, v44
    v_pk_add_f32 v[64:65], v[48:49], v[50:51]
    v_pk_add_f32 v[66:67], v[48:49], v[50:51] neg_lo:[0,1] neg_hi:[0,1]
    v_pk_add_f32 v[68:69], v[52:53], v[54:55]
    v_pk_add_f32 v[70:71], v[52:53], v[54:55] neg_lo:[0,1] neg_hi:[0,1]
    v_pk_add_f32 v[72:73], v[56:57], v[58:59]
    v_pk_add_f32 v[74:75], v[56:57], v[58:59] neg_lo:[0,1] neg_hi:[0,1]
    v_pk_add_f32 v[76:77], v[60:61], v[62:63]
    v_pk_add_f32 v[78:79], v[60:61], v[62:63] neg_lo:[0,1] neg_hi:[0,1]
    v_pk_add_f32 v[48:49], v[64:65], v[68:69]
    v_pk_add_f32 v[50:51], v[72:73], v[76:77]
    v_pk_add_f32 v[52:53], v[64:65], v[68:69] neg_lo:[0,1] neg_hi:[0,1]
    v_pk_add_f32 v[54:55], v[72:73], v[76:77] neg_lo:[0,1] neg_hi:[0,1]
    v_pk_add_f32 v[56:57], v[66:67], v[70:71]
    v_pk_add_f32 v[58:59], v[74:75], v[78:79]
    v_pk_add_f32 v[60:61], v[66:67], v[70:71] neg_lo:[0,1] neg_hi:[0,1]
    v_pk_add_f32 v[62:63], v[74:75], v[78:79] neg_lo:[0,1] neg_hi:[0,1]
    v_pk_add_f32 v[64:65], v[48:49], v[50:51]
    v_pk_add_f32 v[68:69], v[48:49], v[50:51] neg_lo:[0,1] neg_hi:[0,1]
    v_pk_add_f32 v[72:73], v[52:53], v[54:55] neg_lo:[0,1] neg_hi:[0,1]
    v_pk_add_f32 v[76:77], v[52:53], v[54:55]
    v_pk_add_f32 v[66:67], v[56:57], v[58:59]
    v_pk_add_f32 v[70:71], v[56:57], v[58:59] neg_lo:[0,1] neg_hi:[0,1]
    v_pk_add_f32 v[74:75], v[60:61], v[62:63] neg_lo:[0,1] neg_hi:[0,1]
    v_pk_add_f32 v[78:79], v[60:61], v[62:63]
    v_cvt_pk_bf16_f32 v80, v64, v65
    v_cvt_pk_bf16_f32 v84, v66, v67
    v_cvt_pk_bf16_f32 v88, v68, v69
    v_cvt_pk_bf16_f32 v92, v70, v71
    v_cvt_pk_bf16_f32 v96, v72, v73
    v_cvt_pk_bf16_f32 v100, v74, v75
    v_cvt_pk_bf16_f32 v104, v76, v77
    v_cvt_pk_bf16_f32 v108, v78, v79
    v_lshlrev_b32 v48, 16, v17
    v_and_b32 v49, 0xffff0000, v17
    v_lshlrev_b32 v50, 16, v21
    v_and_b32 v51, 0xffff0000, v21
    v_lshlrev_b32 v52, 16, v25
    v_and_b32 v53, 0xffff0000, v25
    v_lshlrev_b32 v54, 16, v29
    v_and_b32 v55, 0xffff0000, v29
    v_lshlrev_b32 v56, 16, v33
    v_and_b32 v57, 0xffff0000, v33
    v_lshlrev_b32 v58, 16, v37
    v_and_b32 v59, 0xffff0000, v37
    v_lshlrev_b32 v60, 16, v41
    v_and_b32 v61, 0xffff0000, v41
    v_lshlrev_b32 v62, 16, v45
    v_and_b32 v63, 0xffff0000, v45
    v_pk_add_f32 v[64:65], v[48:49], v[50:51]
    v_pk_add_f32 v[66:67], v[48:49], v[50:51] neg_lo:[0,1] neg_hi:[0,1]
    v_pk_add_f32 v[68:69], v[52:53], v[54:55]
    v_pk_add_f32 v[70:71], v[52:53], v[54:55] neg_lo:[0,1] neg_hi:[0,1]
    v_pk_add_f32 v[72:73], v[56:57], v[58:59]
    v_pk_add_f32 v[74:75], v[56:57], v[58:59] neg_lo:[0,1] neg_hi:[0,1]
    v_pk_add_f32 v[76:77], v[60:61], v[62:63]
    v_pk_add_f32 v[78:79], v[60:61], v[62:63] neg_lo:[0,1] neg_hi:[0,1]
    v_pk_add_f32 v[48:49], v[64:65], v[68:69]
    v_pk_add_f32 v[50:51], v[72:73], v[76:77]
    v_pk_add_f32 v[52:53], v[64:65], v[68:69] neg_lo:[0,1] neg_hi:[0,1]
    v_pk_add_f32 v[54:55], v[72:73], v[76:77] neg_lo:[0,1] neg_hi:[0,1]
    v_pk_add_f32 v[56:57], v[66:67], v[70:71]
    v_pk_add_f32 v[58:59], v[74:75], v[78:79]
    v_pk_add_f32 v[60:61], v[66:67], v[70:71] neg_lo:[0,1] neg_hi:[0,1]
    v_pk_add_f32 v[62:63], v[74:75], v[78:79] neg_lo:[0,1] neg_hi:[0,1]
    v_pk_add_f32 v[64:65], v[48:49], v[50:51]
    v_pk_add_f32 v[68:69], v[48:49], v[50:51] neg_lo:[0,1] neg_hi:[0,1]
    v_pk_add_f32 v[72:73], v[52:53], v[54:55] neg_lo:[0,1] neg_hi:[0,1]
    v_pk_add_f32 v[76:77], v[52:53], v[54:55]
    v_pk_add_f32 v[66:67], v[56:57], v[58:59]
    v_pk_add_f32 v[70:71], v[56:57], v[58:59] neg_lo:[0,1] neg_hi:[0,1]
    v_pk_add_f32 v[74:75], v[60:61], v[62:63] neg_lo:[0,1] neg_hi:[0,1]
    v_pk_add_f32 v[78:79], v[60:61], v[62:63]
    v_cvt_pk_bf16_f32 v81, v64, v65
    v_cvt_pk_bf16_f32 v85, v66, v67
    v_cvt_pk_bf16_f32 v89, v68, v69
    v_cvt_pk_bf16_f32 v93, v70, v71
    v_cvt_pk_bf16_f32 v97, v72, v73
    v_cvt_pk_bf16_f32 v101, v74, v75
    v_cvt_pk_bf16_f32 v105, v76, v77
    v_cvt_pk_bf16_f32 v109, v78, v79
    v_lshlrev_b32 v48, 16, v18
    v_and_b32 v49, 0xffff0000, v18
    v_lshlrev_b32 v50, 16, v22
    v_and_b32 v51, 0xffff0000, v22
    v_lshlrev_b32 v52, 16, v26
    v_and_b32 v53, 0xffff0000, v26
    v_lshlrev_b32 v54, 16, v30
    v_and_b32 v55, 0xffff0000, v30
    v_lshlrev_b32 v56, 16, v34
    v_and_b32 v57, 0xffff0000, v34
    v_lshlrev_b32 v58, 16, v38
    v_and_b32 v59, 0xffff0000, v38
    v_lshlrev_b32 v60, 16, v42
    v_and_b32 v61, 0xffff0000, v42
    v_lshlrev_b32 v62, 16, v46
    v_and_b32 v63, 0xffff0000, v46
    v_pk_add_f32 v[64:65], v[48:49], v[50:51]
    v_pk_add_f32 v[66:67], v[48:49], v[50:51] neg_lo:[0,1] neg_hi:[0,1]
    v_pk_add_f32 v[68:69], v[52:53], v[54:55]
    v_pk_add_f32 v[70:71], v[52:53], v[54:55] neg_lo:[0,1] neg_hi:[0,1]
    v_pk_add_f32 v[72:73], v[56:57], v[58:59]
    v_pk_add_f32 v[74:75], v[56:57], v[58:59] neg_lo:[0,1] neg_hi:[0,1]
    v_pk_add_f32 v[76:77], v[60:61], v[62:63]
    v_pk_add_f32 v[78:79], v[60:61], v[62:63] neg_lo:[0,1] neg_hi:[0,1]
    v_pk_add_f32 v[48:49], v[64:65], v[68:69]
    v_pk_add_f32 v[50:51], v[72:73], v[76:77]
    v_pk_add_f32 v[52:53], v[64:65], v[68:69] neg_lo:[0,1] neg_hi:[0,1]
    v_pk_add_f32 v[54:55], v[72:73], v[76:77] neg_lo:[0,1] neg_hi:[0,1]
    v_pk_add_f32 v[56:57], v[66:67], v[70:71]
    v_pk_add_f32 v[58:59], v[74:75], v[78:79]
    v_pk_add_f32 v[60:61], v[66:67], v[70:71] neg_lo:[0,1] neg_hi:[0,1]
    v_pk_add_f32 v[62:63], v[74:75], v[78:79] neg_lo:[0,1] neg_hi:[0,1]
    v_pk_add_f32 v[64:65], v[48:49], v[50:51]
    v_pk_add_f32 v[68:69], v[48:49], v[50:51] neg_lo:[0,1] neg_hi:[0,1]
    v_pk_add_f32 v[72:73], v[52:53], v[54:55] neg_lo:[0,1] neg_hi:[0,1]
    v_pk_add_f32 v[76:77], v[52:53], v[54:55]
    v_pk_add_f32 v[66:67], v[56:57], v[58:59]
    v_pk_add_f32 v[70:71], v[56:57], v[58:59] neg_lo:[0,1] neg_hi:[0,1]
    v_pk_add_f32 v[74:75], v[60:61], v[62:63] neg_lo:[0,1] neg_hi:[0,1]
    v_pk_add_f32 v[78:79], v[60:61], v[62:63]
    v_cvt_pk_bf16_f32 v82, v64, v65
    v_cvt_pk_bf16_f32 v86, v66, v67
    v_cvt_pk_bf16_f32 v90, v68, v69
    v_cvt_pk_bf16_f32 v94, v70, v71
    v_cvt_pk_bf16_f32 v98, v72, v73
    v_cvt_pk_bf16_f32 v102, v74, v75
    v_cvt_pk_bf16_f32 v106, v76, v77
    v_cvt_pk_bf16_f32 v110, v78, v79
    v_lshlrev_b32 v48, 16, v19
    v_and_b32 v49, 0xffff0000, v19
    v_lshlrev_b32 v50, 16, v23
    v_and_b32 v51, 0xffff0000, v23
    v_lshlrev_b32 v52, 16, v27
    v_and_b32 v53, 0xffff0000, v27
    v_lshlrev_b32 v54, 16, v31
    v_and_b32 v55, 0xffff0000, v31
    v_lshlrev_b32 v56, 16, v35
    v_and_b32 v57, 0xffff0000, v35
    v_lshlrev_b32 v58, 16, v39
    v_and_b32 v59, 0xffff0000, v39
    v_lshlrev_b32 v60, 16, v43
    v_and_b32 v61, 0xffff0000, v43
    v_lshlrev_b32 v62, 16, v47
    v_and_b32 v63, 0xffff0000, v47
    v_pk_add_f32 v[64:65], v[48:49], v[50:51]
    v_pk_add_f32 v[66:67], v[48:49], v[50:51] neg_lo:[0,1] neg_hi:[0,1]
    v_pk_add_f32 v[68:69], v[52:53], v[54:55]
    v_pk_add_f32 v[70:71], v[52:53], v[54:55] neg_lo:[0,1] neg_hi:[0,1]
    v_pk_add_f32 v[72:73], v[56:57], v[58:59]
    v_pk_add_f32 v[74:75], v[56:57], v[58:59] neg_lo:[0,1] neg_hi:[0,1]
    v_pk_add_f32 v[76:77], v[60:61], v[62:63]
    v_pk_add_f32 v[78:79], v[60:61], v[62:63] neg_lo:[0,1] neg_hi:[0,1]
    v_pk_add_f32 v[48:49], v[64:65], v[68:69]
    v_pk_add_f32 v[50:51], v[72:73], v[76:77]
    v_pk_add_f32 v[52:53], v[64:65], v[68:69] neg_lo:[0,1] neg_hi:[0,1]
    v_pk_add_f32 v[54:55], v[72:73], v[76:77] neg_lo:[0,1] neg_hi:[0,1]
    v_pk_add_f32 v[56:57], v[66:67], v[70:71]
    v_pk_add_f32 v[58:59], v[74:75], v[78:79]
    v_pk_add_f32 v[60:61], v[66:67], v[70:71] neg_lo:[0,1] neg_hi:[0,1]
    v_pk_add_f32 v[62:63], v[74:75], v[78:79] neg_lo:[0,1] neg_hi:[0,1]
    v_pk_add_f32 v[64:65], v[48:49], v[50:51]
    v_pk_add_f32 v[68:69], v[48:49], v[50:51] neg_lo:[0,1] neg_hi:[0,1]
    v_pk_add_f32 v[72:73], v[52:53], v[54:55] neg_lo:[0,1] neg_hi:[0,1]
    v_pk_add_f32 v[76:77], v[52:53], v[54:55]
    v_pk_add_f32 v[66:67], v[56:57], v[58:59]
    v_pk_add_f32 v[70:71], v[56:57], v[58:59] neg_lo:[0,1] neg_hi:[0,1]
    v_pk_add_f32 v[74:75], v[60:61], v[62:63] neg_lo:[0,1] neg_hi:[0,1]
    v_pk_add_f32 v[78:79], v[60:61], v[62:63]
    v_cvt_pk_bf16_f32 v83, v64, v65
    v_cvt_pk_bf16_f32 v87, v66, v67
    v_cvt_pk_bf16_f32 v91, v68, v69
    v_cvt_pk_bf16_f32 v95, v70, v71
    v_cvt_pk_bf16_f32 v99, v72, v73
    v_cvt_pk_bf16_f32 v103, v74, v75
    v_cvt_pk_bf16_f32 v107, v76, v77
    v_cvt_pk_bf16_f32 v111, v78, v79
    buffer_store_dwordx4 v[80:83], v205, s[12:15], s55 offen sc1
    s_add_u32 s55, s55, 348160
    buffer_store_dwordx4 v[84:87], v205, s[12:15], s55 offen sc1
    s_add_u32 s55, s55, 348160
    buffer_store_dwordx4 v[88:91], v205, s[12:15], s55 offen sc1
    s_add_u32 s55, s55, 348160
    buffer_store_dwordx4 v[92:95], v205, s[12:15], s55 offen sc1
    s_add_u32 s55, s55, 348160
    buffer_store_dwordx4 v[96:99], v205, s[12:15], s55 offen sc1
    s_add_u32 s55, s55, 348160
    buffer_store_dwordx4 v[100:103], v205, s[12:15], s55 offen sc1
    s_add_u32 s55, s55, 348160
    buffer_store_dwordx4 v[104:107], v205, s[12:15], s55 offen sc1
    s_add_u32 s55, s55, 348160
    buffer_store_dwordx4 v[108:111], v205, s[12:15], s55 offen sc1
    s_waitcnt vmcnt(0)
    s_cmp_lt_u32 s3, 4
    s_cbranch_scc1 concat_heads__mha_block__spectral_fnet__prompt_kernel_s1
    s_branch concat_heads__mha_block__spectral_fnet__prompt_kernel_tagget
concat_heads__mha_block__spectral_fnet__prompt_kernel_comp:
    s_getpc_b64 s[56:57]
    s_sub_u32 s56, s56, concat_heads__mha_block__spectral_fnet__prompt_kernel_comp + 4 - concat_heads__mha_block__spectral_fnet__prompt_kernel
    s_subb_u32 s57, s57, 0
    s_lshr_b32 s27, s2, 3
    s_lshl_b32 s27, s27, 2
    s_add_u32 s27, s27, s3
    s_lshl_b32 s27, s27, 9
    v_and_b32 v2, 3, v0
    v_lshl_add_u32 v2, v2, 7, s27
    v_min_u32 v2, concat_heads__mha_block__spectral_fnet__prompt_kernel_exit - concat_heads__mha_block__spectral_fnet__prompt_kernel, v2
    global_load_dword v207, v2, s[56:57]
    s_waitcnt lgkmcnt(0)
    s_add_u32 s12, s50, 0x0
    s_addc_u32 s13, s51, 0
    s_mov_b32 s50, 256
    s_mov_b32 s51, 0x00020000
    s_cmp_ge_u32 s30, 15
    s_cbranch_scc1 concat_heads__mha_block__spectral_fnet__prompt_kernel_idle
    s_mul_i32 s23, s30, 52
    s_lshr_b32 s23, s23, 8
    s_mul_i32 s24, s23, 5
    s_sub_u32 s24, s30, s24
    s_mul_i32 s52, s24, 49152
    s_lshl_b32 s23, s23, 12
    s_add_u32 s52, s52, s23
    s_lshl_b32 s23, s31, 8
    s_add_u32 s52, s52, s23
    s_add_u32 s52, s52, 0x2000000
    v_lshrrev_b32 v206, 4, v0
    v_and_b32 v2, 15, v0
    v_lshlrev_b32 v206, 14, v206
    v_lshl_add_u32 v206, v2, 4, v206
    s_cmp_eq_u32 s24, 0
    s_cselect_b32 s54, -1, 0xffffff00
    s_cmp_eq_u32 s24, 4
    s_cselect_b32 s55, -1, 0xffffff
    s_cmp_lg_u32 s3, 1
    s_cbranch_scc1 concat_heads__mha_block__spectral_fnet__prompt_kernel_nopt
    v_mov_b32 v100, 0
    v_mov_b32 v101, 0
    v_mov_b32 v102, 0
    v_mov_b32 v103, 0
    s_mov_b64 exec, s[54:55]
    buffer_store_dwordx4 v[100:103], v206, s[12:15], s52 offen sc1
    s_mov_b64 exec, -1
concat_heads__mha_block__spectral_fnet__prompt_kernel_nopt:
    v_and_b32 v1, 31, v0
    v_lshrrev_b32 v2, 5, v0
    v_mov_b32 v6, v1
    s_cmp_lt_u32 s30, 10
    s_cbranch_scc1 concat_heads__mha_block__spectral_fnet__prompt_kernel_nosw
    v_and_b32 v6, 19, v0
    v_lshrrev_b32 v3, 1, v0
    v_and_b32 v3, 4, v3
    v_lshlrev_b32 v4, 1, v0
    v_and_b32 v4, 8, v4
    v_or3_b32 v6, v6, v3, v4
concat_heads__mha_block__spectral_fnet__prompt_kernel_nosw:
    v_bfe_u32 v3, v6, 1, 3
    v_xor_b32 v3, v3, v2
    s_and_b32 s23, s3, 1
    s_lshl_b32 s23, s23, 13
    v_lshl_add_u32 v4, v6, 7, s23
    v_xor_b32 v5, 0, v3
    v_lshl_add_u32 v17, v5, 4, v4
    v_add_u32 v21, 0x10000, v17
    v_add_u32 v25, 0x20000, v17
    v_xor_b32 v5, 2, v3
    v_lshl_add_u32 v18, v5, 4, v4
    v_add_u32 v22, 0x10000, v18
    v_add_u32 v26, 0x20000, v18
    v_xor_b32 v5, 4, v3
    v_lshl_add_u32 v19, v5, 4, v4
    v_add_u32 v23, 0x10000, v19
    v_add_u32 v27, 0x20000, v19
    v_xor_b32 v5, 6, v3
    v_lshl_add_u32 v20, v5, 4, v4
    v_add_u32 v24, 0x10000, v20
    v_add_u32 v28, 0x20000, v20
    v_and_b32 v5, 1, v0
    v_bfe_u32 v6, v0, 1, 1
    s_cmp_ge_u32 s30, 10
    s_cselect_b64 vcc, -1, 0
    v_bfe_u32 v3, v0, 2, 2
    v_lshl_add_u32 v4, v2, 3, v3
    v_cndmask_b32 v7, v6, v5, vcc
    v_cndmask_b32 v6, v5, v6, vcc
    v_lshlrev_b32 v4, 8, v4
    v_lshl_add_u32 v4, v7, 3, v4
    v_add_u32 v4, 16384, v4
    v_bfe_u32 v5, v0, 4, 1
    v_lshl_add_u32 v5, v5, 1, v6
    v_lshl_add_u32 v5, v3, 2, v5
    s_lshr_b32 s23, s3, 1
    s_lshl_b32 s24, s23, 3
    v_xor_b32 v5, s24, v5
    v_lshl_add_u32 v29, v5, 4, v4
    v_xor_b32 v5, 4, v5
    v_lshl_add_u32 v30, v5, 4, v4
    v_add_u32 v31, 0x10000, v29
    v_add_u32 v32, 0x10000, v30
    v_add_u32 v33, 0x20000, v29
    v_add_u32 v34, 0x20000, v30
    s_and_b32 s25, s3, 1
    s_lshl_b32 s26, s31, 1
    s_add_u32 s25, s25, s26
    s_lshl_b32 s25, s25, 1
    s_cmp_ge_u32 s30, 10
    s_cbranch_scc1 concat_heads__mha_block__spectral_fnet__prompt_kernel_vset
    s_cmp_ge_u32 s30, 5
    s_cselect_b32 s26, 5, 0
    s_mov_b32 s27, 40960
    s_cselect_b32 s27, 82048, s27
    s_cselect_b32 s20, 0x300000, 0
    s_mov_b32 s42, 0x3ea52b5c
    s_sub_u32 s26, s30, s26
    s_mul_i32 s25, s25, s27
    s_add_u32 s20, s20, s25
    s_add_u32 s21, s20, s27
    s_lshl_b32 s26, s26, 4
    s_add_u32 s26, s26, s24
    v_add_u32 v3, s26, v2
    v_add_u32 v4, 0, v3
    v_mul_u32_u24 v5, 205, v4
    v_lshrrev_b32 v5, 10, v5
    v_mul_u32_u24 v6, 5, v5
    v_sub_u32 v6, v4, v6
    v_cmp_lt_u32 vcc, 2, v6
    v_mul_u32_u24 v5, 2560, v5
    v_lshl_add_u32 v5, v1, 4, v5
    v_subb_co_u32 v7, vcc, v6, 0, vcc
    v_cmp_eq_u32 vcc, 2, v6
    s_nop 1
    v_cndmask_b32 v7, v7, 4, vcc
    v_lshl_add_u32 v9, v7, 9, v5
    v_add_u32 v4, 2, v3
    v_mul_u32_u24 v5, 205, v4
    v_lshrrev_b32 v5, 10, v5
    v_mul_u32_u24 v6, 5, v5
    v_sub_u32 v6, v4, v6
    v_cmp_lt_u32 vcc, 2, v6
    v_mul_u32_u24 v5, 2560, v5
    v_lshl_add_u32 v5, v1, 4, v5
    v_subb_co_u32 v7, vcc, v6, 0, vcc
    v_cmp_eq_u32 vcc, 2, v6
    s_nop 1
    v_cndmask_b32 v7, v7, 4, vcc
    v_lshl_add_u32 v10, v7, 9, v5
    v_add_u32 v4, 4, v3
    v_mul_u32_u24 v5, 205, v4
    v_lshrrev_b32 v5, 10, v5
    v_mul_u32_u24 v6, 5, v5
    v_sub_u32 v6, v4, v6
    v_cmp_lt_u32 vcc, 2, v6
    v_mul_u32_u24 v5, 2560, v5
    v_lshl_add_u32 v5, v1, 4, v5
    v_subb_co_u32 v7, vcc, v6, 0, vcc
    v_cmp_eq_u32 vcc, 2, v6
    s_nop 1
    v_cndmask_b32 v7, v7, 4, vcc
    v_lshl_add_u32 v11, v7, 9, v5
    v_add_u32 v4, 6, v3
    v_mul_u32_u24 v5, 205, v4
    v_lshrrev_b32 v5, 10, v5
    v_mul_u32_u24 v6, 5, v5
    v_sub_u32 v6, v4, v6
    v_cmp_lt_u32 vcc, 2, v6
    v_mul_u32_u24 v5, 2560, v5
    v_lshl_add_u32 v5, v1, 4, v5
    v_subb_co_u32 v7, vcc, v6, 0, vcc
    v_cmp_eq_u32 vcc, 2, v6
    s_nop 1
    v_cndmask_b32 v7, v7, 4, vcc
    v_lshl_add_u32 v12, v7, 9, v5
    s_setprio 1
    s_barrier
    ds_read_b128 v[100:103], v17 offset:0
    ds_read_b128 v[104:107], v17 offset:4096
    ds_read_b64_tr_b16 v[116:117], v29 offset:0
    ds_read_b64_tr_b16 v[118:119], v29 offset:1024
    ds_read_b64_tr_b16 v[120:121], v30 offset:0
    ds_read_b64_tr_b16 v[122:123], v30 offset:1024
    s_waitcnt lgkmcnt(0)
    v_mfma_f32_32x32x16_bf16 v[36:51], v[116:119], v[100:103], 0
    ds_read_b128 v[108:111], v18 offset:0
    ds_read_b128 v[112:115], v18 offset:4096
    v_mfma_f32_32x32x16_bf16 v[52:67], v[116:119], v[104:107], 0
    ds_read_b64_tr_b16 v[124:125], v29 offset:4096
    ds_read_b64_tr_b16 v[126:127], v29 offset:5120
    v_mfma_f32_32x32x16_bf16 v[68:83], v[120:123], v[100:103], 0
    ds_read_b64_tr_b16 v[128:129], v30 offset:4096
    ds_read_b64_tr_b16 v[130:131], v30 offset:5120
    v_mfma_f32_32x32x16_bf16 v[84:99], v[120:123], v[104:107], 0
    s_waitcnt lgkmcnt(0)
    v_mfma_f32_32x32x16_bf16 v[36:51], v[124:127], v[108:111], v[36:51]
    ds_read_b128 v[100:103], v19 offset:0
    ds_read_b128 v[104:107], v19 offset:4096
    v_mfma_f32_32x32x16_bf16 v[52:67], v[124:127], v[112:115], v[52:67]
    ds_read_b64_tr_b16 v[116:117], v29 offset:8192
    ds_read_b64_tr_b16 v[118:119], v29 offset:9216
    v_mfma_f32_32x32x16_bf16 v[68:83], v[128:131], v[108:111], v[68:83]
    ds_read_b64_tr_b16 v[120:121], v30 offset:8192
    ds_read_b64_tr_b16 v[122:123], v30 offset:9216
    v_mfma_f32_32x32x16_bf16 v[84:99], v[128:131], v[112:115], v[84:99]
    s_waitcnt lgkmcnt(0)
    v_mfma_f32_32x32x16_bf16 v[36:51], v[116:119], v[100:103], v[36:51]
    ds_read_b128 v[108:111], v20 offset:0
    ds_read_b128 v[112:115], v20 offset:4096
    v_mfma_f32_32x32x16_bf16 v[52:67], v[116:119], v[104:107], v[52:67]
    ds_read_b64_tr_b16 v[124:125], v29 offset:12288
    ds_read_b64_tr_b16 v[126:127], v29 offset:13312
    v_mfma_f32_32x32x16_bf16 v[68:83], v[120:123], v[100:103], v[68:83]
    ds_read_b64_tr_b16 v[128:129], v30 offset:12288
    ds_read_b64_tr_b16 v[130:131], v30 offset:13312
    s_barrier
    v_mfma_f32_32x32x16_bf16 v[84:99], v[120:123], v[104:107], v[84:99]
    s_waitcnt lgkmcnt(0)
    v_mfma_f32_32x32x16_bf16 v[36:51], v[124:127], v[108:111], v[36:51]
    ds_read_b128 v[100:103], v17 offset:32768
    ds_read_b128 v[104:107], v17 offset:36864
    v_mfma_f32_32x32x16_bf16 v[52:67], v[124:127], v[112:115], v[52:67]
    ds_read_b64_tr_b16 v[116:117], v29 offset:32768
    ds_read_b64_tr_b16 v[118:119], v29 offset:33792
    v_mfma_f32_32x32x16_bf16 v[68:83], v[128:131], v[108:111], v[68:83]
    ds_read_b64_tr_b16 v[120:121], v30 offset:32768
    ds_read_b64_tr_b16 v[122:123], v30 offset:33792
    v_mfma_f32_32x32x16_bf16 v[84:99], v[128:131], v[112:115], v[84:99]
    s_waitcnt lgkmcnt(0)
    v_mfma_f32_32x32x16_bf16 v[36:51], v[116:119], v[100:103], v[36:51]
    ds_read_b128 v[108:111], v18 offset:32768
    ds_read_b128 v[112:115], v18 offset:36864
    v_mfma_f32_32x32x16_bf16 v[52:67], v[116:119], v[104:107], v[52:67]
    ds_read_b64_tr_b16 v[124:125], v29 offset:36864
    ds_read_b64_tr_b16 v[126:127], v29 offset:37888
    v_mfma_f32_32x32x16_bf16 v[68:83], v[120:123], v[100:103], v[68:83]
    ds_read_b64_tr_b16 v[128:129], v30 offset:36864
    ds_read_b64_tr_b16 v[130:131], v30 offset:37888
    v_mfma_f32_32x32x16_bf16 v[84:99], v[120:123], v[104:107], v[84:99]
    s_waitcnt lgkmcnt(0)
    v_mfma_f32_32x32x16_bf16 v[36:51], v[124:127], v[108:111], v[36:51]
    ds_read_b128 v[100:103], v19 offset:32768
    ds_read_b128 v[104:107], v19 offset:36864
    v_mfma_f32_32x32x16_bf16 v[52:67], v[124:127], v[112:115], v[52:67]
    ds_read_b64_tr_b16 v[116:117], v29 offset:40960
    ds_read_b64_tr_b16 v[118:119], v29 offset:41984
    v_mfma_f32_32x32x16_bf16 v[68:83], v[128:131], v[108:111], v[68:83]
    ds_read_b64_tr_b16 v[120:121], v30 offset:40960
    ds_read_b64_tr_b16 v[122:123], v30 offset:41984
    v_mfma_f32_32x32x16_bf16 v[84:99], v[128:131], v[112:115], v[84:99]
    s_waitcnt lgkmcnt(0)
    v_mfma_f32_32x32x16_bf16 v[36:51], v[116:119], v[100:103], v[36:51]
    ds_read_b128 v[108:111], v20 offset:32768
    ds_read_b128 v[112:115], v20 offset:36864
    v_mfma_f32_32x32x16_bf16 v[52:67], v[116:119], v[104:107], v[52:67]
    ds_read_b64_tr_b16 v[124:125], v29 offset:45056
    ds_read_b64_tr_b16 v[126:127], v29 offset:46080
    v_mfma_f32_32x32x16_bf16 v[68:83], v[120:123], v[100:103], v[68:83]
    ds_read_b64_tr_b16 v[128:129], v30 offset:45056
    ds_read_b64_tr_b16 v[130:131], v30 offset:46080
    s_barrier
    v_mfma_f32_32x32x16_bf16 v[84:99], v[120:123], v[104:107], v[84:99]
    s_waitcnt lgkmcnt(0)
    v_mfma_f32_32x32x16_bf16 v[36:51], v[124:127], v[108:111], v[36:51]
    ds_read_b128 v[100:103], v21 offset:0
    ds_read_b128 v[104:107], v21 offset:4096
    v_mfma_f32_32x32x16_bf16 v[52:67], v[124:127], v[112:115], v[52:67]
    ds_read_b64_tr_b16 v[116:117], v31 offset:0
    ds_read_b64_tr_b16 v[118:119], v31 offset:1024
    v_mfma_f32_32x32x16_bf16 v[68:83], v[128:131], v[108:111], v[68:83]
    ds_read_b64_tr_b16 v[120:121], v32 offset:0
    ds_read_b64_tr_b16 v[122:123], v32 offset:1024
    v_mfma_f32_32x32x16_bf16 v[84:99], v[128:131], v[112:115], v[84:99]
    s_waitcnt lgkmcnt(0)
    v_mfma_f32_32x32x16_bf16 v[36:51], v[116:119], v[100:103], v[36:51]
    ds_read_b128 v[108:111], v22 offset:0
    ds_read_b128 v[112:115], v22 offset:4096
    v_mfma_f32_32x32x16_bf16 v[52:67], v[116:119], v[104:107], v[52:67]
    ds_read_b64_tr_b16 v[124:125], v31 offset:4096
    ds_read_b64_tr_b16 v[126:127], v31 offset:5120
    v_mfma_f32_32x32x16_bf16 v[68:83], v[120:123], v[100:103], v[68:83]
    ds_read_b64_tr_b16 v[128:129], v32 offset:4096
    ds_read_b64_tr_b16 v[130:131], v32 offset:5120
    v_mfma_f32_32x32x16_bf16 v[84:99], v[120:123], v[104:107], v[84:99]
    s_waitcnt lgkmcnt(0)
    v_mfma_f32_32x32x16_bf16 v[36:51], v[124:127], v[108:111], v[36:51]
    ds_read_b128 v[100:103], v23 offset:0
    ds_read_b128 v[104:107], v23 offset:4096
    v_mfma_f32_32x32x16_bf16 v[52:67], v[124:127], v[112:115], v[52:67]
    ds_read_b64_tr_b16 v[116:117], v31 offset:8192
    ds_read_b64_tr_b16 v[118:119], v31 offset:9216
    v_mfma_f32_32x32x16_bf16 v[68:83], v[128:131], v[108:111], v[68:83]
    ds_read_b64_tr_b16 v[120:121], v32 offset:8192
    ds_read_b64_tr_b16 v[122:123], v32 offset:9216
    v_mfma_f32_32x32x16_bf16 v[84:99], v[128:131], v[112:115], v[84:99]
    s_waitcnt lgkmcnt(0)
    v_mfma_f32_32x32x16_bf16 v[36:51], v[116:119], v[100:103], v[36:51]
    ds_read_b128 v[108:111], v24 offset:0
    ds_read_b128 v[112:115], v24 offset:4096
    v_mfma_f32_32x32x16_bf16 v[52:67], v[116:119], v[104:107], v[52:67]
    ds_read_b64_tr_b16 v[124:125], v31 offset:12288
    ds_read_b64_tr_b16 v[126:127], v31 offset:13312
    v_mfma_f32_32x32x16_bf16 v[68:83], v[120:123], v[100:103], v[68:83]
    ds_read_b64_tr_b16 v[128:129], v32 offset:12288
    ds_read_b64_tr_b16 v[130:131], v32 offset:13312
    s_barrier
    v_mfma_f32_32x32x16_bf16 v[84:99], v[120:123], v[104:107], v[84:99]
    s_waitcnt lgkmcnt(0)
    v_mfma_f32_32x32x16_bf16 v[36:51], v[124:127], v[108:111], v[36:51]
    ds_read_b128 v[100:103], v21 offset:32768
    ds_read_b128 v[104:107], v21 offset:36864
    v_mfma_f32_32x32x16_bf16 v[52:67], v[124:127], v[112:115], v[52:67]
    ds_read_b64_tr_b16 v[116:117], v31 offset:32768
    ds_read_b64_tr_b16 v[118:119], v31 offset:33792
    v_mfma_f32_32x32x16_bf16 v[68:83], v[128:131], v[108:111], v[68:83]
    ds_read_b64_tr_b16 v[120:121], v32 offset:32768
    ds_read_b64_tr_b16 v[122:123], v32 offset:33792
    v_mfma_f32_32x32x16_bf16 v[84:99], v[128:131], v[112:115], v[84:99]
    s_waitcnt lgkmcnt(0)
    v_mfma_f32_32x32x16_bf16 v[36:51], v[116:119], v[100:103], v[36:51]
    ds_read_b128 v[108:111], v22 offset:32768
    ds_read_b128 v[112:115], v22 offset:36864
    v_mfma_f32_32x32x16_bf16 v[52:67], v[116:119], v[104:107], v[52:67]
    ds_read_b64_tr_b16 v[124:125], v31 offset:36864
    ds_read_b64_tr_b16 v[126:127], v31 offset:37888
    v_mfma_f32_32x32x16_bf16 v[68:83], v[120:123], v[100:103], v[68:83]
    ds_read_b64_tr_b16 v[128:129], v32 offset:36864
    ds_read_b64_tr_b16 v[130:131], v32 offset:37888
    v_mfma_f32_32x32x16_bf16 v[84:99], v[120:123], v[104:107], v[84:99]
    s_waitcnt lgkmcnt(0)
    v_mfma_f32_32x32x16_bf16 v[36:51], v[124:127], v[108:111], v[36:51]
    ds_read_b128 v[100:103], v23 offset:32768
    ds_read_b128 v[104:107], v23 offset:36864
    v_mfma_f32_32x32x16_bf16 v[52:67], v[124:127], v[112:115], v[52:67]
    ds_read_b64_tr_b16 v[116:117], v31 offset:40960
    ds_read_b64_tr_b16 v[118:119], v31 offset:41984
    v_mfma_f32_32x32x16_bf16 v[68:83], v[128:131], v[108:111], v[68:83]
    ds_read_b64_tr_b16 v[120:121], v32 offset:40960
    ds_read_b64_tr_b16 v[122:123], v32 offset:41984
    v_mfma_f32_32x32x16_bf16 v[84:99], v[128:131], v[112:115], v[84:99]
    s_waitcnt lgkmcnt(0)
    v_mfma_f32_32x32x16_bf16 v[36:51], v[116:119], v[100:103], v[36:51]
    ds_read_b128 v[108:111], v24 offset:32768
    ds_read_b128 v[112:115], v24 offset:36864
    v_mfma_f32_32x32x16_bf16 v[52:67], v[116:119], v[104:107], v[52:67]
    ds_read_b64_tr_b16 v[124:125], v31 offset:45056
    ds_read_b64_tr_b16 v[126:127], v31 offset:46080
    v_mfma_f32_32x32x16_bf16 v[68:83], v[120:123], v[100:103], v[68:83]
    ds_read_b64_tr_b16 v[128:129], v32 offset:45056
    ds_read_b64_tr_b16 v[130:131], v32 offset:46080
    s_barrier
    v_mfma_f32_32x32x16_bf16 v[84:99], v[120:123], v[104:107], v[84:99]
    s_waitcnt lgkmcnt(0)
    v_mfma_f32_32x32x16_bf16 v[36:51], v[124:127], v[108:111], v[36:51]
    ds_read_b128 v[100:103], v25 offset:0
    ds_read_b128 v[104:107], v25 offset:4096
    v_mfma_f32_32x32x16_bf16 v[52:67], v[124:127], v[112:115], v[52:67]
    ds_read_b64_tr_b16 v[116:117], v33 offset:0
    ds_read_b64_tr_b16 v[118:119], v33 offset:1024
    v_mfma_f32_32x32x16_bf16 v[68:83], v[128:131], v[108:111], v[68:83]
    ds_read_b64_tr_b16 v[120:121], v34 offset:0
    ds_read_b64_tr_b16 v[122:123], v34 offset:1024
    v_mfma_f32_32x32x16_bf16 v[84:99], v[128:131], v[112:115], v[84:99]
    s_waitcnt lgkmcnt(0)
    v_mfma_f32_32x32x16_bf16 v[36:51], v[116:119], v[100:103], v[36:51]
    ds_read_b128 v[108:111], v26 offset:0
    ds_read_b128 v[112:115], v26 offset:4096
    v_mfma_f32_32x32x16_bf16 v[52:67], v[116:119], v[104:107], v[52:67]
    ds_read_b64_tr_b16 v[124:125], v33 offset:4096
    ds_read_b64_tr_b16 v[126:127], v33 offset:5120
    v_mfma_f32_32x32x16_bf16 v[68:83], v[120:123], v[100:103], v[68:83]
    ds_read_b64_tr_b16 v[128:129], v34 offset:4096
    ds_read_b64_tr_b16 v[130:131], v34 offset:5120
    v_mfma_f32_32x32x16_bf16 v[84:99], v[120:123], v[104:107], v[84:99]
    s_waitcnt lgkmcnt(0)
    v_mfma_f32_32x32x16_bf16 v[36:51], v[124:127], v[108:111], v[36:51]
    ds_read_b128 v[100:103], v27 offset:0
    ds_read_b128 v[104:107], v27 offset:4096
    v_mfma_f32_32x32x16_bf16 v[52:67], v[124:127], v[112:115], v[52:67]
    ds_read_b64_tr_b16 v[116:117], v33 offset:8192
    ds_read_b64_tr_b16 v[118:119], v33 offset:9216
    v_mfma_f32_32x32x16_bf16 v[68:83], v[128:131], v[108:111], v[68:83]
    ds_read_b64_tr_b16 v[120:121], v34 offset:8192
    ds_read_b64_tr_b16 v[122:123], v34 offset:9216
    v_mfma_f32_32x32x16_bf16 v[84:99], v[128:131], v[112:115], v[84:99]
    s_waitcnt lgkmcnt(0)
    v_mfma_f32_32x32x16_bf16 v[36:51], v[116:119], v[100:103], v[36:51]
    ds_read_b128 v[108:111], v28 offset:0
    ds_read_b128 v[112:115], v28 offset:4096
    v_mfma_f32_32x32x16_bf16 v[52:67], v[116:119], v[104:107], v[52:67]
    ds_read_b64_tr_b16 v[124:125], v33 offset:12288
    ds_read_b64_tr_b16 v[126:127], v33 offset:13312
    v_mfma_f32_32x32x16_bf16 v[68:83], v[120:123], v[100:103], v[68:83]
    ds_read_b64_tr_b16 v[128:129], v34 offset:12288
    ds_read_b64_tr_b16 v[130:131], v34 offset:13312
    s_barrier
    v_mfma_f32_32x32x16_bf16 v[84:99], v[120:123], v[104:107], v[84:99]
    s_waitcnt lgkmcnt(0)
    v_mfma_f32_32x32x16_bf16 v[36:51], v[124:127], v[108:111], v[36:51]
    ds_read_b128 v[100:103], v17 offset:0
    ds_read_b128 v[104:107], v17 offset:4096
    v_mfma_f32_32x32x16_bf16 v[52:67], v[124:127], v[112:115], v[52:67]
    ds_read_b64_tr_b16 v[116:117], v29 offset:0
    ds_read_b64_tr_b16 v[118:119], v29 offset:1024
    v_mfma_f32_32x32x16_bf16 v[68:83], v[128:131], v[108:111], v[68:83]
    ds_read_b64_tr_b16 v[120:121], v30 offset:0
    ds_read_b64_tr_b16 v[122:123], v30 offset:1024
    v_mfma_f32_32x32x16_bf16 v[84:99], v[128:131], v[112:115], v[84:99]
    s_waitcnt lgkmcnt(0)
    v_mfma_f32_32x32x16_bf16 v[36:51], v[116:119], v[100:103], v[36:51]
    ds_read_b128 v[108:111], v18 offset:0
    ds_read_b128 v[112:115], v18 offset:4096
    v_mfma_f32_32x32x16_bf16 v[52:67], v[116:119], v[104:107], v[52:67]
    ds_read_b64_tr_b16 v[124:125], v29 offset:4096
    ds_read_b64_tr_b16 v[126:127], v29 offset:5120
    v_mfma_f32_32x32x16_bf16 v[68:83], v[120:123], v[100:103], v[68:83]
    ds_read_b64_tr_b16 v[128:129], v30 offset:4096
    ds_read_b64_tr_b16 v[130:131], v30 offset:5120
    v_mfma_f32_32x32x16_bf16 v[84:99], v[120:123], v[104:107], v[84:99]
    s_waitcnt lgkmcnt(0)
    v_mfma_f32_32x32x16_bf16 v[36:51], v[124:127], v[108:111], v[36:51]
    ds_read_b128 v[100:103], v19 offset:0
    ds_read_b128 v[104:107], v19 offset:4096
    v_mfma_f32_32x32x16_bf16 v[52:67], v[124:127], v[112:115], v[52:67]
    ds_read_b64_tr_b16 v[116:117], v29 offset:8192
    ds_read_b64_tr_b16 v[118:119], v29 offset:9216
    v_mfma_f32_32x32x16_bf16 v[68:83], v[128:131], v[108:111], v[68:83]
    ds_read_b64_tr_b16 v[120:121], v30 offset:8192
    ds_read_b64_tr_b16 v[122:123], v30 offset:9216
    v_mfma_f32_32x32x16_bf16 v[84:99], v[128:131], v[112:115], v[84:99]
    s_waitcnt lgkmcnt(0)
    v_mfma_f32_32x32x16_bf16 v[36:51], v[116:119], v[100:103], v[36:51]
    ds_read_b128 v[108:111], v20 offset:0
    ds_read_b128 v[112:115], v20 offset:4096
    v_mfma_f32_32x32x16_bf16 v[52:67], v[116:119], v[104:107], v[52:67]
    ds_read_b64_tr_b16 v[124:125], v29 offset:12288
    ds_read_b64_tr_b16 v[126:127], v29 offset:13312
    v_mfma_f32_32x32x16_bf16 v[68:83], v[120:123], v[100:103], v[68:83]
    ds_read_b64_tr_b16 v[128:129], v30 offset:12288
    ds_read_b64_tr_b16 v[130:131], v30 offset:13312
    s_barrier
    v_mfma_f32_32x32x16_bf16 v[84:99], v[120:123], v[104:107], v[84:99]
    s_waitcnt lgkmcnt(0)
    v_mfma_f32_32x32x16_bf16 v[36:51], v[124:127], v[108:111], v[36:51]
    ds_read_b128 v[100:103], v17 offset:32768
    ds_read_b128 v[104:107], v17 offset:36864
    v_mfma_f32_32x32x16_bf16 v[52:67], v[124:127], v[112:115], v[52:67]
    ds_read_b64_tr_b16 v[116:117], v29 offset:32768
    ds_read_b64_tr_b16 v[118:119], v29 offset:33792
    v_mfma_f32_32x32x16_bf16 v[68:83], v[128:131], v[108:111], v[68:83]
    ds_read_b64_tr_b16 v[120:121], v30 offset:32768
    ds_read_b64_tr_b16 v[122:123], v30 offset:33792
    v_mfma_f32_32x32x16_bf16 v[84:99], v[128:131], v[112:115], v[84:99]
    s_waitcnt lgkmcnt(0)
    v_mfma_f32_32x32x16_bf16 v[36:51], v[116:119], v[100:103], v[36:51]
    ds_read_b128 v[108:111], v18 offset:32768
    ds_read_b128 v[112:115], v18 offset:36864
    v_mfma_f32_32x32x16_bf16 v[52:67], v[116:119], v[104:107], v[52:67]
    ds_read_b64_tr_b16 v[124:125], v29 offset:36864
    ds_read_b64_tr_b16 v[126:127], v29 offset:37888
    v_mfma_f32_32x32x16_bf16 v[68:83], v[120:123], v[100:103], v[68:83]
    ds_read_b64_tr_b16 v[128:129], v30 offset:36864
    ds_read_b64_tr_b16 v[130:131], v30 offset:37888
    v_mfma_f32_32x32x16_bf16 v[84:99], v[120:123], v[104:107], v[84:99]
    s_waitcnt lgkmcnt(0)
    v_mfma_f32_32x32x16_bf16 v[36:51], v[124:127], v[108:111], v[36:51]
    ds_read_b128 v[100:103], v19 offset:32768
    ds_read_b128 v[104:107], v19 offset:36864
    v_mfma_f32_32x32x16_bf16 v[52:67], v[124:127], v[112:115], v[52:67]
    ds_read_b64_tr_b16 v[116:117], v29 offset:40960
    ds_read_b64_tr_b16 v[118:119], v29 offset:41984
    v_mfma_f32_32x32x16_bf16 v[68:83], v[128:131], v[108:111], v[68:83]
    ds_read_b64_tr_b16 v[120:121], v30 offset:40960
    ds_read_b64_tr_b16 v[122:123], v30 offset:41984
    v_mfma_f32_32x32x16_bf16 v[84:99], v[128:131], v[112:115], v[84:99]
    s_waitcnt lgkmcnt(0)
    v_mfma_f32_32x32x16_bf16 v[36:51], v[116:119], v[100:103], v[36:51]
    ds_read_b128 v[108:111], v20 offset:32768
    ds_read_b128 v[112:115], v20 offset:36864
    v_mfma_f32_32x32x16_bf16 v[52:67], v[116:119], v[104:107], v[52:67]
    ds_read_b64_tr_b16 v[124:125], v29 offset:45056
    ds_read_b64_tr_b16 v[126:127], v29 offset:46080
    v_mfma_f32_32x32x16_bf16 v[68:83], v[120:123], v[100:103], v[68:83]
    ds_read_b64_tr_b16 v[128:129], v30 offset:45056
    ds_read_b64_tr_b16 v[130:131], v30 offset:46080
    s_barrier
    v_mfma_f32_32x32x16_bf16 v[84:99], v[120:123], v[104:107], v[84:99]
    s_waitcnt lgkmcnt(0)
    v_mfma_f32_32x32x16_bf16 v[36:51], v[124:127], v[108:111], v[36:51]
    ds_read_b128 v[100:103], v21 offset:0
    ds_read_b128 v[104:107], v21 offset:4096
    v_mfma_f32_32x32x16_bf16 v[52:67], v[124:127], v[112:115], v[52:67]
    ds_read_b64_tr_b16 v[116:117], v31 offset:0
    ds_read_b64_tr_b16 v[118:119], v31 offset:1024
    v_mfma_f32_32x32x16_bf16 v[68:83], v[128:131], v[108:111], v[68:83]
    ds_read_b64_tr_b16 v[120:121], v32 offset:0
    ds_read_b64_tr_b16 v[122:123], v32 offset:1024
    v_mfma_f32_32x32x16_bf16 v[84:99], v[128:131], v[112:115], v[84:99]
    s_waitcnt lgkmcnt(0)
    v_mfma_f32_32x32x16_bf16 v[36:51], v[116:119], v[100:103], v[36:51]
    ds_read_b128 v[108:111], v22 offset:0
    ds_read_b128 v[112:115], v22 offset:4096
    v_mfma_f32_32x32x16_bf16 v[52:67], v[116:119], v[104:107], v[52:67]
    ds_read_b64_tr_b16 v[124:125], v31 offset:4096
    ds_read_b64_tr_b16 v[126:127], v31 offset:5120
    v_mfma_f32_32x32x16_bf16 v[68:83], v[120:123], v[100:103], v[68:83]
    ds_read_b64_tr_b16 v[128:129], v32 offset:4096
    ds_read_b64_tr_b16 v[130:131], v32 offset:5120
    v_mfma_f32_32x32x16_bf16 v[84:99], v[120:123], v[104:107], v[84:99]
    s_waitcnt lgkmcnt(0)
    v_mfma_f32_32x32x16_bf16 v[36:51], v[124:127], v[108:111], v[36:51]
    ds_read_b128 v[100:103], v23 offset:0
    ds_read_b128 v[104:107], v23 offset:4096
    v_mfma_f32_32x32x16_bf16 v[52:67], v[124:127], v[112:115], v[52:67]
    ds_read_b64_tr_b16 v[116:117], v31 offset:8192
    ds_read_b64_tr_b16 v[118:119], v31 offset:9216
    v_mfma_f32_32x32x16_bf16 v[68:83], v[128:131], v[108:111], v[68:83]
    ds_read_b64_tr_b16 v[120:121], v32 offset:8192
    ds_read_b64_tr_b16 v[122:123], v32 offset:9216
    v_mfma_f32_32x32x16_bf16 v[84:99], v[128:131], v[112:115], v[84:99]
    s_waitcnt lgkmcnt(0)
    v_mfma_f32_32x32x16_bf16 v[36:51], v[116:119], v[100:103], v[36:51]
    ds_read_b128 v[108:111], v24 offset:0
    ds_read_b128 v[112:115], v24 offset:4096
    v_mfma_f32_32x32x16_bf16 v[52:67], v[116:119], v[104:107], v[52:67]
    ds_read_b64_tr_b16 v[124:125], v31 offset:12288
    ds_read_b64_tr_b16 v[126:127], v31 offset:13312
    v_mfma_f32_32x32x16_bf16 v[68:83], v[120:123], v[100:103], v[68:83]
    ds_read_b64_tr_b16 v[128:129], v32 offset:12288
    ds_read_b64_tr_b16 v[130:131], v32 offset:13312
    s_barrier
    v_mfma_f32_32x32x16_bf16 v[84:99], v[120:123], v[104:107], v[84:99]
    s_waitcnt lgkmcnt(0)
    v_mfma_f32_32x32x16_bf16 v[36:51], v[124:127], v[108:111], v[36:51]
    ds_read_b128 v[100:103], v21 offset:32768
    ds_read_b128 v[104:107], v21 offset:36864
    v_mfma_f32_32x32x16_bf16 v[52:67], v[124:127], v[112:115], v[52:67]
    ds_read_b64_tr_b16 v[116:117], v31 offset:32768
    ds_read_b64_tr_b16 v[118:119], v31 offset:33792
    v_mfma_f32_32x32x16_bf16 v[68:83], v[128:131], v[108:111], v[68:83]
    ds_read_b64_tr_b16 v[120:121], v32 offset:32768
    ds_read_b64_tr_b16 v[122:123], v32 offset:33792
    v_mfma_f32_32x32x16_bf16 v[84:99], v[128:131], v[112:115], v[84:99]
    s_waitcnt lgkmcnt(0)
    v_mfma_f32_32x32x16_bf16 v[36:51], v[116:119], v[100:103], v[36:51]
    ds_read_b128 v[108:111], v22 offset:32768
    ds_read_b128 v[112:115], v22 offset:36864
    v_mfma_f32_32x32x16_bf16 v[52:67], v[116:119], v[104:107], v[52:67]
    ds_read_b64_tr_b16 v[124:125], v31 offset:36864
    ds_read_b64_tr_b16 v[126:127], v31 offset:37888
    v_mfma_f32_32x32x16_bf16 v[68:83], v[120:123], v[100:103], v[68:83]
    ds_read_b64_tr_b16 v[128:129], v32 offset:36864
    ds_read_b64_tr_b16 v[130:131], v32 offset:37888
    v_mfma_f32_32x32x16_bf16 v[84:99], v[120:123], v[104:107], v[84:99]
    s_waitcnt lgkmcnt(0)
    v_mfma_f32_32x32x16_bf16 v[36:51], v[124:127], v[108:111], v[36:51]
    ds_read_b128 v[100:103], v23 offset:32768
    ds_read_b128 v[104:107], v23 offset:36864
    v_mfma_f32_32x32x16_bf16 v[52:67], v[124:127], v[112:115], v[52:67]
    ds_read_b64_tr_b16 v[116:117], v31 offset:40960
    ds_read_b64_tr_b16 v[118:119], v31 offset:41984
    v_mfma_f32_32x32x16_bf16 v[68:83], v[128:131], v[108:111], v[68:83]
    ds_read_b64_tr_b16 v[120:121], v32 offset:40960
    ds_read_b64_tr_b16 v[122:123], v32 offset:41984
    v_mfma_f32_32x32x16_bf16 v[84:99], v[128:131], v[112:115], v[84:99]
    s_waitcnt lgkmcnt(0)
    v_mfma_f32_32x32x16_bf16 v[36:51], v[116:119], v[100:103], v[36:51]
    ds_read_b128 v[108:111], v24 offset:32768
    ds_read_b128 v[112:115], v24 offset:36864
    v_mfma_f32_32x32x16_bf16 v[52:67], v[116:119], v[104:107], v[52:67]
    ds_read_b64_tr_b16 v[124:125], v31 offset:45056
    ds_read_b64_tr_b16 v[126:127], v31 offset:46080
    v_mfma_f32_32x32x16_bf16 v[68:83], v[120:123], v[100:103], v[68:83]
    ds_read_b64_tr_b16 v[128:129], v32 offset:45056
    ds_read_b64_tr_b16 v[130:131], v32 offset:46080
    s_barrier
    v_mfma_f32_32x32x16_bf16 v[84:99], v[120:123], v[104:107], v[84:99]
    s_waitcnt lgkmcnt(0)
    v_mfma_f32_32x32x16_bf16 v[36:51], v[124:127], v[108:111], v[36:51]
    ds_read_b128 v[100:103], v25 offset:0
    ds_read_b128 v[104:107], v25 offset:4096
    v_mfma_f32_32x32x16_bf16 v[52:67], v[124:127], v[112:115], v[52:67]
    ds_read_b64_tr_b16 v[116:117], v33 offset:0
    ds_read_b64_tr_b16 v[118:119], v33 offset:1024
    v_mfma_f32_32x32x16_bf16 v[68:83], v[128:131], v[108:111], v[68:83]
    ds_read_b64_tr_b16 v[120:121], v34 offset:0
    ds_read_b64_tr_b16 v[122:123], v34 offset:1024
    v_mfma_f32_32x32x16_bf16 v[84:99], v[128:131], v[112:115], v[84:99]
    s_waitcnt lgkmcnt(0)
    v_mfma_f32_32x32x16_bf16 v[36:51], v[116:119], v[100:103], v[36:51]
    ds_read_b128 v[108:111], v26 offset:0
    ds_read_b128 v[112:115], v26 offset:4096
    v_mfma_f32_32x32x16_bf16 v[52:67], v[116:119], v[104:107], v[52:67]
    ds_read_b64_tr_b16 v[124:125], v33 offset:4096
    ds_read_b64_tr_b16 v[126:127], v33 offset:5120
    v_mfma_f32_32x32x16_bf16 v[68:83], v[120:123], v[100:103], v[68:83]
    ds_read_b64_tr_b16 v[128:129], v34 offset:4096
    ds_read_b64_tr_b16 v[130:131], v34 offset:5120
    v_mfma_f32_32x32x16_bf16 v[84:99], v[120:123], v[104:107], v[84:99]
    s_waitcnt lgkmcnt(0)
    v_mfma_f32_32x32x16_bf16 v[36:51], v[124:127], v[108:111], v[36:51]
    ds_read_b128 v[100:103], v27 offset:0
    ds_read_b128 v[104:107], v27 offset:4096
    v_mfma_f32_32x32x16_bf16 v[52:67], v[124:127], v[112:115], v[52:67]
    ds_read_b64_tr_b16 v[116:117], v33 offset:8192
    ds_read_b64_tr_b16 v[118:119], v33 offset:9216
    v_mfma_f32_32x32x16_bf16 v[68:83], v[128:131], v[108:111], v[68:83]
    ds_read_b64_tr_b16 v[120:121], v34 offset:8192
    ds_read_b64_tr_b16 v[122:123], v34 offset:9216
    v_mfma_f32_32x32x16_bf16 v[84:99], v[128:131], v[112:115], v[84:99]
    s_waitcnt lgkmcnt(0)
    v_mfma_f32_32x32x16_bf16 v[36:51], v[116:119], v[100:103], v[36:51]
    ds_read_b128 v[108:111], v28 offset:0
    ds_read_b128 v[112:115], v28 offset:4096
    v_mfma_f32_32x32x16_bf16 v[52:67], v[116:119], v[104:107], v[52:67]
    ds_read_b64_tr_b16 v[124:125], v33 offset:12288
    ds_read_b64_tr_b16 v[126:127], v33 offset:13312
    v_mfma_f32_32x32x16_bf16 v[68:83], v[120:123], v[100:103], v[68:83]
    ds_read_b64_tr_b16 v[128:129], v34 offset:12288
    ds_read_b64_tr_b16 v[130:131], v34 offset:13312
    v_mfma_f32_32x32x16_bf16 v[84:99], v[120:123], v[104:107], v[84:99]
    s_waitcnt lgkmcnt(0)
    v_mfma_f32_32x32x16_bf16 v[36:51], v[124:127], v[108:111], v[36:51]
    v_mfma_f32_32x32x16_bf16 v[52:67], v[124:127], v[112:115], v[52:67]
    v_mfma_f32_32x32x16_bf16 v[68:83], v[128:131], v[108:111], v[68:83]
    v_mfma_f32_32x32x16_bf16 v[84:99], v[128:131], v[112:115], v[84:99]
    s_cmp_ge_u32 s30, 5
    s_nop 6
    s_cbranch_scc1 concat_heads__mha_block__spectral_fnet__prompt_kernel_nosc
    v_pk_mul_f32 v[36:37], v[36:37], s[42:43] op_sel_hi:[1,0]
    v_pk_mul_f32 v[38:39], v[38:39], s[42:43] op_sel_hi:[1,0]
    v_pk_mul_f32 v[40:41], v[40:41], s[42:43] op_sel_hi:[1,0]
    v_pk_mul_f32 v[42:43], v[42:43], s[42:43] op_sel_hi:[1,0]
    v_pk_mul_f32 v[44:45], v[44:45], s[42:43] op_sel_hi:[1,0]
    v_pk_mul_f32 v[46:47], v[46:47], s[42:43] op_sel_hi:[1,0]
    v_pk_mul_f32 v[48:49], v[48:49], s[42:43] op_sel_hi:[1,0]
    v_pk_mul_f32 v[50:51], v[50:51], s[42:43] op_sel_hi:[1,0]
    v_cvt_pk_bf16_f32 v36, v36, v37
    v_cvt_pk_bf16_f32 v37, v38, v39
    v_cvt_pk_bf16_f32 v38, v40, v41
    v_cvt_pk_bf16_f32 v39, v42, v43
    buffer_store_dwordx4 v[36:39], v9, s[12:15], s20 offen sc1
    v_cvt_pk_bf16_f32 v40, v44, v45
    v_cvt_pk_bf16_f32 v41, v46, v47
    v_cvt_pk_bf16_f32 v42, v48, v49
    v_cvt_pk_bf16_f32 v43, v50, v51
    buffer_store_dwordx4 v[40:43], v10, s[12:15], s20 offen sc1
    v_pk_mul_f32 v[52:53], v[52:53], s[42:43] op_sel_hi:[1,0]
    v_pk_mul_f32 v[54:55], v[54:55], s[42:43] op_sel_hi:[1,0]
    v_pk_mul_f32 v[56:57], v[56:57], s[42:43] op_sel_hi:[1,0]
    v_pk_mul_f32 v[58:59], v[58:59], s[42:43] op_sel_hi:[1,0]
    v_pk_mul_f32 v[60:61], v[60:61], s[42:43] op_sel_hi:[1,0]
    v_pk_mul_f32 v[62:63], v[62:63], s[42:43] op_sel_hi:[1,0]
    v_pk_mul_f32 v[64:65], v[64:65], s[42:43] op_sel_hi:[1,0]
    v_pk_mul_f32 v[66:67], v[66:67], s[42:43] op_sel_hi:[1,0]
    v_cvt_pk_bf16_f32 v52, v52, v53
    v_cvt_pk_bf16_f32 v53, v54, v55
    v_cvt_pk_bf16_f32 v54, v56, v57
    v_cvt_pk_bf16_f32 v55, v58, v59
    buffer_store_dwordx4 v[52:55], v9, s[12:15], s21 offen sc1
    v_cvt_pk_bf16_f32 v56, v60, v61
    v_cvt_pk_bf16_f32 v57, v62, v63
    v_cvt_pk_bf16_f32 v58, v64, v65
    v_cvt_pk_bf16_f32 v59, v66, v67
    buffer_store_dwordx4 v[56:59], v10, s[12:15], s21 offen sc1
    v_pk_mul_f32 v[68:69], v[68:69], s[42:43] op_sel_hi:[1,0]
    v_pk_mul_f32 v[70:71], v[70:71], s[42:43] op_sel_hi:[1,0]
    v_pk_mul_f32 v[72:73], v[72:73], s[42:43] op_sel_hi:[1,0]
    v_pk_mul_f32 v[74:75], v[74:75], s[42:43] op_sel_hi:[1,0]
    v_pk_mul_f32 v[76:77], v[76:77], s[42:43] op_sel_hi:[1,0]
    v_pk_mul_f32 v[78:79], v[78:79], s[42:43] op_sel_hi:[1,0]
    v_pk_mul_f32 v[80:81], v[80:81], s[42:43] op_sel_hi:[1,0]
    v_pk_mul_f32 v[82:83], v[82:83], s[42:43] op_sel_hi:[1,0]
    v_cvt_pk_bf16_f32 v68, v68, v69
    v_cvt_pk_bf16_f32 v69, v70, v71
    v_cvt_pk_bf16_f32 v70, v72, v73
    v_cvt_pk_bf16_f32 v71, v74, v75
    buffer_store_dwordx4 v[68:71], v11, s[12:15], s20 offen sc1
    v_cvt_pk_bf16_f32 v72, v76, v77
    v_cvt_pk_bf16_f32 v73, v78, v79
    v_cvt_pk_bf16_f32 v74, v80, v81
    v_cvt_pk_bf16_f32 v75, v82, v83
    buffer_store_dwordx4 v[72:75], v12, s[12:15], s20 offen sc1
    v_pk_mul_f32 v[84:85], v[84:85], s[42:43] op_sel_hi:[1,0]
    v_pk_mul_f32 v[86:87], v[86:87], s[42:43] op_sel_hi:[1,0]
    v_pk_mul_f32 v[88:89], v[88:89], s[42:43] op_sel_hi:[1,0]
    v_pk_mul_f32 v[90:91], v[90:91], s[42:43] op_sel_hi:[1,0]
    v_pk_mul_f32 v[92:93], v[92:93], s[42:43] op_sel_hi:[1,0]
    v_pk_mul_f32 v[94:95], v[94:95], s[42:43] op_sel_hi:[1,0]
    v_pk_mul_f32 v[96:97], v[96:97], s[42:43] op_sel_hi:[1,0]
    v_pk_mul_f32 v[98:99], v[98:99], s[42:43] op_sel_hi:[1,0]
    v_cvt_pk_bf16_f32 v84, v84, v85
    v_cvt_pk_bf16_f32 v85, v86, v87
    v_cvt_pk_bf16_f32 v86, v88, v89
    v_cvt_pk_bf16_f32 v87, v90, v91
    buffer_store_dwordx4 v[84:87], v11, s[12:15], s21 offen sc1
    v_cvt_pk_bf16_f32 v88, v92, v93
    v_cvt_pk_bf16_f32 v89, v94, v95
    v_cvt_pk_bf16_f32 v90, v96, v97
    v_cvt_pk_bf16_f32 v91, v98, v99
    buffer_store_dwordx4 v[88:91], v12, s[12:15], s21 offen sc1
    s_branch concat_heads__mha_block__spectral_fnet__prompt_kernel_s1
concat_heads__mha_block__spectral_fnet__prompt_kernel_nosc:
    v_cvt_pk_bf16_f32 v36, v36, v37
    v_cvt_pk_bf16_f32 v37, v38, v39
    v_cvt_pk_bf16_f32 v38, v40, v41
    v_cvt_pk_bf16_f32 v39, v42, v43
    buffer_store_dwordx4 v[36:39], v9, s[12:15], s20 offen sc1
    v_cvt_pk_bf16_f32 v40, v44, v45
    v_cvt_pk_bf16_f32 v41, v46, v47
    v_cvt_pk_bf16_f32 v42, v48, v49
    v_cvt_pk_bf16_f32 v43, v50, v51
    buffer_store_dwordx4 v[40:43], v10, s[12:15], s20 offen sc1
    v_cvt_pk_bf16_f32 v52, v52, v53
    v_cvt_pk_bf16_f32 v53, v54, v55
    v_cvt_pk_bf16_f32 v54, v56, v57
    v_cvt_pk_bf16_f32 v55, v58, v59
    buffer_store_dwordx4 v[52:55], v9, s[12:15], s21 offen sc1
    v_cvt_pk_bf16_f32 v56, v60, v61
    v_cvt_pk_bf16_f32 v57, v62, v63
    v_cvt_pk_bf16_f32 v58, v64, v65
    v_cvt_pk_bf16_f32 v59, v66, v67
    buffer_store_dwordx4 v[56:59], v10, s[12:15], s21 offen sc1
    v_cvt_pk_bf16_f32 v68, v68, v69
    v_cvt_pk_bf16_f32 v69, v70, v71
    v_cvt_pk_bf16_f32 v70, v72, v73
    v_cvt_pk_bf16_f32 v71, v74, v75
    buffer_store_dwordx4 v[68:71], v11, s[12:15], s20 offen sc1
    v_cvt_pk_bf16_f32 v72, v76, v77
    v_cvt_pk_bf16_f32 v73, v78, v79
    v_cvt_pk_bf16_f32 v74, v80, v81
    v_cvt_pk_bf16_f32 v75, v82, v83
    buffer_store_dwordx4 v[72:75], v12, s[12:15], s20 offen sc1
    v_cvt_pk_bf16_f32 v84, v84, v85
    v_cvt_pk_bf16_f32 v85, v86, v87
    v_cvt_pk_bf16_f32 v86, v88, v89
    v_cvt_pk_bf16_f32 v87, v90, v91
    buffer_store_dwordx4 v[84:87], v11, s[12:15], s21 offen sc1
    v_cvt_pk_bf16_f32 v88, v92, v93
    v_cvt_pk_bf16_f32 v89, v94, v95
    v_cvt_pk_bf16_f32 v90, v96, v97
    v_cvt_pk_bf16_f32 v91, v98, v99
    buffer_store_dwordx4 v[88:91], v12, s[12:15], s21 offen sc1
    s_branch concat_heads__mha_block__spectral_fnet__prompt_kernel_s1
concat_heads__mha_block__spectral_fnet__prompt_kernel_vset:
    s_mul_i32 s25, s25, 82048
    s_add_u32 s20, s25, 0x30a000
    s_sub_u32 s26, s30, 10
    s_lshl_b32 s26, s26, 11
    s_lshl_b32 s27, s23, 10
    s_add_u32 s26, s26, s27
    s_add_u32 s20, s20, s26
    s_add_u32 s21, s20, 82048
    v_mul_u32_u24 v2, 10240, v2
    v_lshl_add_u32 v9, v1, 4, v2
    v_add_u32 v10, 20480, v9
    s_setprio 1
    s_barrier
    ds_read_b128 v[100:103], v17 offset:0
    ds_read_b128 v[104:107], v17 offset:4096
    ds_read_b64_tr_b16 v[116:117], v29 offset:0
    ds_read_b64_tr_b16 v[118:119], v29 offset:1024
    ds_read_b64_tr_b16 v[120:121], v30 offset:0
    ds_read_b64_tr_b16 v[122:123], v30 offset:1024
    s_waitcnt lgkmcnt(0)
    v_mfma_f32_32x32x16_bf16 v[36:51], v[100:103], v[116:119], 0
    ds_read_b128 v[108:111], v18 offset:0
    ds_read_b128 v[112:115], v18 offset:4096
    v_mfma_f32_32x32x16_bf16 v[52:67], v[104:107], v[116:119], 0
    ds_read_b64_tr_b16 v[124:125], v29 offset:4096
    ds_read_b64_tr_b16 v[126:127], v29 offset:5120
    v_mfma_f32_32x32x16_bf16 v[68:83], v[100:103], v[120:123], 0
    ds_read_b64_tr_b16 v[128:129], v30 offset:4096
    ds_read_b64_tr_b16 v[130:131], v30 offset:5120
    v_mfma_f32_32x32x16_bf16 v[84:99], v[104:107], v[120:123], 0
    s_waitcnt lgkmcnt(0)
    v_mfma_f32_32x32x16_bf16 v[36:51], v[108:111], v[124:127], v[36:51]
    ds_read_b128 v[100:103], v19 offset:0
    ds_read_b128 v[104:107], v19 offset:4096
    v_mfma_f32_32x32x16_bf16 v[52:67], v[112:115], v[124:127], v[52:67]
    ds_read_b64_tr_b16 v[116:117], v29 offset:8192
    ds_read_b64_tr_b16 v[118:119], v29 offset:9216
    v_mfma_f32_32x32x16_bf16 v[68:83], v[108:111], v[128:131], v[68:83]
    ds_read_b64_tr_b16 v[120:121], v30 offset:8192
    ds_read_b64_tr_b16 v[122:123], v30 offset:9216
    v_mfma_f32_32x32x16_bf16 v[84:99], v[112:115], v[128:131], v[84:99]
    s_waitcnt lgkmcnt(0)
    v_mfma_f32_32x32x16_bf16 v[36:51], v[100:103], v[116:119], v[36:51]
    ds_read_b128 v[108:111], v20 offset:0
    ds_read_b128 v[112:115], v20 offset:4096
    v_mfma_f32_32x32x16_bf16 v[52:67], v[104:107], v[116:119], v[52:67]
    ds_read_b64_tr_b16 v[124:125], v29 offset:12288
    ds_read_b64_tr_b16 v[126:127], v29 offset:13312
    v_mfma_f32_32x32x16_bf16 v[68:83], v[100:103], v[120:123], v[68:83]
    ds_read_b64_tr_b16 v[128:129], v30 offset:12288
    ds_read_b64_tr_b16 v[130:131], v30 offset:13312
    s_barrier
    v_mfma_f32_32x32x16_bf16 v[84:99], v[104:107], v[120:123], v[84:99]
    s_waitcnt lgkmcnt(0)
    v_mfma_f32_32x32x16_bf16 v[36:51], v[108:111], v[124:127], v[36:51]
    ds_read_b128 v[100:103], v17 offset:32768
    ds_read_b128 v[104:107], v17 offset:36864
    v_mfma_f32_32x32x16_bf16 v[52:67], v[112:115], v[124:127], v[52:67]
    ds_read_b64_tr_b16 v[116:117], v29 offset:32768
    ds_read_b64_tr_b16 v[118:119], v29 offset:33792
    v_mfma_f32_32x32x16_bf16 v[68:83], v[108:111], v[128:131], v[68:83]
    ds_read_b64_tr_b16 v[120:121], v30 offset:32768
    ds_read_b64_tr_b16 v[122:123], v30 offset:33792
    v_mfma_f32_32x32x16_bf16 v[84:99], v[112:115], v[128:131], v[84:99]
    s_waitcnt lgkmcnt(0)
    v_mfma_f32_32x32x16_bf16 v[36:51], v[100:103], v[116:119], v[36:51]
    ds_read_b128 v[108:111], v18 offset:32768
    ds_read_b128 v[112:115], v18 offset:36864
    v_mfma_f32_32x32x16_bf16 v[52:67], v[104:107], v[116:119], v[52:67]
    ds_read_b64_tr_b16 v[124:125], v29 offset:36864
    ds_read_b64_tr_b16 v[126:127], v29 offset:37888
    v_mfma_f32_32x32x16_bf16 v[68:83], v[100:103], v[120:123], v[68:83]
    ds_read_b64_tr_b16 v[128:129], v30 offset:36864
    ds_read_b64_tr_b16 v[130:131], v30 offset:37888
    v_mfma_f32_32x32x16_bf16 v[84:99], v[104:107], v[120:123], v[84:99]
    s_waitcnt lgkmcnt(0)
    v_mfma_f32_32x32x16_bf16 v[36:51], v[108:111], v[124:127], v[36:51]
    ds_read_b128 v[100:103], v19 offset:32768
    ds_read_b128 v[104:107], v19 offset:36864
    v_mfma_f32_32x32x16_bf16 v[52:67], v[112:115], v[124:127], v[52:67]
    ds_read_b64_tr_b16 v[116:117], v29 offset:40960
    ds_read_b64_tr_b16 v[118:119], v29 offset:41984
    v_mfma_f32_32x32x16_bf16 v[68:83], v[108:111], v[128:131], v[68:83]
    ds_read_b64_tr_b16 v[120:121], v30 offset:40960
    ds_read_b64_tr_b16 v[122:123], v30 offset:41984
    v_mfma_f32_32x32x16_bf16 v[84:99], v[112:115], v[128:131], v[84:99]
    s_waitcnt lgkmcnt(0)
    v_mfma_f32_32x32x16_bf16 v[36:51], v[100:103], v[116:119], v[36:51]
    ds_read_b128 v[108:111], v20 offset:32768
    ds_read_b128 v[112:115], v20 offset:36864
    v_mfma_f32_32x32x16_bf16 v[52:67], v[104:107], v[116:119], v[52:67]
    ds_read_b64_tr_b16 v[124:125], v29 offset:45056
    ds_read_b64_tr_b16 v[126:127], v29 offset:46080
    v_mfma_f32_32x32x16_bf16 v[68:83], v[100:103], v[120:123], v[68:83]
    ds_read_b64_tr_b16 v[128:129], v30 offset:45056
    ds_read_b64_tr_b16 v[130:131], v30 offset:46080
    s_barrier
    v_mfma_f32_32x32x16_bf16 v[84:99], v[104:107], v[120:123], v[84:99]
    s_waitcnt lgkmcnt(0)
    v_mfma_f32_32x32x16_bf16 v[36:51], v[108:111], v[124:127], v[36:51]
    ds_read_b128 v[100:103], v21 offset:0
    ds_read_b128 v[104:107], v21 offset:4096
    v_mfma_f32_32x32x16_bf16 v[52:67], v[112:115], v[124:127], v[52:67]
    ds_read_b64_tr_b16 v[116:117], v31 offset:0
    ds_read_b64_tr_b16 v[118:119], v31 offset:1024
    v_mfma_f32_32x32x16_bf16 v[68:83], v[108:111], v[128:131], v[68:83]
    ds_read_b64_tr_b16 v[120:121], v32 offset:0
    ds_read_b64_tr_b16 v[122:123], v32 offset:1024
    v_mfma_f32_32x32x16_bf16 v[84:99], v[112:115], v[128:131], v[84:99]
    s_waitcnt lgkmcnt(0)
    v_mfma_f32_32x32x16_bf16 v[36:51], v[100:103], v[116:119], v[36:51]
    ds_read_b128 v[108:111], v22 offset:0
    ds_read_b128 v[112:115], v22 offset:4096
    v_mfma_f32_32x32x16_bf16 v[52:67], v[104:107], v[116:119], v[52:67]
    ds_read_b64_tr_b16 v[124:125], v31 offset:4096
    ds_read_b64_tr_b16 v[126:127], v31 offset:5120
    v_mfma_f32_32x32x16_bf16 v[68:83], v[100:103], v[120:123], v[68:83]
    ds_read_b64_tr_b16 v[128:129], v32 offset:4096
    ds_read_b64_tr_b16 v[130:131], v32 offset:5120
    v_mfma_f32_32x32x16_bf16 v[84:99], v[104:107], v[120:123], v[84:99]
    s_waitcnt lgkmcnt(0)
    v_mfma_f32_32x32x16_bf16 v[36:51], v[108:111], v[124:127], v[36:51]
    ds_read_b128 v[100:103], v23 offset:0
    ds_read_b128 v[104:107], v23 offset:4096
    v_mfma_f32_32x32x16_bf16 v[52:67], v[112:115], v[124:127], v[52:67]
    ds_read_b64_tr_b16 v[116:117], v31 offset:8192
    ds_read_b64_tr_b16 v[118:119], v31 offset:9216
    v_mfma_f32_32x32x16_bf16 v[68:83], v[108:111], v[128:131], v[68:83]
    ds_read_b64_tr_b16 v[120:121], v32 offset:8192
    ds_read_b64_tr_b16 v[122:123], v32 offset:9216
    v_mfma_f32_32x32x16_bf16 v[84:99], v[112:115], v[128:131], v[84:99]
    s_waitcnt lgkmcnt(0)
    v_mfma_f32_32x32x16_bf16 v[36:51], v[100:103], v[116:119], v[36:51]
    ds_read_b128 v[108:111], v24 offset:0
    ds_read_b128 v[112:115], v24 offset:4096
    v_mfma_f32_32x32x16_bf16 v[52:67], v[104:107], v[116:119], v[52:67]
    ds_read_b64_tr_b16 v[124:125], v31 offset:12288
    ds_read_b64_tr_b16 v[126:127], v31 offset:13312
    v_mfma_f32_32x32x16_bf16 v[68:83], v[100:103], v[120:123], v[68:83]
    ds_read_b64_tr_b16 v[128:129], v32 offset:12288
    ds_read_b64_tr_b16 v[130:131], v32 offset:13312
    s_barrier
    v_mfma_f32_32x32x16_bf16 v[84:99], v[104:107], v[120:123], v[84:99]
    s_waitcnt lgkmcnt(0)
    v_mfma_f32_32x32x16_bf16 v[36:51], v[108:111], v[124:127], v[36:51]
    ds_read_b128 v[100:103], v21 offset:32768
    ds_read_b128 v[104:107], v21 offset:36864
    v_mfma_f32_32x32x16_bf16 v[52:67], v[112:115], v[124:127], v[52:67]
    ds_read_b64_tr_b16 v[116:117], v31 offset:32768
    ds_read_b64_tr_b16 v[118:119], v31 offset:33792
    v_mfma_f32_32x32x16_bf16 v[68:83], v[108:111], v[128:131], v[68:83]
    ds_read_b64_tr_b16 v[120:121], v32 offset:32768
    ds_read_b64_tr_b16 v[122:123], v32 offset:33792
    v_mfma_f32_32x32x16_bf16 v[84:99], v[112:115], v[128:131], v[84:99]
    s_waitcnt lgkmcnt(0)
    v_mfma_f32_32x32x16_bf16 v[36:51], v[100:103], v[116:119], v[36:51]
    ds_read_b128 v[108:111], v22 offset:32768
    ds_read_b128 v[112:115], v22 offset:36864
    v_mfma_f32_32x32x16_bf16 v[52:67], v[104:107], v[116:119], v[52:67]
    ds_read_b64_tr_b16 v[124:125], v31 offset:36864
    ds_read_b64_tr_b16 v[126:127], v31 offset:37888
    v_mfma_f32_32x32x16_bf16 v[68:83], v[100:103], v[120:123], v[68:83]
    ds_read_b64_tr_b16 v[128:129], v32 offset:36864
    ds_read_b64_tr_b16 v[130:131], v32 offset:37888
    v_mfma_f32_32x32x16_bf16 v[84:99], v[104:107], v[120:123], v[84:99]
    s_waitcnt lgkmcnt(0)
    v_mfma_f32_32x32x16_bf16 v[36:51], v[108:111], v[124:127], v[36:51]
    ds_read_b128 v[100:103], v23 offset:32768
    ds_read_b128 v[104:107], v23 offset:36864
    v_mfma_f32_32x32x16_bf16 v[52:67], v[112:115], v[124:127], v[52:67]
    ds_read_b64_tr_b16 v[116:117], v31 offset:40960
    ds_read_b64_tr_b16 v[118:119], v31 offset:41984
    v_mfma_f32_32x32x16_bf16 v[68:83], v[108:111], v[128:131], v[68:83]
    ds_read_b64_tr_b16 v[120:121], v32 offset:40960
    ds_read_b64_tr_b16 v[122:123], v32 offset:41984
    v_mfma_f32_32x32x16_bf16 v[84:99], v[112:115], v[128:131], v[84:99]
    s_waitcnt lgkmcnt(0)
    v_mfma_f32_32x32x16_bf16 v[36:51], v[100:103], v[116:119], v[36:51]
    ds_read_b128 v[108:111], v24 offset:32768
    ds_read_b128 v[112:115], v24 offset:36864
    v_mfma_f32_32x32x16_bf16 v[52:67], v[104:107], v[116:119], v[52:67]
    ds_read_b64_tr_b16 v[124:125], v31 offset:45056
    ds_read_b64_tr_b16 v[126:127], v31 offset:46080
    v_mfma_f32_32x32x16_bf16 v[68:83], v[100:103], v[120:123], v[68:83]
    ds_read_b64_tr_b16 v[128:129], v32 offset:45056
    ds_read_b64_tr_b16 v[130:131], v32 offset:46080
    s_barrier
    v_mfma_f32_32x32x16_bf16 v[84:99], v[104:107], v[120:123], v[84:99]
    s_waitcnt lgkmcnt(0)
    v_mfma_f32_32x32x16_bf16 v[36:51], v[108:111], v[124:127], v[36:51]
    ds_read_b128 v[100:103], v25 offset:0
    ds_read_b128 v[104:107], v25 offset:4096
    v_mfma_f32_32x32x16_bf16 v[52:67], v[112:115], v[124:127], v[52:67]
    ds_read_b64_tr_b16 v[116:117], v33 offset:0
    ds_read_b64_tr_b16 v[118:119], v33 offset:1024
    v_mfma_f32_32x32x16_bf16 v[68:83], v[108:111], v[128:131], v[68:83]
    ds_read_b64_tr_b16 v[120:121], v34 offset:0
    ds_read_b64_tr_b16 v[122:123], v34 offset:1024
    v_mfma_f32_32x32x16_bf16 v[84:99], v[112:115], v[128:131], v[84:99]
    s_waitcnt lgkmcnt(0)
    v_mfma_f32_32x32x16_bf16 v[36:51], v[100:103], v[116:119], v[36:51]
    ds_read_b128 v[108:111], v26 offset:0
    ds_read_b128 v[112:115], v26 offset:4096
    v_mfma_f32_32x32x16_bf16 v[52:67], v[104:107], v[116:119], v[52:67]
    ds_read_b64_tr_b16 v[124:125], v33 offset:4096
    ds_read_b64_tr_b16 v[126:127], v33 offset:5120
    v_mfma_f32_32x32x16_bf16 v[68:83], v[100:103], v[120:123], v[68:83]
    ds_read_b64_tr_b16 v[128:129], v34 offset:4096
    ds_read_b64_tr_b16 v[130:131], v34 offset:5120
    v_mfma_f32_32x32x16_bf16 v[84:99], v[104:107], v[120:123], v[84:99]
    s_waitcnt lgkmcnt(0)
    v_mfma_f32_32x32x16_bf16 v[36:51], v[108:111], v[124:127], v[36:51]
    ds_read_b128 v[100:103], v27 offset:0
    ds_read_b128 v[104:107], v27 offset:4096
    v_mfma_f32_32x32x16_bf16 v[52:67], v[112:115], v[124:127], v[52:67]
    ds_read_b64_tr_b16 v[116:117], v33 offset:8192
    ds_read_b64_tr_b16 v[118:119], v33 offset:9216
    v_mfma_f32_32x32x16_bf16 v[68:83], v[108:111], v[128:131], v[68:83]
    ds_read_b64_tr_b16 v[120:121], v34 offset:8192
    ds_read_b64_tr_b16 v[122:123], v34 offset:9216
    v_mfma_f32_32x32x16_bf16 v[84:99], v[112:115], v[128:131], v[84:99]
    s_waitcnt lgkmcnt(0)
    v_mfma_f32_32x32x16_bf16 v[36:51], v[100:103], v[116:119], v[36:51]
    ds_read_b128 v[108:111], v28 offset:0
    ds_read_b128 v[112:115], v28 offset:4096
    v_mfma_f32_32x32x16_bf16 v[52:67], v[104:107], v[116:119], v[52:67]
    ds_read_b64_tr_b16 v[124:125], v33 offset:12288
    ds_read_b64_tr_b16 v[126:127], v33 offset:13312
    v_mfma_f32_32x32x16_bf16 v[68:83], v[100:103], v[120:123], v[68:83]
    ds_read_b64_tr_b16 v[128:129], v34 offset:12288
    ds_read_b64_tr_b16 v[130:131], v34 offset:13312
    s_barrier
    v_mfma_f32_32x32x16_bf16 v[84:99], v[104:107], v[120:123], v[84:99]
    s_waitcnt lgkmcnt(0)
    v_mfma_f32_32x32x16_bf16 v[36:51], v[108:111], v[124:127], v[36:51]
    ds_read_b128 v[100:103], v17 offset:0
    ds_read_b128 v[104:107], v17 offset:4096
    v_mfma_f32_32x32x16_bf16 v[52:67], v[112:115], v[124:127], v[52:67]
    ds_read_b64_tr_b16 v[116:117], v29 offset:0
    ds_read_b64_tr_b16 v[118:119], v29 offset:1024
    v_mfma_f32_32x32x16_bf16 v[68:83], v[108:111], v[128:131], v[68:83]
    ds_read_b64_tr_b16 v[120:121], v30 offset:0
    ds_read_b64_tr_b16 v[122:123], v30 offset:1024
    v_mfma_f32_32x32x16_bf16 v[84:99], v[112:115], v[128:131], v[84:99]
    s_waitcnt lgkmcnt(0)
    v_mfma_f32_32x32x16_bf16 v[36:51], v[100:103], v[116:119], v[36:51]
    ds_read_b128 v[108:111], v18 offset:0
    ds_read_b128 v[112:115], v18 offset:4096
    v_mfma_f32_32x32x16_bf16 v[52:67], v[104:107], v[116:119], v[52:67]
    ds_read_b64_tr_b16 v[124:125], v29 offset:4096
    ds_read_b64_tr_b16 v[126:127], v29 offset:5120
    v_mfma_f32_32x32x16_bf16 v[68:83], v[100:103], v[120:123], v[68:83]
    ds_read_b64_tr_b16 v[128:129], v30 offset:4096
    ds_read_b64_tr_b16 v[130:131], v30 offset:5120
    v_mfma_f32_32x32x16_bf16 v[84:99], v[104:107], v[120:123], v[84:99]
    s_waitcnt lgkmcnt(0)
    v_mfma_f32_32x32x16_bf16 v[36:51], v[108:111], v[124:127], v[36:51]
    ds_read_b128 v[100:103], v19 offset:0
    ds_read_b128 v[104:107], v19 offset:4096
    v_mfma_f32_32x32x16_bf16 v[52:67], v[112:115], v[124:127], v[52:67]
    ds_read_b64_tr_b16 v[116:117], v29 offset:8192
    ds_read_b64_tr_b16 v[118:119], v29 offset:9216
    v_mfma_f32_32x32x16_bf16 v[68:83], v[108:111], v[128:131], v[68:83]
    ds_read_b64_tr_b16 v[120:121], v30 offset:8192
    ds_read_b64_tr_b16 v[122:123], v30 offset:9216
    v_mfma_f32_32x32x16_bf16 v[84:99], v[112:115], v[128:131], v[84:99]
    s_waitcnt lgkmcnt(0)
    v_mfma_f32_32x32x16_bf16 v[36:51], v[100:103], v[116:119], v[36:51]
    ds_read_b128 v[108:111], v20 offset:0
    ds_read_b128 v[112:115], v20 offset:4096
    v_mfma_f32_32x32x16_bf16 v[52:67], v[104:107], v[116:119], v[52:67]
    ds_read_b64_tr_b16 v[124:125], v29 offset:12288
    ds_read_b64_tr_b16 v[126:127], v29 offset:13312
    v_mfma_f32_32x32x16_bf16 v[68:83], v[100:103], v[120:123], v[68:83]
    ds_read_b64_tr_b16 v[128:129], v30 offset:12288
    ds_read_b64_tr_b16 v[130:131], v30 offset:13312
    s_barrier
    v_mfma_f32_32x32x16_bf16 v[84:99], v[104:107], v[120:123], v[84:99]
    s_waitcnt lgkmcnt(0)
    v_mfma_f32_32x32x16_bf16 v[36:51], v[108:111], v[124:127], v[36:51]
    ds_read_b128 v[100:103], v17 offset:32768
    ds_read_b128 v[104:107], v17 offset:36864
    v_mfma_f32_32x32x16_bf16 v[52:67], v[112:115], v[124:127], v[52:67]
    ds_read_b64_tr_b16 v[116:117], v29 offset:32768
    ds_read_b64_tr_b16 v[118:119], v29 offset:33792
    v_mfma_f32_32x32x16_bf16 v[68:83], v[108:111], v[128:131], v[68:83]
    ds_read_b64_tr_b16 v[120:121], v30 offset:32768
    ds_read_b64_tr_b16 v[122:123], v30 offset:33792
    v_mfma_f32_32x32x16_bf16 v[84:99], v[112:115], v[128:131], v[84:99]
    s_waitcnt lgkmcnt(0)
    v_mfma_f32_32x32x16_bf16 v[36:51], v[100:103], v[116:119], v[36:51]
    ds_read_b128 v[108:111], v18 offset:32768
    ds_read_b128 v[112:115], v18 offset:36864
    v_mfma_f32_32x32x16_bf16 v[52:67], v[104:107], v[116:119], v[52:67]
    ds_read_b64_tr_b16 v[124:125], v29 offset:36864
    ds_read_b64_tr_b16 v[126:127], v29 offset:37888
    v_mfma_f32_32x32x16_bf16 v[68:83], v[100:103], v[120:123], v[68:83]
    ds_read_b64_tr_b16 v[128:129], v30 offset:36864
    ds_read_b64_tr_b16 v[130:131], v30 offset:37888
    v_mfma_f32_32x32x16_bf16 v[84:99], v[104:107], v[120:123], v[84:99]
    s_waitcnt lgkmcnt(0)
    v_mfma_f32_32x32x16_bf16 v[36:51], v[108:111], v[124:127], v[36:51]
    ds_read_b128 v[100:103], v19 offset:32768
    ds_read_b128 v[104:107], v19 offset:36864
    v_mfma_f32_32x32x16_bf16 v[52:67], v[112:115], v[124:127], v[52:67]
    ds_read_b64_tr_b16 v[116:117], v29 offset:40960
    ds_read_b64_tr_b16 v[118:119], v29 offset:41984
    v_mfma_f32_32x32x16_bf16 v[68:83], v[108:111], v[128:131], v[68:83]
    ds_read_b64_tr_b16 v[120:121], v30 offset:40960
    ds_read_b64_tr_b16 v[122:123], v30 offset:41984
    v_mfma_f32_32x32x16_bf16 v[84:99], v[112:115], v[128:131], v[84:99]
    s_waitcnt lgkmcnt(0)
    v_mfma_f32_32x32x16_bf16 v[36:51], v[100:103], v[116:119], v[36:51]
    ds_read_b128 v[108:111], v20 offset:32768
    ds_read_b128 v[112:115], v20 offset:36864
    v_mfma_f32_32x32x16_bf16 v[52:67], v[104:107], v[116:119], v[52:67]
    ds_read_b64_tr_b16 v[124:125], v29 offset:45056
    ds_read_b64_tr_b16 v[126:127], v29 offset:46080
    v_mfma_f32_32x32x16_bf16 v[68:83], v[100:103], v[120:123], v[68:83]
    ds_read_b64_tr_b16 v[128:129], v30 offset:45056
    ds_read_b64_tr_b16 v[130:131], v30 offset:46080
    s_barrier
    v_mfma_f32_32x32x16_bf16 v[84:99], v[104:107], v[120:123], v[84:99]
    s_waitcnt lgkmcnt(0)
    v_mfma_f32_32x32x16_bf16 v[36:51], v[108:111], v[124:127], v[36:51]
    ds_read_b128 v[100:103], v21 offset:0
    ds_read_b128 v[104:107], v21 offset:4096
    v_mfma_f32_32x32x16_bf16 v[52:67], v[112:115], v[124:127], v[52:67]
    ds_read_b64_tr_b16 v[116:117], v31 offset:0
    ds_read_b64_tr_b16 v[118:119], v31 offset:1024
    v_mfma_f32_32x32x16_bf16 v[68:83], v[108:111], v[128:131], v[68:83]
    ds_read_b64_tr_b16 v[120:121], v32 offset:0
    ds_read_b64_tr_b16 v[122:123], v32 offset:1024
    v_mfma_f32_32x32x16_bf16 v[84:99], v[112:115], v[128:131], v[84:99]
    s_waitcnt lgkmcnt(0)
    v_mfma_f32_32x32x16_bf16 v[36:51], v[100:103], v[116:119], v[36:51]
    ds_read_b128 v[108:111], v22 offset:0
    ds_read_b128 v[112:115], v22 offset:4096
    v_mfma_f32_32x32x16_bf16 v[52:67], v[104:107], v[116:119], v[52:67]
    ds_read_b64_tr_b16 v[124:125], v31 offset:4096
    ds_read_b64_tr_b16 v[126:127], v31 offset:5120
    v_mfma_f32_32x32x16_bf16 v[68:83], v[100:103], v[120:123], v[68:83]
    ds_read_b64_tr_b16 v[128:129], v32 offset:4096
    ds_read_b64_tr_b16 v[130:131], v32 offset:5120
    v_mfma_f32_32x32x16_bf16 v[84:99], v[104:107], v[120:123], v[84:99]
    s_waitcnt lgkmcnt(0)
    v_mfma_f32_32x32x16_bf16 v[36:51], v[108:111], v[124:127], v[36:51]
    ds_read_b128 v[100:103], v23 offset:0
    ds_read_b128 v[104:107], v23 offset:4096
    v_mfma_f32_32x32x16_bf16 v[52:67], v[112:115], v[124:127], v[52:67]
    ds_read_b64_tr_b16 v[116:117], v31 offset:8192
    ds_read_b64_tr_b16 v[118:119], v31 offset:9216
    v_mfma_f32_32x32x16_bf16 v[68:83], v[108:111], v[128:131], v[68:83]
    ds_read_b64_tr_b16 v[120:121], v32 offset:8192
    ds_read_b64_tr_b16 v[122:123], v32 offset:9216
    v_mfma_f32_32x32x16_bf16 v[84:99], v[112:115], v[128:131], v[84:99]
    s_waitcnt lgkmcnt(0)
    v_mfma_f32_32x32x16_bf16 v[36:51], v[100:103], v[116:119], v[36:51]
    ds_read_b128 v[108:111], v24 offset:0
    ds_read_b128 v[112:115], v24 offset:4096
    v_mfma_f32_32x32x16_bf16 v[52:67], v[104:107], v[116:119], v[52:67]
    ds_read_b64_tr_b16 v[124:125], v31 offset:12288
    ds_read_b64_tr_b16 v[126:127], v31 offset:13312
    v_mfma_f32_32x32x16_bf16 v[68:83], v[100:103], v[120:123], v[68:83]
    ds_read_b64_tr_b16 v[128:129], v32 offset:12288
    ds_read_b64_tr_b16 v[130:131], v32 offset:13312
    s_barrier
    v_mfma_f32_32x32x16_bf16 v[84:99], v[104:107], v[120:123], v[84:99]
    s_waitcnt lgkmcnt(0)
    v_mfma_f32_32x32x16_bf16 v[36:51], v[108:111], v[124:127], v[36:51]
    ds_read_b128 v[100:103], v21 offset:32768
    ds_read_b128 v[104:107], v21 offset:36864
    v_mfma_f32_32x32x16_bf16 v[52:67], v[112:115], v[124:127], v[52:67]
    ds_read_b64_tr_b16 v[116:117], v31 offset:32768
    ds_read_b64_tr_b16 v[118:119], v31 offset:33792
    v_mfma_f32_32x32x16_bf16 v[68:83], v[108:111], v[128:131], v[68:83]
    ds_read_b64_tr_b16 v[120:121], v32 offset:32768
    ds_read_b64_tr_b16 v[122:123], v32 offset:33792
    v_mfma_f32_32x32x16_bf16 v[84:99], v[112:115], v[128:131], v[84:99]
    s_waitcnt lgkmcnt(0)
    v_mfma_f32_32x32x16_bf16 v[36:51], v[100:103], v[116:119], v[36:51]
    ds_read_b128 v[108:111], v22 offset:32768
    ds_read_b128 v[112:115], v22 offset:36864
    v_mfma_f32_32x32x16_bf16 v[52:67], v[104:107], v[116:119], v[52:67]
    ds_read_b64_tr_b16 v[124:125], v31 offset:36864
    ds_read_b64_tr_b16 v[126:127], v31 offset:37888
    v_mfma_f32_32x32x16_bf16 v[68:83], v[100:103], v[120:123], v[68:83]
    ds_read_b64_tr_b16 v[128:129], v32 offset:36864
    ds_read_b64_tr_b16 v[130:131], v32 offset:37888
    v_mfma_f32_32x32x16_bf16 v[84:99], v[104:107], v[120:123], v[84:99]
    s_waitcnt lgkmcnt(0)
    v_mfma_f32_32x32x16_bf16 v[36:51], v[108:111], v[124:127], v[36:51]
    ds_read_b128 v[100:103], v23 offset:32768
    ds_read_b128 v[104:107], v23 offset:36864
    v_mfma_f32_32x32x16_bf16 v[52:67], v[112:115], v[124:127], v[52:67]
    ds_read_b64_tr_b16 v[116:117], v31 offset:40960
    ds_read_b64_tr_b16 v[118:119], v31 offset:41984
    v_mfma_f32_32x32x16_bf16 v[68:83], v[108:111], v[128:131], v[68:83]
    ds_read_b64_tr_b16 v[120:121], v32 offset:40960
    ds_read_b64_tr_b16 v[122:123], v32 offset:41984
    v_mfma_f32_32x32x16_bf16 v[84:99], v[112:115], v[128:131], v[84:99]
    s_waitcnt lgkmcnt(0)
    v_mfma_f32_32x32x16_bf16 v[36:51], v[100:103], v[116:119], v[36:51]
    ds_read_b128 v[108:111], v24 offset:32768
    ds_read_b128 v[112:115], v24 offset:36864
    v_mfma_f32_32x32x16_bf16 v[52:67], v[104:107], v[116:119], v[52:67]
    ds_read_b64_tr_b16 v[124:125], v31 offset:45056
    ds_read_b64_tr_b16 v[126:127], v31 offset:46080
    v_mfma_f32_32x32x16_bf16 v[68:83], v[100:103], v[120:123], v[68:83]
    ds_read_b64_tr_b16 v[128:129], v32 offset:45056
    ds_read_b64_tr_b16 v[130:131], v32 offset:46080
    s_barrier
    v_mfma_f32_32x32x16_bf16 v[84:99], v[104:107], v[120:123], v[84:99]
    s_waitcnt lgkmcnt(0)
    v_mfma_f32_32x32x16_bf16 v[36:51], v[108:111], v[124:127], v[36:51]
    ds_read_b128 v[100:103], v25 offset:0
    ds_read_b128 v[104:107], v25 offset:4096
    v_mfma_f32_32x32x16_bf16 v[52:67], v[112:115], v[124:127], v[52:67]
    ds_read_b64_tr_b16 v[116:117], v33 offset:0
    ds_read_b64_tr_b16 v[118:119], v33 offset:1024
    v_mfma_f32_32x32x16_bf16 v[68:83], v[108:111], v[128:131], v[68:83]
    ds_read_b64_tr_b16 v[120:121], v34 offset:0
    ds_read_b64_tr_b16 v[122:123], v34 offset:1024
    v_mfma_f32_32x32x16_bf16 v[84:99], v[112:115], v[128:131], v[84:99]
    s_waitcnt lgkmcnt(0)
    v_mfma_f32_32x32x16_bf16 v[36:51], v[100:103], v[116:119], v[36:51]
    ds_read_b128 v[108:111], v26 offset:0
    ds_read_b128 v[112:115], v26 offset:4096
    v_mfma_f32_32x32x16_bf16 v[52:67], v[104:107], v[116:119], v[52:67]
    ds_read_b64_tr_b16 v[124:125], v33 offset:4096
    ds_read_b64_tr_b16 v[126:127], v33 offset:5120
    v_mfma_f32_32x32x16_bf16 v[68:83], v[100:103], v[120:123], v[68:83]
    ds_read_b64_tr_b16 v[128:129], v34 offset:4096
    ds_read_b64_tr_b16 v[130:131], v34 offset:5120
    v_mfma_f32_32x32x16_bf16 v[84:99], v[104:107], v[120:123], v[84:99]
    s_waitcnt lgkmcnt(0)
    v_mfma_f32_32x32x16_bf16 v[36:51], v[108:111], v[124:127], v[36:51]
    ds_read_b128 v[100:103], v27 offset:0
    ds_read_b128 v[104:107], v27 offset:4096
    v_mfma_f32_32x32x16_bf16 v[52:67], v[112:115], v[124:127], v[52:67]
    ds_read_b64_tr_b16 v[116:117], v33 offset:8192
    ds_read_b64_tr_b16 v[118:119], v33 offset:9216
    v_mfma_f32_32x32x16_bf16 v[68:83], v[108:111], v[128:131], v[68:83]
    ds_read_b64_tr_b16 v[120:121], v34 offset:8192
    ds_read_b64_tr_b16 v[122:123], v34 offset:9216
    v_mfma_f32_32x32x16_bf16 v[84:99], v[112:115], v[128:131], v[84:99]
    s_waitcnt lgkmcnt(0)
    v_mfma_f32_32x32x16_bf16 v[36:51], v[100:103], v[116:119], v[36:51]
    ds_read_b128 v[108:111], v28 offset:0
    ds_read_b128 v[112:115], v28 offset:4096
    v_mfma_f32_32x32x16_bf16 v[52:67], v[104:107], v[116:119], v[52:67]
    ds_read_b64_tr_b16 v[124:125], v33 offset:12288
    ds_read_b64_tr_b16 v[126:127], v33 offset:13312
    v_mfma_f32_32x32x16_bf16 v[68:83], v[100:103], v[120:123], v[68:83]
    ds_read_b64_tr_b16 v[128:129], v34 offset:12288
    ds_read_b64_tr_b16 v[130:131], v34 offset:13312
    v_mfma_f32_32x32x16_bf16 v[84:99], v[104:107], v[120:123], v[84:99]
    s_waitcnt lgkmcnt(0)
    v_mfma_f32_32x32x16_bf16 v[36:51], v[108:111], v[124:127], v[36:51]
    v_mfma_f32_32x32x16_bf16 v[52:67], v[112:115], v[124:127], v[52:67]
    v_mfma_f32_32x32x16_bf16 v[68:83], v[108:111], v[128:131], v[68:83]
    v_mfma_f32_32x32x16_bf16 v[84:99], v[112:115], v[128:131], v[84:99]
    s_nop 8
    v_cvt_pk_bf16_f32 v36, v36, v37
    v_cvt_pk_bf16_f32 v37, v38, v39
    v_cvt_pk_bf16_f32 v38, v40, v41
    v_cvt_pk_bf16_f32 v39, v42, v43
    buffer_store_dwordx4 v[36:39], v9, s[12:15], s20 offen offset:0 sc1
    v_cvt_pk_bf16_f32 v40, v44, v45
    v_cvt_pk_bf16_f32 v41, v46, v47
    v_cvt_pk_bf16_f32 v42, v48, v49
    v_cvt_pk_bf16_f32 v43, v50, v51
    buffer_store_dwordx4 v[40:43], v10, s[12:15], s20 offen offset:0 sc1
    v_cvt_pk_bf16_f32 v52, v52, v53
    v_cvt_pk_bf16_f32 v53, v54, v55
    v_cvt_pk_bf16_f32 v54, v56, v57
    v_cvt_pk_bf16_f32 v55, v58, v59
    buffer_store_dwordx4 v[52:55], v9, s[12:15], s21 offen offset:0 sc1
    v_cvt_pk_bf16_f32 v56, v60, v61
    v_cvt_pk_bf16_f32 v57, v62, v63
    v_cvt_pk_bf16_f32 v58, v64, v65
    v_cvt_pk_bf16_f32 v59, v66, v67
    buffer_store_dwordx4 v[56:59], v10, s[12:15], s21 offen offset:0 sc1
    v_cvt_pk_bf16_f32 v68, v68, v69
    v_cvt_pk_bf16_f32 v69, v70, v71
    v_cvt_pk_bf16_f32 v70, v72, v73
    v_cvt_pk_bf16_f32 v71, v74, v75
    buffer_store_dwordx4 v[68:71], v9, s[12:15], s20 offen offset:512 sc1
    v_cvt_pk_bf16_f32 v72, v76, v77
    v_cvt_pk_bf16_f32 v73, v78, v79
    v_cvt_pk_bf16_f32 v74, v80, v81
    v_cvt_pk_bf16_f32 v75, v82, v83
    buffer_store_dwordx4 v[72:75], v10, s[12:15], s20 offen offset:512 sc1
    v_cvt_pk_bf16_f32 v84, v84, v85
    v_cvt_pk_bf16_f32 v85, v86, v87
    v_cvt_pk_bf16_f32 v86, v88, v89
    v_cvt_pk_bf16_f32 v87, v90, v91
    buffer_store_dwordx4 v[84:87], v9, s[12:15], s21 offen offset:512 sc1
    v_cvt_pk_bf16_f32 v88, v92, v93
    v_cvt_pk_bf16_f32 v89, v94, v95
    v_cvt_pk_bf16_f32 v90, v96, v97
    v_cvt_pk_bf16_f32 v91, v98, v99
    buffer_store_dwordx4 v[88:91], v10, s[12:15], s21 offen offset:512 sc1
concat_heads__mha_block__spectral_fnet__prompt_kernel_s1:
    s_setprio 0
    s_waitcnt vmcnt(0)
concat_heads__mha_block__spectral_fnet__prompt_kernel_s1b:
    s_waitcnt lgkmcnt(0)
    s_barrier
    v_mov_b32 v1, 0
    ds_read_b32 v1, v1 offset:1024
    s_waitcnt lgkmcnt(0)
    v_readfirstlane_b32 s96, v1
    s_nop 1
    v_mov_b32 v4, s96
    v_mov_b32 v5, s96
    v_mov_b32 v6, s96
    v_mov_b32 v7, s96
    s_cmp_lt_u32 s30, 15
    s_cbranch_scc1 concat_heads__mha_block__spectral_fnet__prompt_kernel_nsp
    v_lshlrev_b32 v3, 4, v0
    s_lshl_b32 s23, s52, 7
    s_add_u32 s23, s23, 0x2090000
    s_cmp_eq_u32 s52, 1087
    s_mov_b64 exec, 0xff
    buffer_store_dwordx4 v[4:7], v3, s[12:15], s54 offen sc1
    s_cselect_b32 exec_lo, 0xffff, exec_lo
    buffer_store_dwordx4 v[4:7], v3, s[12:15], s23 offen sc1
    s_mov_b64 exec, -1
    s_mov_b32 s52, 0x4000
    s_mov_b32 s38, 0x4000
    s_cmp_lg_u32 s3, 1
    s_cbranch_scc1 concat_heads__mha_block__spectral_fnet__prompt_kernel_nsp
    v_lshrrev_b32 v3, 3, v0
    v_and_b32 v2, 7, v0
    v_lshlrev_b32 v3, 13, v3
    v_lshl_add_u32 v3, v2, 4, v3
    s_lshl_b32 s23, s31, 7
    s_add_u32 s23, s23, 0x2060a00
    buffer_store_dwordx4 v[4:7], v3, s[12:15], s23 offen sc1
    s_add_u32 s23, s23, 0x10000
    buffer_store_dwordx4 v[4:7], v3, s[12:15], s23 offen sc1
    s_add_u32 s23, s23, 0x10000
    s_mov_b64 exec, 0xff
    buffer_store_dwordx4 v[4:7], v3, s[12:15], s23 offen sc1
    s_mov_b64 exec, -1
concat_heads__mha_block__spectral_fnet__prompt_kernel_nsp:
    s_cmp_lt_u32 s3, 4
    s_cbranch_scc0 concat_heads__mha_block__spectral_fnet__prompt_kernel_helper
    s_cmp_lg_u32 s3, 1
    s_cbranch_scc1 concat_heads__mha_block__spectral_fnet__prompt_kernel_noflagA
    s_cmp_ge_u32 s30, 15
    s_cbranch_scc1 concat_heads__mha_block__spectral_fnet__prompt_kernel_noflagA
    s_mov_b64 exec, s[54:55]
    buffer_store_dwordx4 v[4:7], v206, s[12:15], s52 offen sc1
    s_mov_b64 exec, -1
concat_heads__mha_block__spectral_fnet__prompt_kernel_noflagA:
    s_and_b32 s17, s2, 7
    s_lshr_b32 s18, s2, 3
    s_and_b32 s19, s18, 1
    s_lshl_b32 s27, s17, 1
    s_add_u32 s27, s27, s19
    s_lshr_b32 s28, s2, 4
    s_lshr_b32 s17, s3, 1
    s_mov_b32 s30, 0
    s_mov_b32 s31, -1
    s_mov_b32 s26, 1
    s_mov_b32 s47, 0x07060302
    s_and_b32 s18, s3, 1
    s_lshl_b32 s18, s18, 2
    v_mov_b32 v7, s18
    v_min_u32 v9, 5, v0
    v_lshl_add_u32 v9, v9, 3, s18
    s_mul_i32 s16, s28, 163840
    s_add_u32 s16, s16, 0x0
    s_mul_i32 s22, s27, 2560
    s_lshl_b32 s18, s17, 10
    s_add_u32 s18, s18, s22
    s_lshl_b32 s19, s17, 3
    s_add_u32 s19, s19, 2048
    s_add_u32 s19, s19, s22
    s_mul_i32 s20, s17, 320
    s_mul_i32 s21, s27, 640
    s_add_u32 s20, s20, s21
    s_add_u32 s20, s20, 40960
    v_lshlrev_b32 v5, 4, v0
    v_add_u32 v1, s18, v5
    v_add_u32 v2, s19, v5
    v_and_b32 v10, 31, v0
    v_lshlrev_b32 v6, 2, v10
    v_lshrrev_b32 v11, 5, v0
    v_mul_u32_u24 v11, 640, v11
    v_add_u32 v11, v10, v11
    v_lshl_add_u32 v3, v11, 4, s20
    v_add_u32 v4, 20480, v3
    v_cmp_eq_u32 vcc, 20, v10
    v_mov_b32 v12, 0x80000000
    v_mov_b32 v13, 81920
    v_cndmask_b32 v3, v3, v13, vcc
    v_cndmask_b32 v4, v4, v13, vcc
    v_cmp_lt_u32 vcc, 20, v10
    s_mov_b32 s29, 0xc2c00000
    s_nop 0
    v_cndmask_b32 v3, v3, v12, vcc
    v_cndmask_b32 v4, v4, v12, vcc
    v_cmp_gt_u32 vcc, 32, v0
    s_nop 1
    v_cndmask_b32 v12, v12, v2, vcc
    v_cndmask_b32 v2, v13, v2, vcc
    s_and_b32 s18, s3, 1
    s_lshl_b32 s46, s28, 1
    s_add_u32 s46, s46, s18
    s_lshl_b32 s46, s46, 4
    s_add_u32 s46, s46, s27
    s_lshl_b32 s46, s46, 1
    s_add_u32 s46, s46, s17
    s_lshl_b32 s46, s46, 7
    s_add_u32 s46, s46, 0x2040000
    v_and_b32 v216, 15, v0
    v_lshlrev_b32 v216, 4, v216
    v_bfe_u32 v217, v0, 4, 1
    v_mul_u32_u24 v217, 20480, v217
    v_add_u32 v216, v216, v217
    v_lshrrev_b32 v217, 5, v0
    v_lshlrev_b32 v217, 8, v217
    v_add_u32 v217, v216, v217
    v_mov_b32 v218, 0x80000000
    v_cndmask_b32 v216, v216, v218, s[30:31]
    s_lshl_b32 s17, s28, 3
    s_and_b32 s18, s3, 1
    s_lshl_b32 s22, s18, 2
    s_add_u32 s17, s17, s22
    s_mul_i32 s17, s17, 20480
    s_add_u32 s17, s17, 0x900000
    s_lshr_b32 s19, s3, 1
    s_lshl_b32 s48, s27, 10
    s_add_u32 s48, s48, s17
    s_lshl_b32 s49, s19, 9
    s_add_u32 s48, s48, s49
    s_lshl_b32 s49, s27, 8
    s_add_u32 s49, s49, 16384
    s_add_u32 s49, s49, s17
    s_lshl_b32 s22, s19, 3
    s_add_u32 s49, s49, s22
    s_add_u32 s50, s48, 40960
    s_add_u32 s51, s49, 40960
    s_mul_i32 s17, s3, 6144
    v_add_u32 v219, s17, v5
    s_xor_b32 s18, s3, 1
    s_mul_i32 s18, s18, 6144
    v_add_u32 v220, s18, v5
    s_lshl_b32 s17, s3, 2
    v_mov_b32 v221, s17
    v_mov_b32 v222, 0
    v_mov_b32 v40, 0
    v_mov_b32 v41, 0
    v_mov_b32 v42, 0
    v_mov_b32 v43, 0
    v_mov_b32 v44, 0
    v_mov_b32 v45, 0
    v_mov_b32 v46, 0
    v_mov_b32 v47, 0
    v_mov_b32 v48, 0
    v_mov_b32 v49, 0
    v_mov_b32 v50, 0
    v_mov_b32 v51, 0
    v_mov_b32 v52, 0
    v_mov_b32 v53, 0
    v_mov_b32 v54, 0
    v_mov_b32 v55, 0
    v_mov_b32 v56, 0
    v_mov_b32 v57, 0
    v_mov_b32 v58, 0
    v_mov_b32 v59, 0
    v_mov_b32 v60, 0
    v_mov_b32 v61, 0
    v_mov_b32 v62, 0
    v_mov_b32 v63, 0
    v_mov_b32 v64, 0
    v_mov_b32 v65, 0
    v_mov_b32 v66, 0
    v_mov_b32 v67, 0
    v_mov_b32 v68, 0
    v_mov_b32 v69, 0
    v_mov_b32 v70, 0
    v_mov_b32 v71, 0
    v_mov_b32 v72, 0
    v_mov_b32 v73, 0
    v_mov_b32 v74, 0
    v_mov_b32 v75, 0
    v_mov_b32 v76, 0
    v_mov_b32 v77, 0
    v_mov_b32 v78, 0
    v_mov_b32 v79, 0
    v_mov_b32 v80, 0
    v_mov_b32 v81, 0
    v_mov_b32 v82, 0
    v_mov_b32 v83, 0
    v_mov_b32 v84, 0
    v_mov_b32 v85, 0
    v_mov_b32 v86, 0
    v_mov_b32 v87, 0
    v_mov_b32 v88, 0
    v_mov_b32 v89, 0
    v_mov_b32 v90, 0
    v_mov_b32 v91, 0
    v_mov_b32 v92, 0
    v_mov_b32 v93, 0
    v_mov_b32 v94, 0
    v_mov_b32 v95, 0
    v_mov_b32 v96, 0
    v_mov_b32 v97, 0
    v_mov_b32 v98, 0
    v_mov_b32 v99, 0
    v_mov_b32 v100, 0
    v_mov_b32 v101, 0
    v_mov_b32 v102, 0
    v_mov_b32 v103, 0
    v_mov_b32 v140, 0
    v_mov_b32 v141, 0
    v_mov_b32 v142, 0
    v_mov_b32 v143, 0
    v_mov_b32 v196, 0
    v_mov_b32 v197, 0
    v_mov_b32 v198, 0
    v_mov_b32 v199, 0
    s_mov_b64 exec, 0xff
    buffer_store_dwordx4 v[140:143], v5, s[12:15], s46 offen sc1
    s_mov_b64 exec, -1
    s_mov_b32 s58, 0x40000
concat_heads__mha_block__spectral_fnet__prompt_kernel_go:
    ds_read_b32 v10, v7 offset:1104
    s_waitcnt lgkmcnt(0)
    v_readfirstlane_b32 s9, v10
    s_sub_u32 s58, s58, 1
    s_cbranch_scc1 concat_heads__mha_block__spectral_fnet__prompt_kernel_go_x
    s_and_b32 s59, s9, 0xff
    s_cmp_lg_u32 s59, 0
    s_cbranch_scc0 concat_heads__mha_block__spectral_fnet__prompt_kernel_go
concat_heads__mha_block__spectral_fnet__prompt_kernel_go_x:
    s_sub_u32 s9, s9, 1
    s_mov_b32 s10, s9
    buffer_load_dwordx4 v[144:147], v1, s[12:15], s10 offen sc1
    buffer_load_dwordx2 v[160:161], v2, s[12:15], s10 offen sc1
    s_add_u32 s17, s16, 0
    buffer_load_dwordx4 v[16:19], v1, s[12:15], s17 offen sc1
    buffer_load_dwordx2 v[32:33], v12, s[12:15], s17 offen sc1
    s_add_u32 s17, s16, 40960
    buffer_load_dwordx4 v[20:23], v1, s[12:15], s17 offen sc1
    buffer_load_dwordx2 v[34:35], v12, s[12:15], s17 offen sc1
    s_add_u32 s17, s16, 81920
    buffer_load_dwordx4 v[24:27], v1, s[12:15], s17 offen sc1
    buffer_load_dwordx2 v[36:37], v12, s[12:15], s17 offen sc1
    s_add_u32 s17, s16, 122880
    buffer_load_dwordx4 v[28:31], v1, s[12:15], s17 offen sc1
    buffer_load_dwordx2 v[38:39], v12, s[12:15], s17 offen sc1
    buffer_load_dwordx4 v[168:171], v3, s[12:15], s10 offen sc1
    buffer_load_dwordx4 v[184:187], v4, s[12:15], s10 offen sc1
    s_add_u32 s10, s10, 82048
    buffer_load_dwordx4 v[148:151], v1, s[12:15], s10 offen sc1
    buffer_load_dwordx2 v[162:163], v2, s[12:15], s10 offen sc1
    buffer_load_dwordx4 v[172:175], v3, s[12:15], s10 offen sc1
    buffer_load_dwordx4 v[188:191], v4, s[12:15], s10 offen sc1
    s_add_u32 s10, s10, 82048
    buffer_load_dwordx4 v[152:155], v1, s[12:15], s10 offen sc1
    buffer_load_dwordx2 v[164:165], v2, s[12:15], s10 offen sc1
    buffer_load_dwordx4 v[176:179], v3, s[12:15], s10 offen sc1
    buffer_load_dwordx4 v[192:195], v4, s[12:15], s10 offen sc1
    s_add_u32 s10, s10, 82048
    s_and_b32 s17, s3, 1
    s_cmp_eq_u32 s17, 0
    s_waitcnt vmcnt(10)
    s_cbranch_scc0 concat_heads__mha_block__spectral_fnet__prompt_kernel_mx1
    v_mfma_f32_32x32x16_bf16 v[104:119], v[144:147], v[16:19], 0
    v_mfma_f32_32x32x8_bf16 v[104:119], v[160:161], v[32:33], v[104:119]
    v_mfma_f32_32x32x16_bf16 v[120:135], v[144:147], v[20:23], 0
    v_mfma_f32_32x32x8_bf16 v[120:135], v[160:161], v[34:35], v[120:135]
    s_nop 7
    s_nop 1
    v_max3_f32 v10, v104, v105, v106
    v_max3_f32 v10, v10, v107, v108
    v_max3_f32 v10, v10, v109, v110
    v_max3_f32 v10, v10, v111, v112
    v_max3_f32 v10, v10, v113, v114
    v_max3_f32 v10, v10, v115, v116
    v_max3_f32 v10, v10, v117, v118
    v_max_f32 v10, v10, v119
    s_nop 2
    v_max3_f32 v11, v120, v121, v122
    v_max3_f32 v11, v11, v123, v124
    v_max3_f32 v11, v11, v125, v126
    v_max3_f32 v11, v11, v127, v128
    v_max3_f32 v11, v11, v129, v130
    v_max3_f32 v11, v11, v131, v132
    v_max3_f32 v11, v11, v133, v134
    v_max_f32 v11, v11, v135
    s_branch concat_heads__mha_block__spectral_fnet__prompt_kernel_mxj
concat_heads__mha_block__spectral_fnet__prompt_kernel_mx1:
    v_mfma_f32_32x32x16_bf16 v[104:119], v[144:147], v[24:27], 0
    v_mfma_f32_32x32x8_bf16 v[104:119], v[160:161], v[36:37], v[104:119]
    v_mfma_f32_32x32x16_bf16 v[120:135], v[144:147], v[28:31], 0
    v_mfma_f32_32x32x8_bf16 v[120:135], v[160:161], v[38:39], v[120:135]
    s_nop 7
    s_nop 1
    v_max3_f32 v10, v104, v105, v106
    v_max3_f32 v10, v10, v107, v108
    v_max3_f32 v10, v10, v109, v110
    v_max3_f32 v10, v10, v111, v112
    v_max3_f32 v10, v10, v113, v114
    v_max3_f32 v10, v10, v115, v116
    v_max3_f32 v10, v10, v117, v118
    v_max_f32 v10, v10, v119
    s_nop 2
    v_max3_f32 v11, v120, v121, v122
    v_max3_f32 v11, v11, v123, v124
    v_max3_f32 v11, v11, v125, v126
    v_max3_f32 v11, v11, v127, v128
    v_max3_f32 v11, v11, v129, v130
    v_max3_f32 v11, v11, v131, v132
    v_max3_f32 v11, v11, v133, v134
    v_max_f32 v11, v11, v135
concat_heads__mha_block__spectral_fnet__prompt_kernel_mxj:
    v_mov_b32 v13, v10
    s_nop 1
    v_permlane32_swap_b32 v10, v13
    v_max_f32 v10, v10, v13
    v_sub_f32 v10, s29, v10
    v_cvt_pk_bf16_f32 v13, v10, v10
    v_and_b32 v13, 0xffff0000, v13
    v_sub_f32 v13, v10, v13
    v_cvt_pk_bf16_f32 v10, v10, v13
    v_mov_b32 v13, v11
    s_nop 1
    v_permlane32_swap_b32 v11, v13
    v_max_f32 v11, v11, v13
    v_sub_f32 v11, s29, v11
    v_cvt_pk_bf16_f32 v13, v11, v11
    v_and_b32 v13, 0xffff0000, v13
    v_sub_f32 v13, v11, v13
    v_cvt_pk_bf16_f32 v11, v11, v13
    s_lshl_b32 s17, s3, 8
    v_add_u32 v13, s17, v6
    ds_write_b32 v13, v10 offset:0
    ds_write_b32 v13, v11 offset:128
    s_lshl_b32 s17, s3, 2
    v_mov_b32 v14, s17
    v_mov_b32 v15, 1
    s_waitcnt lgkmcnt(0)
    ds_write_b32 v14, v15 offset:1040
    v_xor_b32 v14, 4, v14
    s_lshr_b32 s17, s3, 1
    s_lshl_b32 s17, s17, 9
    v_add_u32 v13, s17, v6
    s_mov_b32 s58, 0x40000
concat_heads__mha_block__spectral_fnet__prompt_kernel_mw:
    ds_read_b32 v10, v14 offset:1040
    s_waitcnt lgkmcnt(0)
    v_readfirstlane_b32 s17, v10
    s_sub_u32 s58, s58, 1
    s_cbranch_scc1 concat_heads__mha_block__spectral_fnet__prompt_kernel_mw_x
    s_and_b32 s59, s17, 0xff
    s_cmp_eq_u32 s59, 1
    s_cbranch_scc0 concat_heads__mha_block__spectral_fnet__prompt_kernel_mw
concat_heads__mha_block__spectral_fnet__prompt_kernel_mw_x:
    s_mov_b64 exec, s[30:31]
    ds_read_b32 v32, v13 offset:0
    ds_read_b32 v34, v13 offset:128
    ds_read_b32 v36, v13 offset:256
    ds_read_b32 v38, v13 offset:384
    s_mov_b64 exec, -1
concat_heads__mha_block__spectral_fnet__prompt_kernel_start:
    v_mov_b32 v136, 0xdddd
    v_mov_b32 v128, 0
    v_mov_b32 v129, 0
    v_mov_b32 v130, 0
    v_mov_b32 v131, 0
    v_mov_b32 v132, 0
    v_mov_b32 v133, 0
    v_mov_b32 v134, 0
    v_mov_b32 v135, 0
    s_mov_b32 s11, 2
    s_waitcnt vmcnt(8) lgkmcnt(0)
    v_mfma_f32_32x32x16_bf16 v[104:119], v[144:147], v[16:19], 0
    v_mfma_f32_32x32x8_bf16 v[104:119], v[160:161], v[32:33], v[104:119]
    s_nop 7
    s_nop 3
.p2align 5
concat_heads__mha_block__spectral_fnet__prompt_kernel_loop:
    v_exp_f32 v104, v104
    v_exp_f32 v105, v105
    v_smfmac_f32_32x32x32_bf16 v[88:103], v[196:199], v[128:135], v136
    v_exp_f32 v106, v106
    v_exp_f32 v107, v107
    v_exp_f32 v108, v108
    v_mfma_f32_32x32x16_bf16 v[120:135], v[144:147], v[20:23], 0
    v_exp_f32 v109, v109
    v_exp_f32 v110, v110
    v_exp_f32 v111, v111
    v_exp_f32 v112, v112
    v_mfma_f32_32x32x8_bf16 v[120:135], v[160:161], v[34:35], v[120:135]
    v_exp_f32 v113, v113
    v_exp_f32 v114, v114
    v_exp_f32 v115, v115
    v_exp_f32 v116, v116
    v_smfmac_f32_32x32x32_bf16 v[40:55], v[168:171], v[104:111], v136
    v_exp_f32 v117, v117
    buffer_load_dwordx4 v[156:159], v1, s[12:15], s10 offen sc1
    buffer_load_dwordx2 v[166:167], v2, s[12:15], s10 offen sc1
    v_exp_f32 v118, v118
    v_exp_f32 v119, v119
    v_exp_f32 v120, v120
    v_exp_f32 v121, v121
    v_smfmac_f32_32x32x32_bf16 v[40:55], v[184:187], v[112:119], v136
    v_exp_f32 v122, v122
    v_exp_f32 v123, v123
    v_exp_f32 v124, v124
    v_mfma_f32_32x32x16_bf16 v[104:119], v[144:147], v[24:27], 0
    v_exp_f32 v125, v125
    v_exp_f32 v126, v126
    v_exp_f32 v127, v127
    v_exp_f32 v128, v128
    v_mfma_f32_32x32x8_bf16 v[104:119], v[160:161], v[36:37], v[104:119]
    v_exp_f32 v129, v129
    v_exp_f32 v130, v130
    v_exp_f32 v131, v131
    v_exp_f32 v132, v132
    v_smfmac_f32_32x32x32_bf16 v[56:71], v[168:171], v[120:127], v136
    v_exp_f32 v133, v133
    buffer_load_dwordx4 v[180:183], v3, s[12:15], s10 offen sc1
    buffer_load_dwordx4 v[196:199], v4, s[12:15], s10 offen sc1
    ds_read_b32 v8, v7 offset:1112
    v_exp_f32 v134, v134
    v_exp_f32 v135, v135
    v_exp_f32 v104, v104
    v_exp_f32 v105, v105
    v_smfmac_f32_32x32x32_bf16 v[56:71], v[184:187], v[128:135], v136
    v_exp_f32 v106, v106
    v_exp_f32 v107, v107
    v_exp_f32 v108, v108
    v_mfma_f32_32x32x16_bf16 v[120:135], v[144:147], v[28:31], 0
    v_exp_f32 v109, v109
    v_exp_f32 v110, v110
    v_exp_f32 v111, v111
    v_exp_f32 v112, v112
    v_mfma_f32_32x32x8_bf16 v[120:135], v[160:161], v[38:39], v[120:135]
    v_exp_f32 v113, v113
    v_exp_f32 v114, v114
    v_exp_f32 v115, v115
    v_exp_f32 v116, v116
    v_smfmac_f32_32x32x32_bf16 v[72:87], v[168:171], v[104:111], v136
    v_exp_f32 v117, v117
    v_exp_f32 v118, v118
    v_exp_f32 v119, v119
    v_exp_f32 v120, v120
    v_exp_f32 v121, v121
    v_smfmac_f32_32x32x32_bf16 v[72:87], v[184:187], v[112:119], v136
    v_exp_f32 v122, v122
    v_exp_f32 v123, v123
    s_waitcnt vmcnt(8) lgkmcnt(0)
    v_readfirstlane_b32 s17, v8
    v_exp_f32 v124, v124
    v_mfma_f32_32x32x16_bf16 v[104:119], v[148:151], v[16:19], 0
    s_bitcmp1_b32 s17, 0
    s_cbranch_scc0 concat_heads__mha_block__spectral_fnet__prompt_kernel_slow0
concat_heads__mha_block__spectral_fnet__prompt_kernel_back0:
    s_sub_u32 s10, s17, 1
    v_exp_f32 v125, v125
    v_exp_f32 v126, v126
    v_exp_f32 v127, v127
    v_exp_f32 v128, v128
    v_mfma_f32_32x32x8_bf16 v[104:119], v[162:163], v[32:33], v[104:119]
    v_exp_f32 v129, v129
    v_exp_f32 v130, v130
    v_exp_f32 v131, v131
    v_exp_f32 v132, v132
    v_smfmac_f32_32x32x32_bf16 v[88:103], v[168:171], v[120:127], v136
    v_exp_f32 v133, v133
    v_exp_f32 v134, v134
    v_exp_f32 v135, v135
    v_exp_f32 v104, v104
    v_exp_f32 v105, v105
    v_smfmac_f32_32x32x32_bf16 v[88:103], v[184:187], v[128:135], v136
    v_exp_f32 v106, v106
    v_exp_f32 v107, v107
    v_exp_f32 v108, v108
    v_mfma_f32_32x32x16_bf16 v[120:135], v[148:151], v[20:23], 0
    v_exp_f32 v109, v109
    v_exp_f32 v110, v110
    v_exp_f32 v111, v111
    v_exp_f32 v112, v112
    v_mfma_f32_32x32x8_bf16 v[120:135], v[162:163], v[34:35], v[120:135]
    v_exp_f32 v113, v113
    v_exp_f32 v114, v114
    v_exp_f32 v115, v115
    v_exp_f32 v116, v116
    v_smfmac_f32_32x32x32_bf16 v[40:55], v[172:175], v[104:111], v136
    v_exp_f32 v117, v117
    buffer_load_dwordx4 v[144:147], v1, s[12:15], s10 offen sc1
    buffer_load_dwordx2 v[160:161], v2, s[12:15], s10 offen sc1
    v_exp_f32 v118, v118
    v_exp_f32 v119, v119
    v_exp_f32 v120, v120
    v_exp_f32 v121, v121
    v_smfmac_f32_32x32x32_bf16 v[40:55], v[188:191], v[112:119], v136
    v_exp_f32 v122, v122
    v_exp_f32 v123, v123
    v_exp_f32 v124, v124
    v_mfma_f32_32x32x16_bf16 v[104:119], v[148:151], v[24:27], 0
    v_exp_f32 v125, v125
    v_exp_f32 v126, v126
    v_exp_f32 v127, v127
    v_exp_f32 v128, v128
    v_mfma_f32_32x32x8_bf16 v[104:119], v[162:163], v[36:37], v[104:119]
    v_exp_f32 v129, v129
    v_exp_f32 v130, v130
    v_exp_f32 v131, v131
    v_exp_f32 v132, v132
    v_smfmac_f32_32x32x32_bf16 v[56:71], v[172:175], v[120:127], v136
    v_exp_f32 v133, v133
    buffer_load_dwordx4 v[168:171], v3, s[12:15], s10 offen sc1
    buffer_load_dwordx4 v[184:187], v4, s[12:15], s10 offen sc1
    s_add_u32 s10, s10, 82048
    v_exp_f32 v134, v134
    v_exp_f32 v135, v135
    v_exp_f32 v104, v104
    v_exp_f32 v105, v105
    v_smfmac_f32_32x32x32_bf16 v[56:71], v[188:191], v[128:135], v136
    v_exp_f32 v106, v106
    v_exp_f32 v107, v107
    v_exp_f32 v108, v108
    v_mfma_f32_32x32x16_bf16 v[120:135], v[148:151], v[28:31], 0
    v_exp_f32 v109, v109
    v_exp_f32 v110, v110
    v_exp_f32 v111, v111
    v_exp_f32 v112, v112
    v_mfma_f32_32x32x8_bf16 v[120:135], v[162:163], v[38:39], v[120:135]
    v_exp_f32 v113, v113
    v_exp_f32 v114, v114
    v_exp_f32 v115, v115
    v_exp_f32 v116, v116
    v_smfmac_f32_32x32x32_bf16 v[72:87], v[172:175], v[104:111], v136
    v_exp_f32 v117, v117
    v_exp_f32 v118, v118
    v_exp_f32 v119, v119
    v_exp_f32 v120, v120
    v_exp_f32 v121, v121
    v_smfmac_f32_32x32x32_bf16 v[72:87], v[188:191], v[112:119], v136
    v_exp_f32 v122, v122
    v_exp_f32 v123, v123
    s_waitcnt vmcnt(8)
    v_exp_f32 v124, v124
    v_mfma_f32_32x32x16_bf16 v[104:119], v[152:155], v[16:19], 0
    v_exp_f32 v125, v125
    v_exp_f32 v126, v126
    v_exp_f32 v127, v127
    v_exp_f32 v128, v128
    v_mfma_f32_32x32x8_bf16 v[104:119], v[164:165], v[32:33], v[104:119]
    v_exp_f32 v129, v129
    v_exp_f32 v130, v130
    v_exp_f32 v131, v131
    v_exp_f32 v132, v132
    v_smfmac_f32_32x32x32_bf16 v[88:103], v[172:175], v[120:127], v136
    v_exp_f32 v133, v133
    v_exp_f32 v134, v134
    v_exp_f32 v135, v135
    v_exp_f32 v104, v104
    v_exp_f32 v105, v105
    v_smfmac_f32_32x32x32_bf16 v[88:103], v[188:191], v[128:135], v136
    v_exp_f32 v106, v106
    v_exp_f32 v107, v107
    v_exp_f32 v108, v108
    v_mfma_f32_32x32x16_bf16 v[120:135], v[152:155], v[20:23], 0
    v_exp_f32 v109, v109
    v_exp_f32 v110, v110
    v_exp_f32 v111, v111
    v_exp_f32 v112, v112
    v_mfma_f32_32x32x8_bf16 v[120:135], v[164:165], v[34:35], v[120:135]
    v_exp_f32 v113, v113
    v_exp_f32 v114, v114
    v_exp_f32 v115, v115
    v_exp_f32 v116, v116
    v_smfmac_f32_32x32x32_bf16 v[40:55], v[176:179], v[104:111], v136
    v_exp_f32 v117, v117
    buffer_load_dwordx4 v[148:151], v1, s[12:15], s10 offen sc1
    buffer_load_dwordx2 v[162:163], v2, s[12:15], s10 offen sc1
    v_exp_f32 v118, v118
    v_exp_f32 v119, v119
    v_exp_f32 v120, v120
    v_exp_f32 v121, v121
    v_smfmac_f32_32x32x32_bf16 v[40:55], v[192:195], v[112:119], v136
    v_exp_f32 v122, v122
    v_exp_f32 v123, v123
    v_exp_f32 v124, v124
    v_mfma_f32_32x32x16_bf16 v[104:119], v[152:155], v[24:27], 0
    v_exp_f32 v125, v125
    v_exp_f32 v126, v126
    v_exp_f32 v127, v127
    v_exp_f32 v128, v128
    v_mfma_f32_32x32x8_bf16 v[104:119], v[164:165], v[36:37], v[104:119]
    v_exp_f32 v129, v129
    v_exp_f32 v130, v130
    v_exp_f32 v131, v131
    v_exp_f32 v132, v132
    v_smfmac_f32_32x32x32_bf16 v[56:71], v[176:179], v[120:127], v136
    v_exp_f32 v133, v133
    buffer_load_dwordx4 v[172:175], v3, s[12:15], s10 offen sc1
    buffer_load_dwordx4 v[188:191], v4, s[12:15], s10 offen sc1
    s_add_u32 s10, s10, 82048
    v_exp_f32 v134, v134
    v_exp_f32 v135, v135
    v_exp_f32 v104, v104
    v_exp_f32 v105, v105
    v_smfmac_f32_32x32x32_bf16 v[56:71], v[192:195], v[128:135], v136
    v_exp_f32 v106, v106
    v_exp_f32 v107, v107
    v_exp_f32 v108, v108
    v_mfma_f32_32x32x16_bf16 v[120:135], v[152:155], v[28:31], 0
    v_exp_f32 v109, v109
    v_exp_f32 v110, v110
    v_exp_f32 v111, v111
    v_exp_f32 v112, v112
    v_mfma_f32_32x32x8_bf16 v[120:135], v[164:165], v[38:39], v[120:135]
    v_exp_f32 v113, v113
    v_exp_f32 v114, v114
    v_exp_f32 v115, v115
    v_exp_f32 v116, v116
    v_smfmac_f32_32x32x32_bf16 v[72:87], v[176:179], v[104:111], v136
    v_exp_f32 v117, v117
    v_exp_f32 v118, v118
    v_exp_f32 v119, v119
    v_exp_f32 v120, v120
    v_exp_f32 v121, v121
    v_smfmac_f32_32x32x32_bf16 v[72:87], v[192:195], v[112:119], v136
    v_exp_f32 v122, v122
    v_exp_f32 v123, v123
    s_waitcnt vmcnt(8)
    v_exp_f32 v124, v124
    v_mfma_f32_32x32x16_bf16 v[104:119], v[156:159], v[16:19], 0
    v_exp_f32 v125, v125
    v_exp_f32 v126, v126
    v_exp_f32 v127, v127
    v_exp_f32 v128, v128
    v_mfma_f32_32x32x8_bf16 v[104:119], v[166:167], v[32:33], v[104:119]
    v_exp_f32 v129, v129
    v_exp_f32 v130, v130
    v_exp_f32 v131, v131
    v_exp_f32 v132, v132
    v_smfmac_f32_32x32x32_bf16 v[88:103], v[176:179], v[120:127], v136
    v_exp_f32 v133, v133
    v_exp_f32 v134, v134
    v_exp_f32 v135, v135
    v_exp_f32 v104, v104
    v_exp_f32 v105, v105
    v_smfmac_f32_32x32x32_bf16 v[88:103], v[192:195], v[128:135], v136
    v_exp_f32 v106, v106
    v_exp_f32 v107, v107
    v_exp_f32 v108, v108
    v_mfma_f32_32x32x16_bf16 v[120:135], v[156:159], v[20:23], 0
    v_exp_f32 v109, v109
    v_exp_f32 v110, v110
    v_exp_f32 v111, v111
    v_exp_f32 v112, v112
    v_mfma_f32_32x32x8_bf16 v[120:135], v[166:167], v[34:35], v[120:135]
    v_exp_f32 v113, v113
    v_exp_f32 v114, v114
    v_exp_f32 v115, v115
    v_exp_f32 v116, v116
    v_smfmac_f32_32x32x32_bf16 v[40:55], v[180:183], v[104:111], v136
    v_exp_f32 v117, v117
    buffer_load_dwordx4 v[152:155], v1, s[12:15], s10 offen sc1
    buffer_load_dwordx2 v[164:165], v2, s[12:15], s10 offen sc1
    v_exp_f32 v118, v118
    v_exp_f32 v119, v119
    v_exp_f32 v120, v120
    v_exp_f32 v121, v121
    v_smfmac_f32_32x32x32_bf16 v[40:55], v[196:199], v[112:119], v136
    v_exp_f32 v122, v122
    v_exp_f32 v123, v123
    v_exp_f32 v124, v124
    v_mfma_f32_32x32x16_bf16 v[104:119], v[156:159], v[24:27], 0
    v_exp_f32 v125, v125
    v_exp_f32 v126, v126
    v_exp_f32 v127, v127
    v_exp_f32 v128, v128
    v_mfma_f32_32x32x8_bf16 v[104:119], v[166:167], v[36:37], v[104:119]
    v_exp_f32 v129, v129
    v_exp_f32 v130, v130
    v_exp_f32 v131, v131
    v_exp_f32 v132, v132
    v_smfmac_f32_32x32x32_bf16 v[56:71], v[180:183], v[120:127], v136
    v_exp_f32 v133, v133
    buffer_load_dwordx4 v[176:179], v3, s[12:15], s10 offen sc1
    buffer_load_dwordx4 v[192:195], v4, s[12:15], s10 offen sc1
    s_add_u32 s10, s10, 82048
    v_exp_f32 v134, v134
    v_exp_f32 v135, v135
    v_exp_f32 v104, v104
    v_exp_f32 v105, v105
    v_smfmac_f32_32x32x32_bf16 v[56:71], v[196:199], v[128:135], v136
    v_exp_f32 v106, v106
    v_exp_f32 v107, v107
    v_exp_f32 v108, v108
    v_mfma_f32_32x32x16_bf16 v[120:135], v[156:159], v[28:31], 0
    v_exp_f32 v109, v109
    v_exp_f32 v110, v110
    v_exp_f32 v111, v111
    v_exp_f32 v112, v112
    v_mfma_f32_32x32x8_bf16 v[120:135], v[166:167], v[38:39], v[120:135]
    v_exp_f32 v113, v113
    v_exp_f32 v114, v114
    v_exp_f32 v115, v115
    v_exp_f32 v116, v116
    v_smfmac_f32_32x32x32_bf16 v[72:87], v[180:183], v[104:111], v136
    v_exp_f32 v117, v117
    v_exp_f32 v118, v118
    v_exp_f32 v119, v119
    v_exp_f32 v120, v120
    v_exp_f32 v121, v121
    v_smfmac_f32_32x32x32_bf16 v[72:87], v[196:199], v[112:119], v136
    v_exp_f32 v122, v122
    v_exp_f32 v123, v123
    s_waitcnt vmcnt(8)
    v_exp_f32 v124, v124
    v_mfma_f32_32x32x16_bf16 v[104:119], v[144:147], v[16:19], 0
    v_exp_f32 v125, v125
    v_exp_f32 v126, v126
    v_exp_f32 v127, v127
    v_exp_f32 v128, v128
    v_mfma_f32_32x32x8_bf16 v[104:119], v[160:161], v[32:33], v[104:119]
    v_exp_f32 v129, v129
    v_exp_f32 v130, v130
    v_exp_f32 v131, v131
    v_exp_f32 v132, v132
    v_smfmac_f32_32x32x32_bf16 v[88:103], v[180:183], v[120:127], v136
    v_exp_f32 v133, v133
    v_exp_f32 v134, v134
    v_exp_f32 v135, v135
    v_exp_f32 v104, v104
    v_exp_f32 v105, v105
    v_smfmac_f32_32x32x32_bf16 v[88:103], v[196:199], v[128:135], v136
    v_exp_f32 v106, v106
    v_exp_f32 v107, v107
    v_exp_f32 v108, v108
    v_mfma_f32_32x32x16_bf16 v[120:135], v[144:147], v[20:23], 0
    v_exp_f32 v109, v109
    v_exp_f32 v110, v110
    v_exp_f32 v111, v111
    v_exp_f32 v112, v112
    v_mfma_f32_32x32x8_bf16 v[120:135], v[160:161], v[34:35], v[120:135]
    v_exp_f32 v113, v113
    v_exp_f32 v114, v114
    v_exp_f32 v115, v115
    v_exp_f32 v116, v116
    v_smfmac_f32_32x32x32_bf16 v[40:55], v[168:171], v[104:111], v136
    v_exp_f32 v117, v117
    buffer_load_dwordx4 v[156:159], v1, s[12:15], s10 offen sc1
    buffer_load_dwordx2 v[166:167], v2, s[12:15], s10 offen sc1
    v_exp_f32 v118, v118
    v_exp_f32 v119, v119
    v_exp_f32 v120, v120
    v_exp_f32 v121, v121
    v_smfmac_f32_32x32x32_bf16 v[40:55], v[184:187], v[112:119], v136
    v_exp_f32 v122, v122
    v_exp_f32 v123, v123
    v_exp_f32 v124, v124
    v_mfma_f32_32x32x16_bf16 v[104:119], v[144:147], v[24:27], 0
    v_exp_f32 v125, v125
    v_exp_f32 v126, v126
    v_exp_f32 v127, v127
    v_exp_f32 v128, v128
    v_mfma_f32_32x32x8_bf16 v[104:119], v[160:161], v[36:37], v[104:119]
    v_exp_f32 v129, v129
    v_exp_f32 v130, v130
    v_exp_f32 v131, v131
    v_exp_f32 v132, v132
    v_smfmac_f32_32x32x32_bf16 v[56:71], v[168:171], v[120:127], v136
    v_exp_f32 v133, v133
    buffer_load_dwordx4 v[180:183], v3, s[12:15], s10 offen sc1
    buffer_load_dwordx4 v[196:199], v4, s[12:15], s10 offen sc1
    ds_read_b32 v8, v7 offset:1120
    v_exp_f32 v134, v134
    v_exp_f32 v135, v135
    v_exp_f32 v104, v104
    v_exp_f32 v105, v105
    v_smfmac_f32_32x32x32_bf16 v[56:71], v[184:187], v[128:135], v136
    v_exp_f32 v106, v106
    v_exp_f32 v107, v107
    v_exp_f32 v108, v108
    v_mfma_f32_32x32x16_bf16 v[120:135], v[144:147], v[28:31], 0
    v_exp_f32 v109, v109
    v_exp_f32 v110, v110
    v_exp_f32 v111, v111
    v_exp_f32 v112, v112
    v_mfma_f32_32x32x8_bf16 v[120:135], v[160:161], v[38:39], v[120:135]
    v_exp_f32 v113, v113
    v_exp_f32 v114, v114
    v_exp_f32 v115, v115
    v_exp_f32 v116, v116
    v_smfmac_f32_32x32x32_bf16 v[72:87], v[168:171], v[104:111], v136
    v_exp_f32 v117, v117
    v_exp_f32 v118, v118
    v_exp_f32 v119, v119
    v_exp_f32 v120, v120
    v_exp_f32 v121, v121
    v_smfmac_f32_32x32x32_bf16 v[72:87], v[184:187], v[112:119], v136
    v_exp_f32 v122, v122
    v_exp_f32 v123, v123
    s_waitcnt vmcnt(8) lgkmcnt(0)
    v_readfirstlane_b32 s17, v8
    v_exp_f32 v124, v124
    v_mfma_f32_32x32x16_bf16 v[104:119], v[148:151], v[16:19], 0
    s_bitcmp1_b32 s17, 0
    s_cbranch_scc0 concat_heads__mha_block__spectral_fnet__prompt_kernel_slow4
concat_heads__mha_block__spectral_fnet__prompt_kernel_back4:
    s_sub_u32 s10, s17, 1
    v_exp_f32 v125, v125
    v_exp_f32 v126, v126
    v_exp_f32 v127, v127
    v_exp_f32 v128, v128
    v_mfma_f32_32x32x8_bf16 v[104:119], v[162:163], v[32:33], v[104:119]
    v_exp_f32 v129, v129
    v_exp_f32 v130, v130
    v_exp_f32 v131, v131
    v_exp_f32 v132, v132
    v_smfmac_f32_32x32x32_bf16 v[88:103], v[168:171], v[120:127], v136
    v_exp_f32 v133, v133
    v_exp_f32 v134, v134
    v_exp_f32 v135, v135
    v_exp_f32 v104, v104
    v_exp_f32 v105, v105
    v_smfmac_f32_32x32x32_bf16 v[88:103], v[184:187], v[128:135], v136
    v_exp_f32 v106, v106
    v_exp_f32 v107, v107
    v_exp_f32 v108, v108
    v_mfma_f32_32x32x16_bf16 v[120:135], v[148:151], v[20:23], 0
    v_exp_f32 v109, v109
    v_exp_f32 v110, v110
    v_exp_f32 v111, v111
    v_exp_f32 v112, v112
    v_mfma_f32_32x32x8_bf16 v[120:135], v[162:163], v[34:35], v[120:135]
    v_exp_f32 v113, v113
    v_exp_f32 v114, v114
    v_exp_f32 v115, v115
    v_exp_f32 v116, v116
    v_smfmac_f32_32x32x32_bf16 v[40:55], v[172:175], v[104:111], v136
    v_exp_f32 v117, v117
    buffer_load_dwordx4 v[144:147], v1, s[12:15], s10 offen sc1
    buffer_load_dwordx2 v[160:161], v2, s[12:15], s10 offen sc1
    v_exp_f32 v118, v118
    v_exp_f32 v119, v119
    v_exp_f32 v120, v120
    v_exp_f32 v121, v121
    v_smfmac_f32_32x32x32_bf16 v[40:55], v[188:191], v[112:119], v136
    v_exp_f32 v122, v122
    v_exp_f32 v123, v123
    v_exp_f32 v124, v124
    v_mfma_f32_32x32x16_bf16 v[104:119], v[148:151], v[24:27], 0
    v_exp_f32 v125, v125
    v_exp_f32 v126, v126
    v_exp_f32 v127, v127
    v_exp_f32 v128, v128
    v_mfma_f32_32x32x8_bf16 v[104:119], v[162:163], v[36:37], v[104:119]
    v_exp_f32 v129, v129
    v_exp_f32 v130, v130
    v_exp_f32 v131, v131
    v_exp_f32 v132, v132
    v_smfmac_f32_32x32x32_bf16 v[56:71], v[172:175], v[120:127], v136
    v_exp_f32 v133, v133
    buffer_load_dwordx4 v[168:171], v3, s[12:15], s10 offen sc1
    buffer_load_dwordx4 v[184:187], v4, s[12:15], s10 offen sc1
    s_add_u32 s10, s10, 82048
    v_exp_f32 v134, v134
    v_exp_f32 v135, v135
    v_exp_f32 v104, v104
    v_exp_f32 v105, v105
    v_smfmac_f32_32x32x32_bf16 v[56:71], v[188:191], v[128:135], v136
    v_exp_f32 v106, v106
    v_exp_f32 v107, v107
    v_exp_f32 v108, v108
    v_mfma_f32_32x32x16_bf16 v[120:135], v[148:151], v[28:31], 0
    v_exp_f32 v109, v109
    v_exp_f32 v110, v110
    v_exp_f32 v111, v111
    v_exp_f32 v112, v112
    v_mfma_f32_32x32x8_bf16 v[120:135], v[162:163], v[38:39], v[120:135]
    v_exp_f32 v113, v113
    v_exp_f32 v114, v114
    v_exp_f32 v115, v115
    v_exp_f32 v116, v116
    v_smfmac_f32_32x32x32_bf16 v[72:87], v[172:175], v[104:111], v136
    v_exp_f32 v117, v117
    v_exp_f32 v118, v118
    v_exp_f32 v119, v119
    v_exp_f32 v120, v120
    v_exp_f32 v121, v121
    v_smfmac_f32_32x32x32_bf16 v[72:87], v[188:191], v[112:119], v136
    v_exp_f32 v122, v122
    v_exp_f32 v123, v123
    s_waitcnt vmcnt(8)
    v_exp_f32 v124, v124
    v_mfma_f32_32x32x16_bf16 v[104:119], v[152:155], v[16:19], 0
    v_exp_f32 v125, v125
    v_exp_f32 v126, v126
    v_exp_f32 v127, v127
    v_exp_f32 v128, v128
    v_mfma_f32_32x32x8_bf16 v[104:119], v[164:165], v[32:33], v[104:119]
    v_exp_f32 v129, v129
    v_exp_f32 v130, v130
    v_exp_f32 v131, v131
    v_exp_f32 v132, v132
    v_smfmac_f32_32x32x32_bf16 v[88:103], v[172:175], v[120:127], v136
    v_exp_f32 v133, v133
    v_exp_f32 v134, v134
    v_exp_f32 v135, v135
    v_exp_f32 v104, v104
    v_exp_f32 v105, v105
    v_smfmac_f32_32x32x32_bf16 v[88:103], v[188:191], v[128:135], v136
    v_exp_f32 v106, v106
    v_exp_f32 v107, v107
    v_exp_f32 v108, v108
    v_mfma_f32_32x32x16_bf16 v[120:135], v[152:155], v[20:23], 0
    v_exp_f32 v109, v109
    v_exp_f32 v110, v110
    v_exp_f32 v111, v111
    v_exp_f32 v112, v112
    v_mfma_f32_32x32x8_bf16 v[120:135], v[164:165], v[34:35], v[120:135]
    v_exp_f32 v113, v113
    v_exp_f32 v114, v114
    v_exp_f32 v115, v115
    v_exp_f32 v116, v116
    v_smfmac_f32_32x32x32_bf16 v[40:55], v[176:179], v[104:111], v136
    v_exp_f32 v117, v117
    buffer_load_dwordx4 v[148:151], v1, s[12:15], s10 offen sc1
    buffer_load_dwordx2 v[162:163], v2, s[12:15], s10 offen sc1
    v_exp_f32 v118, v118
    v_exp_f32 v119, v119
    v_exp_f32 v120, v120
    v_exp_f32 v121, v121
    v_smfmac_f32_32x32x32_bf16 v[40:55], v[192:195], v[112:119], v136
    v_exp_f32 v122, v122
    v_exp_f32 v123, v123
    v_exp_f32 v124, v124
    v_mfma_f32_32x32x16_bf16 v[104:119], v[152:155], v[24:27], 0
    v_exp_f32 v125, v125
    v_exp_f32 v126, v126
    v_exp_f32 v127, v127
    v_exp_f32 v128, v128
    v_mfma_f32_32x32x8_bf16 v[104:119], v[164:165], v[36:37], v[104:119]
    v_exp_f32 v129, v129
    v_exp_f32 v130, v130
    v_exp_f32 v131, v131
    v_exp_f32 v132, v132
    v_smfmac_f32_32x32x32_bf16 v[56:71], v[176:179], v[120:127], v136
    v_exp_f32 v133, v133
    buffer_load_dwordx4 v[172:175], v3, s[12:15], s10 offen sc1
    buffer_load_dwordx4 v[188:191], v4, s[12:15], s10 offen sc1
    s_add_u32 s10, s10, 82048
    v_exp_f32 v134, v134
    v_exp_f32 v135, v135
    v_exp_f32 v104, v104
    v_exp_f32 v105, v105
    v_smfmac_f32_32x32x32_bf16 v[56:71], v[192:195], v[128:135], v136
    v_exp_f32 v106, v106
    v_exp_f32 v107, v107
    v_exp_f32 v108, v108
    v_mfma_f32_32x32x16_bf16 v[120:135], v[152:155], v[28:31], 0
    v_exp_f32 v109, v109
    v_exp_f32 v110, v110
    v_exp_f32 v111, v111
    v_exp_f32 v112, v112
    v_mfma_f32_32x32x8_bf16 v[120:135], v[164:165], v[38:39], v[120:135]
    v_exp_f32 v113, v113
    v_exp_f32 v114, v114
    v_exp_f32 v115, v115
    v_exp_f32 v116, v116
    v_smfmac_f32_32x32x32_bf16 v[72:87], v[176:179], v[104:111], v136
    v_exp_f32 v117, v117
    v_exp_f32 v118, v118
    v_exp_f32 v119, v119
    v_exp_f32 v120, v120
    v_exp_f32 v121, v121
    v_smfmac_f32_32x32x32_bf16 v[72:87], v[192:195], v[112:119], v136
    v_exp_f32 v122, v122
    v_exp_f32 v123, v123
    s_waitcnt vmcnt(8)
    v_exp_f32 v124, v124
    v_mfma_f32_32x32x16_bf16 v[104:119], v[156:159], v[16:19], 0
    v_exp_f32 v125, v125
    v_exp_f32 v126, v126
    v_exp_f32 v127, v127
    v_exp_f32 v128, v128
    v_mfma_f32_32x32x8_bf16 v[104:119], v[166:167], v[32:33], v[104:119]
    v_exp_f32 v129, v129
    v_exp_f32 v130, v130
    v_exp_f32 v131, v131
    v_exp_f32 v132, v132
    v_smfmac_f32_32x32x32_bf16 v[88:103], v[176:179], v[120:127], v136
    v_exp_f32 v133, v133
    v_exp_f32 v134, v134
    v_exp_f32 v135, v135
    v_exp_f32 v104, v104
    v_exp_f32 v105, v105
    v_smfmac_f32_32x32x32_bf16 v[88:103], v[192:195], v[128:135], v136
    v_exp_f32 v106, v106
    v_exp_f32 v107, v107
    v_exp_f32 v108, v108
    v_mfma_f32_32x32x16_bf16 v[120:135], v[156:159], v[20:23], 0
    v_exp_f32 v109, v109
    v_exp_f32 v110, v110
    v_exp_f32 v111, v111
    v_exp_f32 v112, v112
    v_mfma_f32_32x32x8_bf16 v[120:135], v[166:167], v[34:35], v[120:135]
    v_exp_f32 v113, v113
    v_exp_f32 v114, v114
    v_exp_f32 v115, v115
    v_exp_f32 v116, v116
    v_smfmac_f32_32x32x32_bf16 v[40:55], v[180:183], v[104:111], v136
    v_exp_f32 v117, v117
    buffer_load_dwordx4 v[152:155], v1, s[12:15], s10 offen sc1
    buffer_load_dwordx2 v[164:165], v2, s[12:15], s10 offen sc1
    v_exp_f32 v118, v118
    v_exp_f32 v119, v119
    v_exp_f32 v120, v120
    v_exp_f32 v121, v121
    v_smfmac_f32_32x32x32_bf16 v[40:55], v[196:199], v[112:119], v136
    v_exp_f32 v122, v122
    v_exp_f32 v123, v123
    v_exp_f32 v124, v124
    v_mfma_f32_32x32x16_bf16 v[104:119], v[156:159], v[24:27], 0
    v_exp_f32 v125, v125
    v_exp_f32 v126, v126
    v_exp_f32 v127, v127
    v_exp_f32 v128, v128
    v_mfma_f32_32x32x8_bf16 v[104:119], v[166:167], v[36:37], v[104:119]
    v_exp_f32 v129, v129
    v_exp_f32 v130, v130
    v_exp_f32 v131, v131
    v_exp_f32 v132, v132
    v_smfmac_f32_32x32x32_bf16 v[56:71], v[180:183], v[120:127], v136
    v_exp_f32 v133, v133
    buffer_load_dwordx4 v[176:179], v3, s[12:15], s10 offen sc1
    buffer_load_dwordx4 v[192:195], v4, s[12:15], s10 offen sc1
    s_add_u32 s10, s10, 82048
    v_exp_f32 v134, v134
    v_exp_f32 v135, v135
    v_exp_f32 v104, v104
    v_exp_f32 v105, v105
    v_smfmac_f32_32x32x32_bf16 v[56:71], v[196:199], v[128:135], v136
    v_exp_f32 v106, v106
    v_exp_f32 v107, v107
    v_exp_f32 v108, v108
    v_mfma_f32_32x32x16_bf16 v[120:135], v[156:159], v[28:31], 0
    v_exp_f32 v109, v109
    v_exp_f32 v110, v110
    v_exp_f32 v111, v111
    v_exp_f32 v112, v112
    v_mfma_f32_32x32x8_bf16 v[120:135], v[166:167], v[38:39], v[120:135]
    v_exp_f32 v113, v113
    v_exp_f32 v114, v114
    v_exp_f32 v115, v115
    v_exp_f32 v116, v116
    v_smfmac_f32_32x32x32_bf16 v[72:87], v[180:183], v[104:111], v136
    v_exp_f32 v117, v117
    v_exp_f32 v118, v118
    v_exp_f32 v119, v119
    v_exp_f32 v120, v120
    v_exp_f32 v121, v121
    v_smfmac_f32_32x32x32_bf16 v[72:87], v[196:199], v[112:119], v136
    v_exp_f32 v122, v122
    v_exp_f32 v123, v123
    s_waitcnt vmcnt(8)
    v_exp_f32 v124, v124
    v_mfma_f32_32x32x16_bf16 v[104:119], v[144:147], v[16:19], 0
    v_exp_f32 v125, v125
    v_exp_f32 v126, v126
    v_exp_f32 v127, v127
    v_exp_f32 v128, v128
    v_mfma_f32_32x32x8_bf16 v[104:119], v[160:161], v[32:33], v[104:119]
    v_exp_f32 v129, v129
    v_exp_f32 v130, v130
    v_exp_f32 v131, v131
    v_exp_f32 v132, v132
    v_smfmac_f32_32x32x32_bf16 v[88:103], v[180:183], v[120:127], v136
    v_exp_f32 v133, v133
    v_exp_f32 v134, v134
    v_exp_f32 v135, v135
    v_exp_f32 v104, v104
    v_exp_f32 v105, v105
    v_smfmac_f32_32x32x32_bf16 v[88:103], v[196:199], v[128:135], v136
    v_exp_f32 v106, v106
    v_exp_f32 v107, v107
    v_exp_f32 v108, v108
    v_mfma_f32_32x32x16_bf16 v[120:135], v[144:147], v[20:23], 0
    v_exp_f32 v109, v109
    v_exp_f32 v110, v110
    v_exp_f32 v111, v111
    v_exp_f32 v112, v112
    v_mfma_f32_32x32x8_bf16 v[120:135], v[160:161], v[34:35], v[120:135]
    v_exp_f32 v113, v113
    v_exp_f32 v114, v114
    v_exp_f32 v115, v115
    v_exp_f32 v116, v116
    v_smfmac_f32_32x32x32_bf16 v[40:55], v[168:171], v[104:111], v136
    v_exp_f32 v117, v117
    buffer_load_dwordx4 v[156:159], v1, s[12:15], s10 offen sc1
    buffer_load_dwordx2 v[166:167], v2, s[12:15], s10 offen sc1
    v_exp_f32 v118, v118
    v_exp_f32 v119, v119
    v_exp_f32 v120, v120
    v_exp_f32 v121, v121
    v_smfmac_f32_32x32x32_bf16 v[40:55], v[184:187], v[112:119], v136
    v_exp_f32 v122, v122
    v_exp_f32 v123, v123
    v_exp_f32 v124, v124
    v_mfma_f32_32x32x16_bf16 v[104:119], v[144:147], v[24:27], 0
    v_exp_f32 v125, v125
    v_exp_f32 v126, v126
    v_exp_f32 v127, v127
    v_exp_f32 v128, v128
    v_mfma_f32_32x32x8_bf16 v[104:119], v[160:161], v[36:37], v[104:119]
    v_exp_f32 v129, v129
    v_exp_f32 v130, v130
    v_exp_f32 v131, v131
    v_exp_f32 v132, v132
    v_smfmac_f32_32x32x32_bf16 v[56:71], v[168:171], v[120:127], v136
    v_exp_f32 v133, v133
    buffer_load_dwordx4 v[180:183], v3, s[12:15], s10 offen sc1
    buffer_load_dwordx4 v[196:199], v4, s[12:15], s10 offen sc1
    ds_read_b32 v8, v7 offset:1128
    v_exp_f32 v134, v134
    v_exp_f32 v135, v135
    v_exp_f32 v104, v104
    v_exp_f32 v105, v105
    v_smfmac_f32_32x32x32_bf16 v[56:71], v[184:187], v[128:135], v136
    v_exp_f32 v106, v106
    v_exp_f32 v107, v107
    v_exp_f32 v108, v108
    v_mfma_f32_32x32x16_bf16 v[120:135], v[144:147], v[28:31], 0
    v_exp_f32 v109, v109
    v_exp_f32 v110, v110
    v_exp_f32 v111, v111
    v_exp_f32 v112, v112
    v_mfma_f32_32x32x8_bf16 v[120:135], v[160:161], v[38:39], v[120:135]
    v_exp_f32 v113, v113
    v_exp_f32 v114, v114
    v_exp_f32 v115, v115
    v_exp_f32 v116, v116
    v_smfmac_f32_32x32x32_bf16 v[72:87], v[168:171], v[104:111], v136
    v_exp_f32 v117, v117
    v_exp_f32 v118, v118
    v_exp_f32 v119, v119
    v_exp_f32 v120, v120
    v_exp_f32 v121, v121
    v_smfmac_f32_32x32x32_bf16 v[72:87], v[184:187], v[112:119], v136
    v_exp_f32 v122, v122
    v_exp_f32 v123, v123
    s_waitcnt vmcnt(8) lgkmcnt(0)
    v_readfirstlane_b32 s17, v8
    v_exp_f32 v124, v124
    v_mfma_f32_32x32x16_bf16 v[104:119], v[148:151], v[16:19], 0
    s_bitcmp1_b32 s17, 0
    s_cbranch_scc0 concat_heads__mha_block__spectral_fnet__prompt_kernel_slow8
concat_heads__mha_block__spectral_fnet__prompt_kernel_back8:
    s_sub_u32 s10, s17, 1
    v_exp_f32 v125, v125
    v_exp_f32 v126, v126
    v_exp_f32 v127, v127
    v_exp_f32 v128, v128
    v_mfma_f32_32x32x8_bf16 v[104:119], v[162:163], v[32:33], v[104:119]
    v_exp_f32 v129, v129
    v_exp_f32 v130, v130
    v_exp_f32 v131, v131
    v_exp_f32 v132, v132
    v_smfmac_f32_32x32x32_bf16 v[88:103], v[168:171], v[120:127], v136
    v_exp_f32 v133, v133
    v_exp_f32 v134, v134
    v_exp_f32 v135, v135
    v_exp_f32 v104, v104
    v_exp_f32 v105, v105
    v_smfmac_f32_32x32x32_bf16 v[88:103], v[184:187], v[128:135], v136
    v_exp_f32 v106, v106
    v_exp_f32 v107, v107
    v_exp_f32 v108, v108
    v_mfma_f32_32x32x16_bf16 v[120:135], v[148:151], v[20:23], 0
    v_exp_f32 v109, v109
    v_exp_f32 v110, v110
    v_exp_f32 v111, v111
    v_exp_f32 v112, v112
    v_mfma_f32_32x32x8_bf16 v[120:135], v[162:163], v[34:35], v[120:135]
    v_exp_f32 v113, v113
    v_exp_f32 v114, v114
    v_exp_f32 v115, v115
    v_exp_f32 v116, v116
    v_smfmac_f32_32x32x32_bf16 v[40:55], v[172:175], v[104:111], v136
    v_exp_f32 v117, v117
    buffer_load_dwordx4 v[144:147], v1, s[12:15], s10 offen sc1
    buffer_load_dwordx2 v[160:161], v2, s[12:15], s10 offen sc1
    v_exp_f32 v118, v118
    v_exp_f32 v119, v119
    v_exp_f32 v120, v120
    v_exp_f32 v121, v121
    v_smfmac_f32_32x32x32_bf16 v[40:55], v[188:191], v[112:119], v136
    v_exp_f32 v122, v122
    v_exp_f32 v123, v123
    v_exp_f32 v124, v124
    v_mfma_f32_32x32x16_bf16 v[104:119], v[148:151], v[24:27], 0
    v_exp_f32 v125, v125
    v_exp_f32 v126, v126
    v_exp_f32 v127, v127
    v_exp_f32 v128, v128
    v_mfma_f32_32x32x8_bf16 v[104:119], v[162:163], v[36:37], v[104:119]
    v_exp_f32 v129, v129
    v_exp_f32 v130, v130
    v_exp_f32 v131, v131
    v_exp_f32 v132, v132
    v_smfmac_f32_32x32x32_bf16 v[56:71], v[172:175], v[120:127], v136
    v_exp_f32 v133, v133
    buffer_load_dwordx4 v[168:171], v3, s[12:15], s10 offen sc1
    buffer_load_dwordx4 v[184:187], v4, s[12:15], s10 offen sc1
    s_add_u32 s10, s10, 82048
    v_exp_f32 v134, v134
    v_exp_f32 v135, v135
    v_exp_f32 v104, v104
    v_exp_f32 v105, v105
    v_smfmac_f32_32x32x32_bf16 v[56:71], v[188:191], v[128:135], v136
    v_exp_f32 v106, v106
    v_exp_f32 v107, v107
    v_exp_f32 v108, v108
    v_mfma_f32_32x32x16_bf16 v[120:135], v[148:151], v[28:31], 0
    v_exp_f32 v109, v109
    v_exp_f32 v110, v110
    v_exp_f32 v111, v111
    v_exp_f32 v112, v112
    v_mfma_f32_32x32x8_bf16 v[120:135], v[162:163], v[38:39], v[120:135]
    v_exp_f32 v113, v113
    v_exp_f32 v114, v114
    v_exp_f32 v115, v115
    v_exp_f32 v116, v116
    v_smfmac_f32_32x32x32_bf16 v[72:87], v[172:175], v[104:111], v136
    v_exp_f32 v117, v117
    v_exp_f32 v118, v118
    v_exp_f32 v119, v119
    v_exp_f32 v120, v120
    v_exp_f32 v121, v121
    v_smfmac_f32_32x32x32_bf16 v[72:87], v[188:191], v[112:119], v136
    v_exp_f32 v122, v122
    v_exp_f32 v123, v123
    s_waitcnt vmcnt(8)
    v_exp_f32 v124, v124
    v_mfma_f32_32x32x16_bf16 v[104:119], v[152:155], v[16:19], 0
    v_exp_f32 v125, v125
    v_exp_f32 v126, v126
    v_exp_f32 v127, v127
    v_exp_f32 v128, v128
    v_mfma_f32_32x32x8_bf16 v[104:119], v[164:165], v[32:33], v[104:119]
    v_exp_f32 v129, v129
    v_exp_f32 v130, v130
    v_exp_f32 v131, v131
    v_exp_f32 v132, v132
    v_smfmac_f32_32x32x32_bf16 v[88:103], v[172:175], v[120:127], v136
    v_exp_f32 v133, v133
    v_exp_f32 v134, v134
    v_exp_f32 v135, v135
    v_exp_f32 v104, v104
    v_exp_f32 v105, v105
    v_smfmac_f32_32x32x32_bf16 v[88:103], v[188:191], v[128:135], v136
    v_exp_f32 v106, v106
    v_exp_f32 v107, v107
    v_exp_f32 v108, v108
    v_mfma_f32_32x32x16_bf16 v[120:135], v[152:155], v[20:23], 0
    v_exp_f32 v109, v109
    v_exp_f32 v110, v110
    v_exp_f32 v111, v111
    v_exp_f32 v112, v112
    v_mfma_f32_32x32x8_bf16 v[120:135], v[164:165], v[34:35], v[120:135]
    v_exp_f32 v113, v113
    v_exp_f32 v114, v114
    v_exp_f32 v115, v115
    v_exp_f32 v116, v116
    v_smfmac_f32_32x32x32_bf16 v[40:55], v[176:179], v[104:111], v136
    v_exp_f32 v117, v117
    buffer_load_dwordx4 v[148:151], v1, s[12:15], s10 offen sc1
    buffer_load_dwordx2 v[162:163], v2, s[12:15], s10 offen sc1
    v_exp_f32 v118, v118
    v_exp_f32 v119, v119
    v_exp_f32 v120, v120
    v_exp_f32 v121, v121
    v_smfmac_f32_32x32x32_bf16 v[40:55], v[192:195], v[112:119], v136
    v_exp_f32 v122, v122
    v_exp_f32 v123, v123
    v_exp_f32 v124, v124
    v_mfma_f32_32x32x16_bf16 v[104:119], v[152:155], v[24:27], 0
    v_exp_f32 v125, v125
    v_exp_f32 v126, v126
    v_exp_f32 v127, v127
    v_exp_f32 v128, v128
    v_mfma_f32_32x32x8_bf16 v[104:119], v[164:165], v[36:37], v[104:119]
    v_exp_f32 v129, v129
    v_exp_f32 v130, v130
    v_exp_f32 v131, v131
    v_exp_f32 v132, v132
    v_smfmac_f32_32x32x32_bf16 v[56:71], v[176:179], v[120:127], v136
    v_exp_f32 v133, v133
    buffer_load_dwordx4 v[172:175], v3, s[12:15], s10 offen sc1
    buffer_load_dwordx4 v[188:191], v4, s[12:15], s10 offen sc1
    s_add_u32 s10, s10, 82048
    v_exp_f32 v134, v134
    v_exp_f32 v135, v135
    v_exp_f32 v104, v104
    v_exp_f32 v105, v105
    v_smfmac_f32_32x32x32_bf16 v[56:71], v[192:195], v[128:135], v136
    v_exp_f32 v106, v106
    v_exp_f32 v107, v107
    v_exp_f32 v108, v108
    v_mfma_f32_32x32x16_bf16 v[120:135], v[152:155], v[28:31], 0
    v_exp_f32 v109, v109
    v_exp_f32 v110, v110
    v_exp_f32 v111, v111
    v_exp_f32 v112, v112
    v_mfma_f32_32x32x8_bf16 v[120:135], v[164:165], v[38:39], v[120:135]
    v_exp_f32 v113, v113
    v_exp_f32 v114, v114
    v_exp_f32 v115, v115
    v_exp_f32 v116, v116
    v_smfmac_f32_32x32x32_bf16 v[72:87], v[176:179], v[104:111], v136
    v_exp_f32 v117, v117
    v_exp_f32 v118, v118
    v_exp_f32 v119, v119
    v_exp_f32 v120, v120
    v_exp_f32 v121, v121
    v_smfmac_f32_32x32x32_bf16 v[72:87], v[192:195], v[112:119], v136
    v_exp_f32 v122, v122
    v_exp_f32 v123, v123
    s_waitcnt vmcnt(8)
    v_exp_f32 v124, v124
    v_mfma_f32_32x32x16_bf16 v[104:119], v[156:159], v[16:19], 0
    v_exp_f32 v125, v125
    v_exp_f32 v126, v126
    v_exp_f32 v127, v127
    v_exp_f32 v128, v128
    v_mfma_f32_32x32x8_bf16 v[104:119], v[166:167], v[32:33], v[104:119]
    v_exp_f32 v129, v129
    v_exp_f32 v130, v130
    v_exp_f32 v131, v131
    v_exp_f32 v132, v132
    v_smfmac_f32_32x32x32_bf16 v[88:103], v[176:179], v[120:127], v136
    v_exp_f32 v133, v133
    v_exp_f32 v134, v134
    v_exp_f32 v135, v135
    v_exp_f32 v104, v104
    v_exp_f32 v105, v105
    v_smfmac_f32_32x32x32_bf16 v[88:103], v[192:195], v[128:135], v136
    v_exp_f32 v106, v106
    v_exp_f32 v107, v107
    v_exp_f32 v108, v108
    v_mfma_f32_32x32x16_bf16 v[120:135], v[156:159], v[20:23], 0
    v_exp_f32 v109, v109
    v_exp_f32 v110, v110
    v_exp_f32 v111, v111
    v_exp_f32 v112, v112
    v_mfma_f32_32x32x8_bf16 v[120:135], v[166:167], v[34:35], v[120:135]
    v_exp_f32 v113, v113
    v_exp_f32 v114, v114
    v_exp_f32 v115, v115
    v_exp_f32 v116, v116
    v_smfmac_f32_32x32x32_bf16 v[40:55], v[180:183], v[104:111], v136
    v_exp_f32 v117, v117
    buffer_load_dwordx4 v[152:155], v1, s[12:15], s10 offen sc1
    buffer_load_dwordx2 v[164:165], v2, s[12:15], s10 offen sc1
    v_exp_f32 v118, v118
    v_exp_f32 v119, v119
    v_exp_f32 v120, v120
    v_exp_f32 v121, v121
    v_smfmac_f32_32x32x32_bf16 v[40:55], v[196:199], v[112:119], v136
    v_exp_f32 v122, v122
    v_exp_f32 v123, v123
    v_exp_f32 v124, v124
    v_mfma_f32_32x32x16_bf16 v[104:119], v[156:159], v[24:27], 0
    v_exp_f32 v125, v125
    v_exp_f32 v126, v126
    v_exp_f32 v127, v127
    v_exp_f32 v128, v128
    v_mfma_f32_32x32x8_bf16 v[104:119], v[166:167], v[36:37], v[104:119]
    v_exp_f32 v129, v129
    v_exp_f32 v130, v130
    v_exp_f32 v131, v131
    v_exp_f32 v132, v132
    v_smfmac_f32_32x32x32_bf16 v[56:71], v[180:183], v[120:127], v136
    v_exp_f32 v133, v133
    buffer_load_dwordx4 v[176:179], v3, s[12:15], s10 offen sc1
    buffer_load_dwordx4 v[192:195], v4, s[12:15], s10 offen sc1
    s_add_u32 s10, s10, 82048
    v_exp_f32 v134, v134
    v_exp_f32 v135, v135
    v_exp_f32 v104, v104
    v_exp_f32 v105, v105
    v_smfmac_f32_32x32x32_bf16 v[56:71], v[196:199], v[128:135], v136
    v_exp_f32 v106, v106
    v_exp_f32 v107, v107
    v_exp_f32 v108, v108
    v_mfma_f32_32x32x16_bf16 v[120:135], v[156:159], v[28:31], 0
    v_exp_f32 v109, v109
    v_exp_f32 v110, v110
    v_exp_f32 v111, v111
    v_exp_f32 v112, v112
    v_mfma_f32_32x32x8_bf16 v[120:135], v[166:167], v[38:39], v[120:135]
    v_exp_f32 v113, v113
    v_exp_f32 v114, v114
    v_exp_f32 v115, v115
    v_exp_f32 v116, v116
    v_smfmac_f32_32x32x32_bf16 v[72:87], v[180:183], v[104:111], v136
    v_exp_f32 v117, v117
    v_exp_f32 v118, v118
    v_exp_f32 v119, v119
    v_exp_f32 v120, v120
    v_exp_f32 v121, v121
    v_smfmac_f32_32x32x32_bf16 v[72:87], v[196:199], v[112:119], v136
    v_exp_f32 v122, v122
    v_exp_f32 v123, v123
    s_waitcnt vmcnt(8)
    v_exp_f32 v124, v124
    v_mfma_f32_32x32x16_bf16 v[104:119], v[144:147], v[16:19], 0
    v_exp_f32 v125, v125
    v_exp_f32 v126, v126
    v_exp_f32 v127, v127
    v_exp_f32 v128, v128
    v_mfma_f32_32x32x8_bf16 v[104:119], v[160:161], v[32:33], v[104:119]
    v_exp_f32 v129, v129
    v_exp_f32 v130, v130
    v_exp_f32 v131, v131
    v_exp_f32 v132, v132
    v_smfmac_f32_32x32x32_bf16 v[88:103], v[180:183], v[120:127], v136
    v_exp_f32 v133, v133
    v_exp_f32 v134, v134
    v_exp_f32 v135, v135
    v_exp_f32 v104, v104
    v_exp_f32 v105, v105
    v_smfmac_f32_32x32x32_bf16 v[88:103], v[196:199], v[128:135], v136
    v_exp_f32 v106, v106
    v_exp_f32 v107, v107
    v_exp_f32 v108, v108
    v_mfma_f32_32x32x16_bf16 v[120:135], v[144:147], v[20:23], 0
    v_exp_f32 v109, v109
    v_exp_f32 v110, v110
    v_exp_f32 v111, v111
    v_exp_f32 v112, v112
    v_mfma_f32_32x32x8_bf16 v[120:135], v[160:161], v[34:35], v[120:135]
    v_exp_f32 v113, v113
    v_exp_f32 v114, v114
    v_exp_f32 v115, v115
    v_exp_f32 v116, v116
    v_smfmac_f32_32x32x32_bf16 v[40:55], v[168:171], v[104:111], v136
    v_exp_f32 v117, v117
    buffer_load_dwordx4 v[156:159], v1, s[12:15], s10 offen sc1
    buffer_load_dwordx2 v[166:167], v2, s[12:15], s10 offen sc1
    v_exp_f32 v118, v118
    v_exp_f32 v119, v119
    v_exp_f32 v120, v120
    v_exp_f32 v121, v121
    v_smfmac_f32_32x32x32_bf16 v[40:55], v[184:187], v[112:119], v136
    v_exp_f32 v122, v122
    v_exp_f32 v123, v123
    v_exp_f32 v124, v124
    v_mfma_f32_32x32x16_bf16 v[104:119], v[144:147], v[24:27], 0
    v_exp_f32 v125, v125
    v_exp_f32 v126, v126
    v_exp_f32 v127, v127
    v_exp_f32 v128, v128
    v_mfma_f32_32x32x8_bf16 v[104:119], v[160:161], v[36:37], v[104:119]
    v_exp_f32 v129, v129
    v_exp_f32 v130, v130
    v_exp_f32 v131, v131
    v_exp_f32 v132, v132
    v_smfmac_f32_32x32x32_bf16 v[56:71], v[168:171], v[120:127], v136
    v_exp_f32 v133, v133
    buffer_load_dwordx4 v[180:183], v3, s[12:15], s10 offen sc1
    buffer_load_dwordx4 v[196:199], v4, s[12:15], s10 offen sc1
    ds_read_b32 v223, v222 offset:1216
    ds_read_b32 v8, v7 offset:1136
    v_exp_f32 v134, v134
    v_exp_f32 v135, v135
    v_exp_f32 v104, v104
    v_exp_f32 v105, v105
    v_smfmac_f32_32x32x32_bf16 v[56:71], v[184:187], v[128:135], v136
    v_exp_f32 v106, v106
    v_exp_f32 v107, v107
    v_exp_f32 v108, v108
    v_mfma_f32_32x32x16_bf16 v[120:135], v[144:147], v[28:31], 0
    v_exp_f32 v109, v109
    v_exp_f32 v110, v110
    v_exp_f32 v111, v111
    v_exp_f32 v112, v112
    v_mfma_f32_32x32x8_bf16 v[120:135], v[160:161], v[38:39], v[120:135]
    v_exp_f32 v113, v113
    v_exp_f32 v114, v114
    v_exp_f32 v115, v115
    v_exp_f32 v116, v116
    v_smfmac_f32_32x32x32_bf16 v[72:87], v[168:171], v[104:111], v136
    v_exp_f32 v117, v117
    v_exp_f32 v118, v118
    v_exp_f32 v119, v119
    v_exp_f32 v120, v120
    v_exp_f32 v121, v121
    v_smfmac_f32_32x32x32_bf16 v[72:87], v[184:187], v[112:119], v136
    v_exp_f32 v122, v122
    v_exp_f32 v123, v123
    s_waitcnt vmcnt(8) lgkmcnt(0)
    v_readfirstlane_b32 s17, v8
    v_exp_f32 v124, v124
    v_mfma_f32_32x32x16_bf16 v[104:119], v[148:151], v[16:19], 0
    s_bitcmp1_b32 s17, 0
    s_cbranch_scc0 concat_heads__mha_block__spectral_fnet__prompt_kernel_slow12
concat_heads__mha_block__spectral_fnet__prompt_kernel_back12:
    s_sub_u32 s10, s17, 1
    v_exp_f32 v125, v125
    v_exp_f32 v126, v126
    v_exp_f32 v127, v127
    v_exp_f32 v128, v128
    v_mfma_f32_32x32x8_bf16 v[104:119], v[162:163], v[32:33], v[104:119]
    v_exp_f32 v129, v129
    v_exp_f32 v130, v130
    v_exp_f32 v131, v131
    v_exp_f32 v132, v132
    v_smfmac_f32_32x32x32_bf16 v[88:103], v[168:171], v[120:127], v136
    v_exp_f32 v133, v133
    v_exp_f32 v134, v134
    v_exp_f32 v135, v135
    v_exp_f32 v104, v104
    v_exp_f32 v105, v105
    v_smfmac_f32_32x32x32_bf16 v[88:103], v[184:187], v[128:135], v136
    v_exp_f32 v106, v106
    v_exp_f32 v107, v107
    v_exp_f32 v108, v108
    v_mfma_f32_32x32x16_bf16 v[120:135], v[148:151], v[20:23], 0
    v_exp_f32 v109, v109
    v_exp_f32 v110, v110
    v_exp_f32 v111, v111
    v_exp_f32 v112, v112
    v_mfma_f32_32x32x8_bf16 v[120:135], v[162:163], v[34:35], v[120:135]
    v_exp_f32 v113, v113
    v_exp_f32 v114, v114
    v_exp_f32 v115, v115
    v_exp_f32 v116, v116
    v_smfmac_f32_32x32x32_bf16 v[40:55], v[172:175], v[104:111], v136
    v_exp_f32 v117, v117
    buffer_load_dwordx4 v[144:147], v1, s[12:15], s10 offen sc1
    buffer_load_dwordx2 v[160:161], v2, s[12:15], s10 offen sc1
    v_exp_f32 v118, v118
    v_exp_f32 v119, v119
    v_exp_f32 v120, v120
    v_exp_f32 v121, v121
    v_smfmac_f32_32x32x32_bf16 v[40:55], v[188:191], v[112:119], v136
    v_exp_f32 v122, v122
    v_exp_f32 v123, v123
    v_exp_f32 v124, v124
    v_mfma_f32_32x32x16_bf16 v[104:119], v[148:151], v[24:27], 0
    v_exp_f32 v125, v125
    v_exp_f32 v126, v126
    v_exp_f32 v127, v127
    v_exp_f32 v128, v128
    v_mfma_f32_32x32x8_bf16 v[104:119], v[162:163], v[36:37], v[104:119]
    v_exp_f32 v129, v129
    v_exp_f32 v130, v130
    v_exp_f32 v131, v131
    v_exp_f32 v132, v132
    v_smfmac_f32_32x32x32_bf16 v[56:71], v[172:175], v[120:127], v136
    v_exp_f32 v133, v133
    buffer_load_dwordx4 v[168:171], v3, s[12:15], s10 offen sc1
    buffer_load_dwordx4 v[184:187], v4, s[12:15], s10 offen sc1
    s_add_u32 s10, s10, 82048
    v_exp_f32 v134, v134
    v_exp_f32 v135, v135
    v_exp_f32 v104, v104
    v_exp_f32 v105, v105
    v_smfmac_f32_32x32x32_bf16 v[56:71], v[188:191], v[128:135], v136
    v_exp_f32 v106, v106
    v_exp_f32 v107, v107
    v_exp_f32 v108, v108
    v_mfma_f32_32x32x16_bf16 v[120:135], v[148:151], v[28:31], 0
    v_exp_f32 v109, v109
    v_exp_f32 v110, v110
    v_exp_f32 v111, v111
    v_exp_f32 v112, v112
    v_mfma_f32_32x32x8_bf16 v[120:135], v[162:163], v[38:39], v[120:135]
    v_exp_f32 v113, v113
    v_exp_f32 v114, v114
    v_exp_f32 v115, v115
    v_exp_f32 v116, v116
    v_smfmac_f32_32x32x32_bf16 v[72:87], v[172:175], v[104:111], v136
    v_exp_f32 v117, v117
    v_exp_f32 v118, v118
    v_exp_f32 v119, v119
    v_exp_f32 v120, v120
    v_exp_f32 v121, v121
    v_smfmac_f32_32x32x32_bf16 v[72:87], v[188:191], v[112:119], v136
    v_exp_f32 v122, v122
    v_exp_f32 v123, v123
    s_waitcnt vmcnt(8)
    v_exp_f32 v124, v124
    v_mfma_f32_32x32x16_bf16 v[104:119], v[152:155], v[16:19], 0
    v_exp_f32 v125, v125
    v_exp_f32 v126, v126
    v_exp_f32 v127, v127
    v_exp_f32 v128, v128
    v_mfma_f32_32x32x8_bf16 v[104:119], v[164:165], v[32:33], v[104:119]
    v_exp_f32 v129, v129
    v_exp_f32 v130, v130
    v_exp_f32 v131, v131
    v_exp_f32 v132, v132
    v_smfmac_f32_32x32x32_bf16 v[88:103], v[172:175], v[120:127], v136
    v_exp_f32 v133, v133
    v_exp_f32 v134, v134
    v_exp_f32 v135, v135
    v_exp_f32 v104, v104
    v_exp_f32 v105, v105
    v_smfmac_f32_32x32x32_bf16 v[88:103], v[188:191], v[128:135], v136
    v_exp_f32 v106, v106
    v_exp_f32 v107, v107
    v_exp_f32 v108, v108
    v_mfma_f32_32x32x16_bf16 v[120:135], v[152:155], v[20:23], 0
    v_exp_f32 v109, v109
    v_exp_f32 v110, v110
    v_exp_f32 v111, v111
    v_exp_f32 v112, v112
    v_mfma_f32_32x32x8_bf16 v[120:135], v[164:165], v[34:35], v[120:135]
    v_exp_f32 v113, v113
    v_exp_f32 v114, v114
    v_exp_f32 v115, v115
    v_exp_f32 v116, v116
    v_smfmac_f32_32x32x32_bf16 v[40:55], v[176:179], v[104:111], v136
    v_exp_f32 v117, v117
    buffer_load_dwordx4 v[148:151], v1, s[12:15], s10 offen sc1
    buffer_load_dwordx2 v[162:163], v2, s[12:15], s10 offen sc1
    v_exp_f32 v118, v118
    v_exp_f32 v119, v119
    v_exp_f32 v120, v120
    v_exp_f32 v121, v121
    v_smfmac_f32_32x32x32_bf16 v[40:55], v[192:195], v[112:119], v136
    v_exp_f32 v122, v122
    v_exp_f32 v123, v123
    v_exp_f32 v124, v124
    v_mfma_f32_32x32x16_bf16 v[104:119], v[152:155], v[24:27], 0
    v_exp_f32 v125, v125
    v_exp_f32 v126, v126
    v_exp_f32 v127, v127
    v_exp_f32 v128, v128
    v_mfma_f32_32x32x8_bf16 v[104:119], v[164:165], v[36:37], v[104:119]
    v_exp_f32 v129, v129
    v_exp_f32 v130, v130
    v_exp_f32 v131, v131
    v_exp_f32 v132, v132
    v_smfmac_f32_32x32x32_bf16 v[56:71], v[176:179], v[120:127], v136
    v_exp_f32 v133, v133
    buffer_load_dwordx4 v[172:175], v3, s[12:15], s10 offen sc1
    buffer_load_dwordx4 v[188:191], v4, s[12:15], s10 offen sc1
    s_add_u32 s10, s10, 82048
    v_exp_f32 v134, v134
    v_exp_f32 v135, v135
    v_exp_f32 v104, v104
    v_exp_f32 v105, v105
    v_smfmac_f32_32x32x32_bf16 v[56:71], v[192:195], v[128:135], v136
    v_exp_f32 v106, v106
    v_exp_f32 v107, v107
    v_exp_f32 v108, v108
    v_mfma_f32_32x32x16_bf16 v[120:135], v[152:155], v[28:31], 0
    v_exp_f32 v109, v109
    v_exp_f32 v110, v110
    v_exp_f32 v111, v111
    v_exp_f32 v112, v112
    v_mfma_f32_32x32x8_bf16 v[120:135], v[164:165], v[38:39], v[120:135]
    v_exp_f32 v113, v113
    v_exp_f32 v114, v114
    v_exp_f32 v115, v115
    v_exp_f32 v116, v116
    v_smfmac_f32_32x32x32_bf16 v[72:87], v[176:179], v[104:111], v136
    v_exp_f32 v117, v117
    v_exp_f32 v118, v118
    v_exp_f32 v119, v119
    v_exp_f32 v120, v120
    v_exp_f32 v121, v121
    v_smfmac_f32_32x32x32_bf16 v[72:87], v[192:195], v[112:119], v136
    v_exp_f32 v122, v122
    v_exp_f32 v123, v123
    s_waitcnt vmcnt(8)
    v_exp_f32 v124, v124
    v_mfma_f32_32x32x16_bf16 v[104:119], v[156:159], v[16:19], 0
    v_exp_f32 v125, v125
    v_exp_f32 v126, v126
    v_exp_f32 v127, v127
    v_exp_f32 v128, v128
    v_mfma_f32_32x32x8_bf16 v[104:119], v[166:167], v[32:33], v[104:119]
    v_exp_f32 v129, v129
    v_exp_f32 v130, v130
    v_exp_f32 v131, v131
    v_exp_f32 v132, v132
    v_smfmac_f32_32x32x32_bf16 v[88:103], v[176:179], v[120:127], v136
    v_exp_f32 v133, v133
    v_exp_f32 v134, v134
    v_exp_f32 v135, v135
    v_exp_f32 v104, v104
    v_exp_f32 v105, v105
    v_smfmac_f32_32x32x32_bf16 v[88:103], v[192:195], v[128:135], v136
    v_exp_f32 v106, v106
    v_exp_f32 v107, v107
    v_exp_f32 v108, v108
    v_mfma_f32_32x32x16_bf16 v[120:135], v[156:159], v[20:23], 0
    v_exp_f32 v109, v109
    v_exp_f32 v110, v110
    v_exp_f32 v111, v111
    v_exp_f32 v112, v112
    v_mfma_f32_32x32x8_bf16 v[120:135], v[166:167], v[34:35], v[120:135]
    v_exp_f32 v113, v113
    v_exp_f32 v114, v114
    v_exp_f32 v115, v115
    v_exp_f32 v116, v116
    v_smfmac_f32_32x32x32_bf16 v[40:55], v[180:183], v[104:111], v136
    v_exp_f32 v117, v117
    buffer_load_dwordx4 v[152:155], v1, s[12:15], s10 offen sc1
    buffer_load_dwordx2 v[164:165], v2, s[12:15], s10 offen sc1
    v_exp_f32 v118, v118
    v_exp_f32 v119, v119
    v_exp_f32 v120, v120
    v_exp_f32 v121, v121
    v_smfmac_f32_32x32x32_bf16 v[40:55], v[196:199], v[112:119], v136
    v_exp_f32 v122, v122
    v_exp_f32 v123, v123
    v_exp_f32 v124, v124
    v_mfma_f32_32x32x16_bf16 v[104:119], v[156:159], v[24:27], 0
    v_exp_f32 v125, v125
    v_exp_f32 v126, v126
    v_exp_f32 v127, v127
    v_exp_f32 v128, v128
    v_mfma_f32_32x32x8_bf16 v[104:119], v[166:167], v[36:37], v[104:119]
    v_exp_f32 v129, v129
    v_exp_f32 v130, v130
    v_exp_f32 v131, v131
    v_exp_f32 v132, v132
    v_smfmac_f32_32x32x32_bf16 v[56:71], v[180:183], v[120:127], v136
    v_exp_f32 v133, v133
    buffer_load_dwordx4 v[176:179], v3, s[12:15], s10 offen sc1
    buffer_load_dwordx4 v[192:195], v4, s[12:15], s10 offen sc1
    s_add_u32 s10, s10, 82048
    v_exp_f32 v134, v134
    v_exp_f32 v135, v135
    v_exp_f32 v104, v104
    v_exp_f32 v105, v105
    v_smfmac_f32_32x32x32_bf16 v[56:71], v[196:199], v[128:135], v136
    v_exp_f32 v106, v106
    v_exp_f32 v107, v107
    v_exp_f32 v108, v108
    v_mfma_f32_32x32x16_bf16 v[120:135], v[156:159], v[28:31], 0
    v_exp_f32 v109, v109
    v_exp_f32 v110, v110
    v_exp_f32 v111, v111
    v_exp_f32 v112, v112
    v_mfma_f32_32x32x8_bf16 v[120:135], v[166:167], v[38:39], v[120:135]
    v_exp_f32 v113, v113
    v_exp_f32 v114, v114
    v_exp_f32 v115, v115
    v_exp_f32 v116, v116
    v_smfmac_f32_32x32x32_bf16 v[72:87], v[180:183], v[104:111], v136
    v_exp_f32 v117, v117
    v_exp_f32 v118, v118
    v_exp_f32 v119, v119
    v_exp_f32 v120, v120
    v_exp_f32 v121, v121
    v_smfmac_f32_32x32x32_bf16 v[72:87], v[196:199], v[112:119], v136
    v_exp_f32 v122, v122
    v_exp_f32 v123, v123
    s_waitcnt vmcnt(8)
    v_exp_f32 v124, v124
    v_mfma_f32_32x32x16_bf16 v[104:119], v[144:147], v[16:19], 0
    v_exp_f32 v125, v125
    v_exp_f32 v126, v126
    v_exp_f32 v127, v127
    v_exp_f32 v128, v128
    v_mfma_f32_32x32x8_bf16 v[104:119], v[160:161], v[32:33], v[104:119]
    v_exp_f32 v129, v129
    v_exp_f32 v130, v130
    v_exp_f32 v131, v131
    v_exp_f32 v132, v132
    v_smfmac_f32_32x32x32_bf16 v[88:103], v[180:183], v[120:127], v136
    v_exp_f32 v133, v133
    v_add_u32 v7, 32, v7
    s_sub_u32 s11, s11, 1
    s_cmp_lg_u32 s11, 0
    v_exp_f32 v134, v134
    v_exp_f32 v135, v135
    s_cbranch_scc1 concat_heads__mha_block__spectral_fnet__prompt_kernel_loop
    s_nop 1
    v_smfmac_f32_32x32x32_bf16 v[88:103], v[196:199], v[128:135], v136
    v_readfirstlane_b32 s23, v223
    s_nop 0
    s_cmp_eq_u32 s23, 1
    s_cbranch_scc1 concat_heads__mha_block__spectral_fnet__prompt_kernel_armw_x
    s_mov_b32 s58, 0x40000
concat_heads__mha_block__spectral_fnet__prompt_kernel_armw:
    ds_read_b32 v15, v222 offset:1216
    s_waitcnt lgkmcnt(0)
    v_readfirstlane_b32 s23, v15
    s_sub_u32 s58, s58, 1
    s_cbranch_scc1 concat_heads__mha_block__spectral_fnet__prompt_kernel_armw_x
    s_and_b32 s59, s23, 0xff
    s_cmp_eq_u32 s59, 1
    s_cbranch_scc0 concat_heads__mha_block__spectral_fnet__prompt_kernel_armw
concat_heads__mha_block__spectral_fnet__prompt_kernel_armw_x:
    s_mov_b32 s21, 0x76000000
    s_and_b32 s17, s3, 1
    s_cbranch_scc0 concat_heads__mha_block__spectral_fnet__prompt_kernel_mg0
    ds_write_b128 v219, v[40:43] offset:4096
    ds_write_b128 v219, v[44:47] offset:5120
    ds_write_b128 v219, v[48:51] offset:6144
    ds_write_b128 v219, v[56:59] offset:7168
    ds_write_b128 v219, v[60:63] offset:8192
    ds_write_b128 v219, v[64:67] offset:9216
    v_maximum3_f32 v14, |v40|, |v41|, |v41|
    v_maximum3_f32 v14, v14, |v42|, |v43|
    v_maximum3_f32 v14, v14, |v44|, |v45|
    v_maximum3_f32 v14, v14, |v46|, |v47|
    v_maximum3_f32 v14, v14, |v48|, |v49|
    v_maximum3_f32 v14, v14, |v50|, |v51|
    v_maximum3_f32 v14, v14, |v56|, |v57|
    v_maximum3_f32 v14, v14, |v58|, |v59|
    v_maximum3_f32 v14, v14, |v60|, |v61|
    v_maximum3_f32 v14, v14, |v62|, |v63|
    v_maximum3_f32 v14, v14, |v64|, |v65|
    v_maximum3_f32 v14, v14, |v66|, |v67|
    v_maximum3_f32 v14, v14, |v72|, |v73|
    v_maximum3_f32 v14, v14, |v74|, |v75|
    v_maximum3_f32 v14, v14, |v76|, |v77|
    v_maximum3_f32 v14, v14, |v78|, |v79|
    v_maximum3_f32 v14, v14, |v80|, |v81|
    v_maximum3_f32 v14, v14, |v82|, |v83|
    v_maximum3_f32 v14, v14, |v88|, |v89|
    v_maximum3_f32 v14, v14, |v90|, |v91|
    v_maximum3_f32 v14, v14, |v92|, |v93|
    v_maximum3_f32 v14, v14, |v94|, |v95|
    v_maximum3_f32 v14, v14, |v96|, |v97|
    v_maximum3_f32 v14, v14, |v98|, |v99|
    v_cmp_ngt_f32 vcc, s21, v14
    v_xor_b32 v14, 4, v221
    s_cmp_lg_u64 vcc, 0
    s_cselect_b32 s22, 0x100, 0
    s_or_b32 s22, s22, s26
    v_mov_b32 v15, s22
    s_waitcnt lgkmcnt(0)
    ds_write_b32 v221, v15 offset:1056
    s_mov_b32 s58, 0x40000
concat_heads__mha_block__spectral_fnet__prompt_kernel_mgw1:
    ds_read_b32 v12, v14 offset:1056
    s_waitcnt lgkmcnt(0)
    v_readfirstlane_b32 s17, v12
    s_sub_u32 s58, s58, 1
    s_cbranch_scc1 concat_heads__mha_block__spectral_fnet__prompt_kernel_mgw1_x
    s_and_b32 s59, s17, 0xff
    s_cmp_eq_u32 s59, s26
    s_cbranch_scc0 concat_heads__mha_block__spectral_fnet__prompt_kernel_mgw1
concat_heads__mha_block__spectral_fnet__prompt_kernel_mgw1_x:
    ds_read_b128 v[104:107], v220 offset:4096
    ds_read_b128 v[108:111], v220 offset:5120
    ds_read_b128 v[112:115], v220 offset:6144
    ds_read_b128 v[120:123], v220 offset:7168
    ds_read_b128 v[124:127], v220 offset:8192
    ds_read_b128 v[128:131], v220 offset:9216
    s_waitcnt lgkmcnt(3)
    v_pk_add_f32 v[104:105], v[104:105], v[72:73]
    v_pk_add_f32 v[106:107], v[106:107], v[74:75]
    v_pk_add_f32 v[108:109], v[108:109], v[76:77]
    v_pk_add_f32 v[110:111], v[110:111], v[78:79]
    v_pk_add_f32 v[112:113], v[112:113], v[80:81]
    v_pk_add_f32 v[114:115], v[114:115], v[82:83]
    s_waitcnt lgkmcnt(0)
    v_pk_add_f32 v[120:121], v[120:121], v[88:89]
    v_pk_add_f32 v[122:123], v[122:123], v[90:91]
    v_pk_add_f32 v[124:125], v[124:125], v[92:93]
    v_pk_add_f32 v[126:127], v[126:127], v[94:95]
    v_pk_add_f32 v[128:129], v[128:129], v[96:97]
    v_pk_add_f32 v[130:131], v[130:131], v[98:99]
    s_branch concat_heads__mha_block__spectral_fnet__prompt_kernel_mgj
concat_heads__mha_block__spectral_fnet__prompt_kernel_mg0:
    ds_write_b128 v219, v[72:75] offset:4096
    ds_write_b128 v219, v[76:79] offset:5120
    ds_write_b128 v219, v[80:83] offset:6144
    v_maximum3_f32 v14, |v40|, |v41|, |v41|
    v_maximum3_f32 v14, v14, |v42|, |v43|
    v_maximum3_f32 v14, v14, |v44|, |v45|
    v_maximum3_f32 v14, v14, |v46|, |v47|
    v_maximum3_f32 v14, v14, |v48|, |v49|
    v_maximum3_f32 v14, v14, |v50|, |v51|
    v_maximum3_f32 v14, v14, |v56|, |v57|
    v_maximum3_f32 v14, v14, |v58|, |v59|
    v_maximum3_f32 v14, v14, |v60|, |v61|
    v_maximum3_f32 v14, v14, |v62|, |v63|
    v_maximum3_f32 v14, v14, |v64|, |v65|
    v_maximum3_f32 v14, v14, |v66|, |v67|
    ds_write_b128 v219, v[88:91] offset:7168
    ds_write_b128 v219, v[92:95] offset:8192
    ds_write_b128 v219, v[96:99] offset:9216
    v_maximum3_f32 v14, v14, |v72|, |v73|
    v_maximum3_f32 v14, v14, |v74|, |v75|
    v_maximum3_f32 v14, v14, |v76|, |v77|
    v_maximum3_f32 v14, v14, |v78|, |v79|
    v_maximum3_f32 v14, v14, |v80|, |v81|
    v_maximum3_f32 v14, v14, |v82|, |v83|
    v_maximum3_f32 v14, v14, |v88|, |v89|
    v_maximum3_f32 v14, v14, |v90|, |v91|
    v_maximum3_f32 v14, v14, |v92|, |v93|
    v_maximum3_f32 v14, v14, |v94|, |v95|
    v_maximum3_f32 v14, v14, |v96|, |v97|
    v_maximum3_f32 v14, v14, |v98|, |v99|
    v_cmp_ngt_f32 vcc, s21, v14
    v_xor_b32 v14, 4, v221
    s_cmp_lg_u64 vcc, 0
    s_cselect_b32 s22, 0x100, 0
    s_or_b32 s22, s22, s26
    v_mov_b32 v15, s22
    s_waitcnt lgkmcnt(0)
    ds_write_b32 v221, v15 offset:1056
    s_mov_b32 s58, 0x40000
concat_heads__mha_block__spectral_fnet__prompt_kernel_mgw0:
    ds_read_b32 v12, v14 offset:1056
    s_waitcnt lgkmcnt(0)
    v_readfirstlane_b32 s17, v12
    s_sub_u32 s58, s58, 1
    s_cbranch_scc1 concat_heads__mha_block__spectral_fnet__prompt_kernel_mgw0_x
    s_and_b32 s59, s17, 0xff
    s_cmp_eq_u32 s59, s26
    s_cbranch_scc0 concat_heads__mha_block__spectral_fnet__prompt_kernel_mgw0
concat_heads__mha_block__spectral_fnet__prompt_kernel_mgw0_x:
    ds_read_b128 v[104:107], v220 offset:4096
    ds_read_b128 v[108:111], v220 offset:5120
    ds_read_b128 v[112:115], v220 offset:6144
    ds_read_b128 v[120:123], v220 offset:7168
    ds_read_b128 v[124:127], v220 offset:8192
    ds_read_b128 v[128:131], v220 offset:9216
    s_waitcnt lgkmcnt(3)
    v_pk_add_f32 v[104:105], v[104:105], v[40:41]
    v_pk_add_f32 v[106:107], v[106:107], v[42:43]
    v_pk_add_f32 v[108:109], v[108:109], v[44:45]
    v_pk_add_f32 v[110:111], v[110:111], v[46:47]
    v_pk_add_f32 v[112:113], v[112:113], v[48:49]
    v_pk_add_f32 v[114:115], v[114:115], v[50:51]
    s_waitcnt lgkmcnt(0)
    v_pk_add_f32 v[120:121], v[120:121], v[56:57]
    v_pk_add_f32 v[122:123], v[122:123], v[58:59]
    v_pk_add_f32 v[124:125], v[124:125], v[60:61]
    v_pk_add_f32 v[126:127], v[126:127], v[62:63]
    v_pk_add_f32 v[128:129], v[128:129], v[64:65]
    v_pk_add_f32 v[130:131], v[130:131], v[66:67]
concat_heads__mha_block__spectral_fnet__prompt_kernel_mgj:
    s_or_b32 s17, s17, s22
    s_cmp_eq_u32 s17, 0x101
    s_cbranch_scc1 concat_heads__mha_block__spectral_fnet__prompt_kernel_fallback
    s_mov_b32 s21, 0x7800000
    v_max3_f32 v14, |v104|, |v105|, |v106|
    v_max3_f32 v14, v14, |v107|, |v108|
    v_max3_f32 v14, v14, |v109|, |v110|
    v_max_f32 v14, v14, |v111|
    v_max3_f32 v15, |v120|, |v121|, |v122|
    v_max3_f32 v15, v15, |v123|, |v124|
    v_max3_f32 v15, v15, |v125|, |v126|
    v_max_f32 v15, v15, |v127|
    v_min_f32 v14, v14, v15
    v_cmp_gt_f32 vcc, s21, v14
    v_xor_b32 v10, 4, v221
    s_cmp_lg_u64 vcc, 0
    s_cselect_b32 s22, 0x100, 0
    s_or_b32 s22, s22, s26
    v_mov_b32 v15, s22
    ds_write_b32 v221, v15 offset:1224
    v_mov_b32 v12, v112
    v_mov_b32 v13, v112
    s_nop 1
    v_permlane32_swap_b32 v12, v13
    v_rcp_f32 v12, v13
    s_nop 0
    v_pk_mul_f32 v[104:105], v[104:105], v[12:13] op_sel_hi:[1,0]
    v_pk_mul_f32 v[106:107], v[106:107], v[12:13] op_sel_hi:[1,0]
    v_pk_mul_f32 v[108:109], v[108:109], v[12:13] op_sel_hi:[1,0]
    v_pk_mul_f32 v[110:111], v[110:111], v[12:13] op_sel_hi:[1,0]
    v_pk_mul_f32 v[112:113], v[112:113], v[12:13] op_sel_hi:[1,0]
    v_pk_mul_f32 v[114:115], v[114:115], v[12:13] op_sel_hi:[1,0]
    s_nop 0
    v_cvt_pk_bf16_f32 v104, v104, v105
    v_cvt_pk_bf16_f32 v105, v106, v107
    v_cvt_pk_bf16_f32 v106, v108, v109
    v_cvt_pk_bf16_f32 v107, v110, v111
    v_cvt_pk_bf16_f32 v108, v112, v113
    v_cvt_pk_bf16_f32 v109, v114, v115
    buffer_store_dwordx4 v[104:107], v217, s[12:15], s48 offen sc1
    buffer_store_dwordx2 v[108:109], v216, s[12:15], s49 offen sc1
    v_mov_b32 v12, v128
    v_mov_b32 v13, v128
    s_nop 1
    v_permlane32_swap_b32 v12, v13
    v_rcp_f32 v12, v13
    s_nop 0
    v_pk_mul_f32 v[120:121], v[120:121], v[12:13] op_sel_hi:[1,0]
    v_pk_mul_f32 v[122:123], v[122:123], v[12:13] op_sel_hi:[1,0]
    v_pk_mul_f32 v[124:125], v[124:125], v[12:13] op_sel_hi:[1,0]
    v_pk_mul_f32 v[126:127], v[126:127], v[12:13] op_sel_hi:[1,0]
    v_pk_mul_f32 v[128:129], v[128:129], v[12:13] op_sel_hi:[1,0]
    v_pk_mul_f32 v[130:131], v[130:131], v[12:13] op_sel_hi:[1,0]
    ds_read_b32 v11, v10 offset:1224
    v_cvt_pk_bf16_f32 v120, v120, v121
    v_cvt_pk_bf16_f32 v121, v122, v123
    v_cvt_pk_bf16_f32 v122, v124, v125
    v_cvt_pk_bf16_f32 v123, v126, v127
    v_cvt_pk_bf16_f32 v124, v128, v129
    v_cvt_pk_bf16_f32 v125, v130, v131
    buffer_store_dwordx4 v[120:123], v217, s[12:15], s50 offen sc1
    buffer_store_dwordx2 v[124:125], v216, s[12:15], s51 offen sc1
    s_waitcnt lgkmcnt(0)
    v_readfirstlane_b32 s17, v11
    s_nop 0
    s_and_b32 s59, s17, 0xff
    s_cmp_eq_u32 s59, s26
    s_cbranch_scc1 concat_heads__mha_block__spectral_fnet__prompt_kernel_m2w_x
    s_mov_b32 s58, 0x40000
concat_heads__mha_block__spectral_fnet__prompt_kernel_m2w:
    ds_read_b32 v11, v10 offset:1224
    s_waitcnt lgkmcnt(0)
    v_readfirstlane_b32 s17, v11
    s_sub_u32 s58, s58, 1
    s_cbranch_scc1 concat_heads__mha_block__spectral_fnet__prompt_kernel_m2w_x
    s_and_b32 s59, s17, 0xff
    s_cmp_eq_u32 s59, s26
    s_cbranch_scc0 concat_heads__mha_block__spectral_fnet__prompt_kernel_m2w
concat_heads__mha_block__spectral_fnet__prompt_kernel_m2w_x:
    s_or_b32 s17, s17, s22
    s_cmp_eq_u32 s17, 0x101
    s_cbranch_scc1 concat_heads__mha_block__spectral_fnet__prompt_kernel_fallback
    s_cmp_eq_u32 s26, 1
    s_cbranch_scc1 concat_heads__mha_block__spectral_fnet__prompt_kernel_sig
    s_waitcnt vmcnt(0)
concat_heads__mha_block__spectral_fnet__prompt_kernel_sig:
    s_load_dwordx2 s[8:9], s[0:1], 64
    s_and_b32 s33, s2, 7
    s_bfe_u32 s34, s2, 0x20003
    s_lshl_b32 s33, s33, 2
    s_add_u32 s34, s34, s33
    s_lshl_b32 s40, s34, 12
    s_add_u32 s40, s40, 0x2040000
    s_lshl_b32 s34, s34, 2
    s_add_u32 s34, s34, s3
    s_mul_i32 s32, s34, 20480
    s_add_u32 s32, s32, 0x900000
    v_lshlrev_b32 v8, 4, v0
    v_mov_b32 v20, s96
    v_mov_b32 v21, s96
    v_mov_b32 v22, s96
    v_mov_b32 v23, s96
    s_mov_b64 exec, 0xff
    buffer_store_dwordx4 v[20:23], v8, s[12:15], s46 offen offset:0 sc1
    s_mov_b64 exec, -1
    s_mul_i32 s41, s34, 40960
    s_lshr_b32 s35, s2, 5
    s_mul_i32 s35, s35, 160
    s_add_u32 s41, s41, s35
    s_mov_b32 s10, 5242880
    s_mov_b32 s11, 0x00020000
    v_bfe_u32 v1, v0, 2, 2
    v_and_b32 v2, 3, v0
    v_lshlrev_b32 v2, 3, v2
    v_add_u32 v2, 28672, v2
    v_lshrrev_b32 v3, 5, v0
    v_bfe_u32 v4, v0, 4, 1
    v_mul_u32_u24 v3, 20, v3
    v_lshl_add_u32 v3, v4, 2, v3
    v_add_u32 v3, v3, v1
    v_mul_u32_u24 v3, 160, v3
    v_add_u32 v12, v3, v2
    v_lshrrev_b32 v3, 4, v0
    v_mul_u32_u24 v3, 40, v3
    v_add_u32 v3, v3, v1
    v_add_u32 v3, 16, v3
    v_mul_u32_u24 v3, 160, v3
    v_add_u32 v13, v3, v2
    v_add_u32 v14, 0x10000, v12
    v_add_u32 v15, 0x10000, v13
    s_mul_i32 s33, s3, 2816
    s_add_u32 s33, s33, 79872
    v_and_b32 v1, 15, v0
    v_mul_u32_u24 v1, 176, v1
    v_lshrrev_b32 v2, 4, v0
    v_lshl_add_u32 v1, v2, 3, v1
    v_add_u32 v16, s33, v1
    v_add_u32 v2, 0, v0
    v_mul_u32_u24 v3, 6554, v2
    v_lshrrev_b32 v3, 16, v3
    v_add_u32 v4, v2, v3
    v_lshl_add_u32 v9, v4, 4, s33
    v_mul_u32_u24 v3, 2400, v3
    v_lshl_add_u32 v5, v2, 4, v3
    v_add_u32 v2, 64, v0
    v_mul_u32_u24 v3, 6554, v2
    v_lshrrev_b32 v3, 16, v3
    v_add_u32 v4, v2, v3
    v_lshl_add_u32 v10, v4, 4, s33
    v_mul_u32_u24 v3, 2400, v3
    v_lshl_add_u32 v6, v2, 4, v3
    v_add_u32 v2, 128, v0
    v_mul_u32_u24 v3, 6554, v2
    v_lshrrev_b32 v3, 16, v3
    v_add_u32 v4, v2, v3
    v_lshl_add_u32 v11, v4, 4, s33
    v_mul_u32_u24 v3, 2400, v3
    v_lshl_add_u32 v7, v2, 4, v3
    v_mov_b32 v2, 0x80000000
    v_cmp_gt_u32 vcc, 32, v0
    v_lshlrev_b32 v8, 4, v0
    v_and_b32 v1, 31, v0
    v_cndmask_b32 v7, v2, v7, vcc
    v_lshlrev_b32 v1, 7, v1
    v_mov_b32 v2, 0
    s_mov_b32 s58, 0x40000
concat_heads__mha_block__spectral_fnet__prompt_kernel_wo0:
    ds_read_b32 v3, v2 offset:1088
    s_waitcnt lgkmcnt(0)
    v_readfirstlane_b32 s33, v3
    s_sub_u32 s58, s58, 1
    s_cbranch_scc1 concat_heads__mha_block__spectral_fnet__prompt_kernel_wo0_x
    s_and_b32 s59, s33, 0xff
    s_cmp_eq_u32 s59, 1
    s_cbranch_scc0 concat_heads__mha_block__spectral_fnet__prompt_kernel_wo0
concat_heads__mha_block__spectral_fnet__prompt_kernel_wo0_x:
    s_mov_b32 s58, 0x40000
concat_heads__mha_block__spectral_fnet__prompt_kernel_wo1:
    ds_read_b32 v3, v2 offset:1092
    s_waitcnt lgkmcnt(0)
    v_readfirstlane_b32 s33, v3
    s_sub_u32 s58, s58, 1
    s_cbranch_scc1 concat_heads__mha_block__spectral_fnet__prompt_kernel_wo1_x
    s_and_b32 s59, s33, 0xff
    s_cmp_eq_u32 s59, 1
    s_cbranch_scc0 concat_heads__mha_block__spectral_fnet__prompt_kernel_wo1
concat_heads__mha_block__spectral_fnet__prompt_kernel_wo1_x:
    s_waitcnt vmcnt(5)
    ds_read_b64_tr_b16 v[136:137], v12 offset:0
    ds_read_b64_tr_b16 v[138:139], v12 offset:1280
    ds_read_b64_tr_b16 v[140:141], v12 offset:32
    ds_read_b64_tr_b16 v[142:143], v12 offset:1312
    ds_read_b64_tr_b16 v[144:145], v12 offset:64
    ds_read_b64_tr_b16 v[146:147], v12 offset:1344
    ds_read_b64_tr_b16 v[148:149], v12 offset:96
    ds_read_b64_tr_b16 v[150:151], v12 offset:1376
    ds_read_b64_tr_b16 v[152:153], v12 offset:128
    ds_read_b64_tr_b16 v[154:155], v12 offset:1408
    ds_read_b64_tr_b16 v[156:157], v12 offset:6400
    ds_read_b64_tr_b16 v[158:159], v12 offset:7680
    ds_read_b64_tr_b16 v[160:161], v12 offset:6432
    ds_read_b64_tr_b16 v[162:163], v12 offset:7712
    ds_read_b64_tr_b16 v[164:165], v12 offset:6464
    ds_read_b64_tr_b16 v[166:167], v12 offset:7744
    ds_read_b64_tr_b16 v[168:169], v12 offset:6496
    ds_read_b64_tr_b16 v[170:171], v12 offset:7776
    ds_read_b64_tr_b16 v[172:173], v12 offset:6528
    ds_read_b64_tr_b16 v[174:175], v12 offset:7808
    ds_read_b64_tr_b16 v[176:177], v12 offset:12800
    ds_read_b64_tr_b16 v[178:179], v12 offset:14080
    ds_read_b64_tr_b16 v[180:181], v12 offset:12832
    ds_read_b64_tr_b16 v[182:183], v12 offset:14112
    ds_read_b64_tr_b16 v[184:185], v12 offset:12864
    ds_read_b64_tr_b16 v[186:187], v12 offset:14144
    ds_read_b64_tr_b16 v[188:189], v12 offset:12896
    ds_read_b64_tr_b16 v[190:191], v12 offset:14176
    ds_read_b64_tr_b16 v[192:193], v12 offset:12928
    ds_read_b64_tr_b16 v[194:195], v12 offset:14208
    ds_read_b64_tr_b16 v[196:197], v12 offset:19200
    ds_read_b64_tr_b16 v[198:199], v12 offset:20480
    ds_read_b64_tr_b16 v[200:201], v12 offset:19232
    ds_read_b64_tr_b16 v[202:203], v12 offset:20512
    ds_read_b64_tr_b16 v[204:205], v12 offset:19264
    ds_read_b64_tr_b16 v[206:207], v12 offset:20544
    ds_read_b64_tr_b16 v[208:209], v12 offset:19296
    ds_read_b64_tr_b16 v[210:211], v12 offset:20576
    ds_read_b64_tr_b16 v[212:213], v12 offset:19328
    ds_read_b64_tr_b16 v[214:215], v12 offset:20608
    ds_read_b64_tr_b16 v[216:217], v12 offset:25600
    ds_read_b64_tr_b16 v[218:219], v12 offset:26880
    ds_read_b64_tr_b16 v[220:221], v12 offset:25632
    ds_read_b64_tr_b16 v[222:223], v12 offset:26912
    ds_read_b64_tr_b16 v[224:225], v12 offset:25664
    ds_read_b64_tr_b16 v[226:227], v12 offset:26944
    ds_read_b64_tr_b16 v[228:229], v12 offset:25696
    ds_read_b64_tr_b16 v[230:231], v12 offset:26976
    ds_read_b64_tr_b16 v[232:233], v12 offset:25728
    ds_read_b64_tr_b16 v[234:235], v12 offset:27008
    s_mov_b32 s58, 0x40000
concat_heads__mha_block__spectral_fnet__prompt_kernel_arm2:
    ds_read_b32 v3, v2 offset:1220
    s_waitcnt lgkmcnt(0)
    v_readfirstlane_b32 s33, v3
    s_sub_u32 s58, s58, 1
    s_cbranch_scc1 concat_heads__mha_block__spectral_fnet__prompt_kernel_arm2_x
    s_and_b32 s59, s33, 0xff
    s_cmp_eq_u32 s59, 1
    s_cbranch_scc0 concat_heads__mha_block__spectral_fnet__prompt_kernel_arm2
concat_heads__mha_block__spectral_fnet__prompt_kernel_arm2_x:
    s_add_u32 s48, s32, 0
    s_add_u32 s49, s32, 4096
    s_add_u32 s50, s32, 8192
    s_add_u32 s51, s32, 12288
    s_add_u32 s52, s32, 16384
    s_mov_b32 s58, 0x4000
concat_heads__mha_block__spectral_fnet__prompt_kernel_pO:
    buffer_load_dword v17, v1, s[12:15], s40 offen sc0 sc1
    s_waitcnt vmcnt(0)
    v_cmp_ne_u32 vcc, s96, v17
    s_nop 1
    s_cbranch_vccz concat_heads__mha_block__spectral_fnet__prompt_kernel_pO_x
    s_sleep 3
    s_sub_u32 s58, s58, 1
    s_cbranch_scc0 concat_heads__mha_block__spectral_fnet__prompt_kernel_pO
concat_heads__mha_block__spectral_fnet__prompt_kernel_pO_x:
    buffer_load_dwordx4 v[24:27], v8, s[12:15], s48 offen offset:0 sc1
    buffer_load_dwordx4 v[28:31], v8, s[12:15], s48 offen offset:1024 sc1
    buffer_load_dwordx4 v[32:35], v8, s[12:15], s48 offen offset:2048 sc1
    buffer_load_dwordx4 v[36:39], v8, s[12:15], s48 offen offset:3072 sc1
    buffer_load_dwordx4 v[40:43], v8, s[12:15], s49 offen offset:0 sc1
    buffer_load_dwordx4 v[44:47], v8, s[12:15], s49 offen offset:1024 sc1
    buffer_load_dwordx4 v[48:51], v8, s[12:15], s49 offen offset:2048 sc1
    buffer_load_dwordx4 v[52:55], v8, s[12:15], s49 offen offset:3072 sc1
    buffer_load_dwordx4 v[56:59], v8, s[12:15], s50 offen offset:0 sc1
    buffer_load_dwordx4 v[60:63], v8, s[12:15], s50 offen offset:1024 sc1
    buffer_load_dwordx4 v[64:67], v8, s[12:15], s50 offen offset:2048 sc1
    buffer_load_dwordx4 v[68:71], v8, s[12:15], s50 offen offset:3072 sc1
    buffer_load_dwordx4 v[72:75], v8, s[12:15], s51 offen offset:0 sc1
    buffer_load_dwordx4 v[76:79], v8, s[12:15], s51 offen offset:1024 sc1
    buffer_load_dwordx4 v[80:83], v8, s[12:15], s51 offen offset:2048 sc1
    buffer_load_dwordx4 v[84:87], v8, s[12:15], s51 offen offset:3072 sc1
    buffer_load_dwordx4 v[88:91], v8, s[12:15], s52 offen offset:0 sc1
    buffer_load_dwordx4 v[92:95], v8, s[12:15], s52 offen offset:1024 sc1
    buffer_load_dwordx4 v[96:99], v8, s[12:15], s52 offen offset:2048 sc1
    buffer_load_dwordx4 v[100:103], v8, s[12:15], s52 offen offset:3072 sc1
    s_waitcnt vmcnt(16)
    v_max3_u32 v17, v24, v25, v26
    v_max3_u32 v17, v17, v27, v28
    v_max3_u32 v17, v17, v29, v30
    v_max3_u32 v17, v17, v31, v32
    v_max3_u32 v17, v17, v33, v34
    v_max3_u32 v17, v17, v35, v36
    v_max3_u32 v17, v17, v37, v38
    v_max_u32 v17, v17, v39
    v_cmp_eq_u32 vcc, -1, v17
    s_waitcnt lgkmcnt(0)
    s_cbranch_vccnz concat_heads__mha_block__spectral_fnet__prompt_kernel_cs0
concat_heads__mha_block__spectral_fnet__prompt_kernel_cb0:
    v_mfma_f32_16x16x32_bf16 v[104:107], v[136:139], v[24:27], 0
    ds_read_b64_tr_b16 v[236:237], v12 offset:32000
    ds_read_b64_tr_b16 v[238:239], v12 offset:33280
    v_mfma_f32_16x16x32_bf16 v[108:111], v[140:143], v[24:27], 0
    ds_read_b64_tr_b16 v[240:241], v12 offset:32032
    ds_read_b64_tr_b16 v[242:243], v12 offset:33312
    v_mfma_f32_16x16x32_bf16 v[112:115], v[144:147], v[24:27], 0
    ds_read_b64_tr_b16 v[244:245], v12 offset:32064
    ds_read_b64_tr_b16 v[246:247], v12 offset:33344
    v_mfma_f32_16x16x32_bf16 v[116:119], v[148:151], v[24:27], 0
    ds_read_b64_tr_b16 v[248:249], v12 offset:32096
    ds_read_b64_tr_b16 v[250:251], v12 offset:33376
    v_mfma_f32_16x16x32_bf16 v[120:123], v[152:155], v[24:27], 0
    ds_read_b64_tr_b16 v[252:253], v12 offset:32128
    ds_read_b64_tr_b16 v[254:255], v12 offset:33408
    s_waitcnt lgkmcnt(15)
    v_mfma_f32_16x16x32_bf16 v[104:107], v[156:159], v[28:31], v[104:107]
    ds_read_b64_tr_b16 v[136:137], v12 offset:38400
    ds_read_b64_tr_b16 v[138:139], v12 offset:39680
    v_mfma_f32_16x16x32_bf16 v[108:111], v[160:163], v[28:31], v[108:111]
    ds_read_b64_tr_b16 v[140:141], v12 offset:38432
    ds_read_b64_tr_b16 v[142:143], v12 offset:39712
    v_mfma_f32_16x16x32_bf16 v[112:115], v[164:167], v[28:31], v[112:115]
    ds_read_b64_tr_b16 v[144:145], v12 offset:38464
    ds_read_b64_tr_b16 v[146:147], v12 offset:39744
    v_mfma_f32_16x16x32_bf16 v[116:119], v[168:171], v[28:31], v[116:119]
    ds_read_b64_tr_b16 v[148:149], v12 offset:38496
    ds_read_b64_tr_b16 v[150:151], v12 offset:39776
    v_mfma_f32_16x16x32_bf16 v[120:123], v[172:175], v[28:31], v[120:123]
    ds_read_b64_tr_b16 v[152:153], v12 offset:38528
    ds_read_b64_tr_b16 v[154:155], v12 offset:39808
    s_waitcnt vmcnt(12) lgkmcnt(15)
    v_mfma_f32_16x16x32_bf16 v[104:107], v[176:179], v[32:35], v[104:107]
    ds_read_b64_tr_b16 v[156:157], v12 offset:44800
    ds_read_b64_tr_b16 v[158:159], v12 offset:46080
    v_max3_u32 v17, v40, v41, v42
    v_mfma_f32_16x16x32_bf16 v[108:111], v[180:183], v[32:35], v[108:111]
    ds_read_b64_tr_b16 v[160:161], v12 offset:44832
    ds_read_b64_tr_b16 v[162:163], v12 offset:46112
    v_max3_u32 v17, v17, v43, v44
    v_mfma_f32_16x16x32_bf16 v[112:115], v[184:187], v[32:35], v[112:115]
    ds_read_b64_tr_b16 v[164:165], v12 offset:44864
    ds_read_b64_tr_b16 v[166:167], v12 offset:46144
    v_max3_u32 v17, v17, v45, v46
    v_mfma_f32_16x16x32_bf16 v[116:119], v[188:191], v[32:35], v[116:119]
    ds_read_b64_tr_b16 v[168:169], v12 offset:44896
    ds_read_b64_tr_b16 v[170:171], v12 offset:46176
    v_max3_u32 v17, v17, v47, v48
    v_mfma_f32_16x16x32_bf16 v[120:123], v[192:195], v[32:35], v[120:123]
    ds_read_b64_tr_b16 v[172:173], v12 offset:44928
    ds_read_b64_tr_b16 v[174:175], v12 offset:46208
    v_max3_u32 v17, v17, v49, v50
    s_waitcnt lgkmcnt(15)
    v_mfma_f32_16x16x32_bf16 v[104:107], v[196:199], v[36:39], v[104:107]
    ds_read_b64_tr_b16 v[176:177], v14 offset:0
    ds_read_b64_tr_b16 v[178:179], v14 offset:1280
    v_max3_u32 v17, v17, v51, v52
    v_mfma_f32_16x16x32_bf16 v[108:111], v[200:203], v[36:39], v[108:111]
    ds_read_b64_tr_b16 v[180:181], v14 offset:32
    ds_read_b64_tr_b16 v[182:183], v14 offset:1312
    v_max3_u32 v17, v17, v53, v54
    v_mfma_f32_16x16x32_bf16 v[112:115], v[204:207], v[36:39], v[112:115]
    ds_read_b64_tr_b16 v[184:185], v14 offset:64
    ds_read_b64_tr_b16 v[186:187], v14 offset:1344
    v_max_u32 v17, v17, v55
    v_mfma_f32_16x16x32_bf16 v[116:119], v[208:211], v[36:39], v[116:119]
    ds_read_b64_tr_b16 v[188:189], v14 offset:96
    ds_read_b64_tr_b16 v[190:191], v14 offset:1376
    v_cmp_eq_u32 vcc, -1, v17
    v_mfma_f32_16x16x32_bf16 v[120:123], v[212:215], v[36:39], v[120:123]
    ds_read_b64_tr_b16 v[192:193], v14 offset:128
    ds_read_b64_tr_b16 v[194:195], v14 offset:1408
    s_waitcnt lgkmcnt(15)
    s_cbranch_vccnz concat_heads__mha_block__spectral_fnet__prompt_kernel_cs1
concat_heads__mha_block__spectral_fnet__prompt_kernel_cb1:
    v_mfma_f32_16x16x32_bf16 v[104:107], v[216:219], v[40:43], v[104:107]
    ds_read_b64_tr_b16 v[196:197], v14 offset:6400
    ds_read_b64_tr_b16 v[198:199], v14 offset:7680
    v_mfma_f32_16x16x32_bf16 v[108:111], v[220:223], v[40:43], v[108:111]
    ds_read_b64_tr_b16 v[200:201], v14 offset:6432
    ds_read_b64_tr_b16 v[202:203], v14 offset:7712
    v_mfma_f32_16x16x32_bf16 v[112:115], v[224:227], v[40:43], v[112:115]
    ds_read_b64_tr_b16 v[204:205], v14 offset:6464
    ds_read_b64_tr_b16 v[206:207], v14 offset:7744
    v_mfma_f32_16x16x32_bf16 v[116:119], v[228:231], v[40:43], v[116:119]
    ds_read_b64_tr_b16 v[208:209], v14 offset:6496
    ds_read_b64_tr_b16 v[210:211], v14 offset:7776
    v_mfma_f32_16x16x32_bf16 v[120:123], v[232:235], v[40:43], v[120:123]
    ds_read_b64_tr_b16 v[212:213], v14 offset:6528
    ds_read_b64_tr_b16 v[214:215], v14 offset:7808
    s_waitcnt lgkmcnt(15)
    v_mfma_f32_16x16x32_bf16 v[104:107], v[236:239], v[44:47], v[104:107]
    ds_read_b64_tr_b16 v[216:217], v14 offset:12800
    ds_read_b64_tr_b16 v[218:219], v14 offset:14080
    v_mfma_f32_16x16x32_bf16 v[108:111], v[240:243], v[44:47], v[108:111]
    ds_read_b64_tr_b16 v[220:221], v14 offset:12832
    ds_read_b64_tr_b16 v[222:223], v14 offset:14112
    v_mfma_f32_16x16x32_bf16 v[112:115], v[244:247], v[44:47], v[112:115]
    ds_read_b64_tr_b16 v[224:225], v14 offset:12864
    ds_read_b64_tr_b16 v[226:227], v14 offset:14144
    v_mfma_f32_16x16x32_bf16 v[116:119], v[248:251], v[44:47], v[116:119]
    ds_read_b64_tr_b16 v[228:229], v14 offset:12896
    ds_read_b64_tr_b16 v[230:231], v14 offset:14176
    v_mfma_f32_16x16x32_bf16 v[120:123], v[252:255], v[44:47], v[120:123]
    ds_read_b64_tr_b16 v[232:233], v14 offset:12928
    ds_read_b64_tr_b16 v[234:235], v14 offset:14208
    s_waitcnt vmcnt(8) lgkmcnt(15)
    v_mfma_f32_16x16x32_bf16 v[104:107], v[136:139], v[48:51], v[104:107]
    ds_read_b64_tr_b16 v[236:237], v14 offset:19200
    ds_read_b64_tr_b16 v[238:239], v14 offset:20480
    v_max3_u32 v17, v56, v57, v58
    v_mfma_f32_16x16x32_bf16 v[108:111], v[140:143], v[48:51], v[108:111]
    ds_read_b64_tr_b16 v[240:241], v14 offset:19232
    ds_read_b64_tr_b16 v[242:243], v14 offset:20512
    v_max3_u32 v17, v17, v59, v60
    v_mfma_f32_16x16x32_bf16 v[112:115], v[144:147], v[48:51], v[112:115]
    ds_read_b64_tr_b16 v[244:245], v14 offset:19264
    ds_read_b64_tr_b16 v[246:247], v14 offset:20544
    v_max3_u32 v17, v17, v61, v62
    v_mfma_f32_16x16x32_bf16 v[116:119], v[148:151], v[48:51], v[116:119]
    ds_read_b64_tr_b16 v[248:249], v14 offset:19296
    ds_read_b64_tr_b16 v[250:251], v14 offset:20576
    v_max3_u32 v17, v17, v63, v64
    v_mfma_f32_16x16x32_bf16 v[120:123], v[152:155], v[48:51], v[120:123]
    ds_read_b64_tr_b16 v[252:253], v14 offset:19328
    ds_read_b64_tr_b16 v[254:255], v14 offset:20608
    v_max3_u32 v17, v17, v65, v66
    s_waitcnt lgkmcnt(15)
    v_mfma_f32_16x16x32_bf16 v[104:107], v[156:159], v[52:55], v[104:107]
    ds_read_b64_tr_b16 v[136:137], v14 offset:25600
    ds_read_b64_tr_b16 v[138:139], v14 offset:26880
    v_max3_u32 v17, v17, v67, v68
    v_mfma_f32_16x16x32_bf16 v[108:111], v[160:163], v[52:55], v[108:111]
    ds_read_b64_tr_b16 v[140:141], v14 offset:25632
    ds_read_b64_tr_b16 v[142:143], v14 offset:26912
    v_max3_u32 v17, v17, v69, v70
    v_mfma_f32_16x16x32_bf16 v[112:115], v[164:167], v[52:55], v[112:115]
    ds_read_b64_tr_b16 v[144:145], v14 offset:25664
    ds_read_b64_tr_b16 v[146:147], v14 offset:26944
    v_max_u32 v17, v17, v71
    v_mfma_f32_16x16x32_bf16 v[116:119], v[168:171], v[52:55], v[116:119]
    ds_read_b64_tr_b16 v[148:149], v14 offset:25696
    ds_read_b64_tr_b16 v[150:151], v14 offset:26976
    v_cmp_eq_u32 vcc, -1, v17
    v_mfma_f32_16x16x32_bf16 v[120:123], v[172:175], v[52:55], v[120:123]
    ds_read_b64_tr_b16 v[152:153], v14 offset:25728
    ds_read_b64_tr_b16 v[154:155], v14 offset:27008
    s_waitcnt lgkmcnt(15)
    s_cbranch_vccnz concat_heads__mha_block__spectral_fnet__prompt_kernel_cs2
concat_heads__mha_block__spectral_fnet__prompt_kernel_cb2:
    v_mfma_f32_16x16x32_bf16 v[104:107], v[176:179], v[56:59], v[104:107]
    ds_read_b64_tr_b16 v[156:157], v14 offset:32000
    ds_read_b64_tr_b16 v[158:159], v14 offset:33280
    v_mfma_f32_16x16x32_bf16 v[108:111], v[180:183], v[56:59], v[108:111]
    ds_read_b64_tr_b16 v[160:161], v14 offset:32032
    ds_read_b64_tr_b16 v[162:163], v14 offset:33312
    v_mfma_f32_16x16x32_bf16 v[112:115], v[184:187], v[56:59], v[112:115]
    ds_read_b64_tr_b16 v[164:165], v14 offset:32064
    ds_read_b64_tr_b16 v[166:167], v14 offset:33344
    v_mfma_f32_16x16x32_bf16 v[116:119], v[188:191], v[56:59], v[116:119]
    ds_read_b64_tr_b16 v[168:169], v14 offset:32096
    ds_read_b64_tr_b16 v[170:171], v14 offset:33376
    v_mfma_f32_16x16x32_bf16 v[120:123], v[192:195], v[56:59], v[120:123]
    ds_read_b64_tr_b16 v[172:173], v14 offset:32128
    ds_read_b64_tr_b16 v[174:175], v14 offset:33408
    s_waitcnt lgkmcnt(15)
    v_mfma_f32_16x16x32_bf16 v[104:107], v[196:199], v[60:63], v[104:107]
    ds_read_b64_tr_b16 v[176:177], v14 offset:38400
    ds_read_b64_tr_b16 v[178:179], v14 offset:39680
    v_mfma_f32_16x16x32_bf16 v[108:111], v[200:203], v[60:63], v[108:111]
    ds_read_b64_tr_b16 v[180:181], v14 offset:38432
    ds_read_b64_tr_b16 v[182:183], v14 offset:39712
    v_mfma_f32_16x16x32_bf16 v[112:115], v[204:207], v[60:63], v[112:115]
    ds_read_b64_tr_b16 v[184:185], v14 offset:38464
    ds_read_b64_tr_b16 v[186:187], v14 offset:39744
    v_mfma_f32_16x16x32_bf16 v[116:119], v[208:211], v[60:63], v[116:119]
    ds_read_b64_tr_b16 v[188:189], v14 offset:38496
    ds_read_b64_tr_b16 v[190:191], v14 offset:39776
    v_mfma_f32_16x16x32_bf16 v[120:123], v[212:215], v[60:63], v[120:123]
    ds_read_b64_tr_b16 v[192:193], v14 offset:38528
    ds_read_b64_tr_b16 v[194:195], v14 offset:39808
    s_waitcnt vmcnt(4) lgkmcnt(15)
    v_mfma_f32_16x16x32_bf16 v[104:107], v[216:219], v[64:67], v[104:107]
    ds_read_b64_tr_b16 v[196:197], v14 offset:44800
    ds_read_b64_tr_b16 v[198:199], v14 offset:46080
    v_max3_u32 v17, v72, v73, v74
    v_mfma_f32_16x16x32_bf16 v[108:111], v[220:223], v[64:67], v[108:111]
    ds_read_b64_tr_b16 v[200:201], v14 offset:44832
    ds_read_b64_tr_b16 v[202:203], v14 offset:46112
    v_max3_u32 v17, v17, v75, v76
    v_mfma_f32_16x16x32_bf16 v[112:115], v[224:227], v[64:67], v[112:115]
    ds_read_b64_tr_b16 v[204:205], v14 offset:44864
    ds_read_b64_tr_b16 v[206:207], v14 offset:46144
    v_max3_u32 v17, v17, v77, v78
    v_mfma_f32_16x16x32_bf16 v[116:119], v[228:231], v[64:67], v[116:119]
    ds_read_b64_tr_b16 v[208:209], v14 offset:44896
    ds_read_b64_tr_b16 v[210:211], v14 offset:46176
    v_max3_u32 v17, v17, v79, v80
    v_mfma_f32_16x16x32_bf16 v[120:123], v[232:235], v[64:67], v[120:123]
    ds_read_b64_tr_b16 v[212:213], v14 offset:44928
    ds_read_b64_tr_b16 v[214:215], v14 offset:46208
    v_max3_u32 v17, v17, v81, v82
    s_waitcnt lgkmcnt(15)
    v_mfma_f32_16x16x32_bf16 v[104:107], v[236:239], v[68:71], v[104:107]
    ds_read_b64_tr_b16 v[216:217], v13 offset:0
    ds_read_b64_tr_b16 v[218:219], v13 offset:3200
    v_max3_u32 v17, v17, v83, v84
    v_mfma_f32_16x16x32_bf16 v[108:111], v[240:243], v[68:71], v[108:111]
    ds_read_b64_tr_b16 v[220:221], v13 offset:32
    ds_read_b64_tr_b16 v[222:223], v13 offset:3232
    v_max3_u32 v17, v17, v85, v86
    v_mfma_f32_16x16x32_bf16 v[112:115], v[244:247], v[68:71], v[112:115]
    ds_read_b64_tr_b16 v[224:225], v13 offset:64
    ds_read_b64_tr_b16 v[226:227], v13 offset:3264
    v_max_u32 v17, v17, v87
    v_mfma_f32_16x16x32_bf16 v[116:119], v[248:251], v[68:71], v[116:119]
    ds_read_b64_tr_b16 v[228:229], v13 offset:96
    ds_read_b64_tr_b16 v[230:231], v13 offset:3296
    v_cmp_eq_u32 vcc, -1, v17
    v_mfma_f32_16x16x32_bf16 v[120:123], v[252:255], v[68:71], v[120:123]
    ds_read_b64_tr_b16 v[232:233], v13 offset:128
    ds_read_b64_tr_b16 v[234:235], v13 offset:3328
    s_waitcnt lgkmcnt(15)
    s_cbranch_vccnz concat_heads__mha_block__spectral_fnet__prompt_kernel_cs3
concat_heads__mha_block__spectral_fnet__prompt_kernel_cb3:
    v_mfma_f32_16x16x32_bf16 v[104:107], v[136:139], v[72:75], v[104:107]
    ds_read_b64_tr_b16 v[236:237], v13 offset:25600
    ds_read_b64_tr_b16 v[238:239], v13 offset:28800
    v_mfma_f32_16x16x32_bf16 v[108:111], v[140:143], v[72:75], v[108:111]
    ds_read_b64_tr_b16 v[240:241], v13 offset:25632
    ds_read_b64_tr_b16 v[242:243], v13 offset:28832
    v_mfma_f32_16x16x32_bf16 v[112:115], v[144:147], v[72:75], v[112:115]
    ds_read_b64_tr_b16 v[244:245], v13 offset:25664
    ds_read_b64_tr_b16 v[246:247], v13 offset:28864
    v_mfma_f32_16x16x32_bf16 v[116:119], v[148:151], v[72:75], v[116:119]
    ds_read_b64_tr_b16 v[248:249], v13 offset:25696
    ds_read_b64_tr_b16 v[250:251], v13 offset:28896
    v_mfma_f32_16x16x32_bf16 v[120:123], v[152:155], v[72:75], v[120:123]
    ds_read_b64_tr_b16 v[252:253], v13 offset:25728
    ds_read_b64_tr_b16 v[254:255], v13 offset:28928
    s_waitcnt lgkmcnt(15)
    v_mfma_f32_16x16x32_bf16 v[104:107], v[156:159], v[76:79], v[104:107]
    ds_read_b64_tr_b16 v[136:137], v15 offset:0
    ds_read_b64_tr_b16 v[138:139], v15 offset:3200
    v_mfma_f32_16x16x32_bf16 v[108:111], v[160:163], v[76:79], v[108:111]
    ds_read_b64_tr_b16 v[140:141], v15 offset:32
    ds_read_b64_tr_b16 v[142:143], v15 offset:3232
    v_mfma_f32_16x16x32_bf16 v[112:115], v[164:167], v[76:79], v[112:115]
    ds_read_b64_tr_b16 v[144:145], v15 offset:64
    ds_read_b64_tr_b16 v[146:147], v15 offset:3264
    v_mfma_f32_16x16x32_bf16 v[116:119], v[168:171], v[76:79], v[116:119]
    ds_read_b64_tr_b16 v[148:149], v15 offset:96
    ds_read_b64_tr_b16 v[150:151], v15 offset:3296
    v_mfma_f32_16x16x32_bf16 v[120:123], v[172:175], v[76:79], v[120:123]
    ds_read_b64_tr_b16 v[152:153], v15 offset:128
    ds_read_b64_tr_b16 v[154:155], v15 offset:3328
    s_waitcnt vmcnt(0) lgkmcnt(15)
    v_mfma_f32_16x16x32_bf16 v[104:107], v[176:179], v[80:83], v[104:107]
    ds_read_b64_tr_b16 v[156:157], v15 offset:25600
    ds_read_b64_tr_b16 v[158:159], v15 offset:28800
    v_max3_u32 v17, v88, v89, v90
    v_mfma_f32_16x16x32_bf16 v[108:111], v[180:183], v[80:83], v[108:111]
    ds_read_b64_tr_b16 v[160:161], v15 offset:25632
    ds_read_b64_tr_b16 v[162:163], v15 offset:28832
    v_max3_u32 v17, v17, v91, v92
    v_mfma_f32_16x16x32_bf16 v[112:115], v[184:187], v[80:83], v[112:115]
    ds_read_b64_tr_b16 v[164:165], v15 offset:25664
    ds_read_b64_tr_b16 v[166:167], v15 offset:28864
    v_max3_u32 v17, v17, v93, v94
    v_mfma_f32_16x16x32_bf16 v[116:119], v[188:191], v[80:83], v[116:119]
    ds_read_b64_tr_b16 v[168:169], v15 offset:25696
    ds_read_b64_tr_b16 v[170:171], v15 offset:28896
    v_max3_u32 v17, v17, v95, v96
    v_mfma_f32_16x16x32_bf16 v[120:123], v[192:195], v[80:83], v[120:123]
    ds_read_b64_tr_b16 v[172:173], v15 offset:25728
    ds_read_b64_tr_b16 v[174:175], v15 offset:28928
    v_max3_u32 v17, v17, v97, v98
    s_waitcnt lgkmcnt(15)
    v_mfma_f32_16x16x32_bf16 v[104:107], v[196:199], v[84:87], v[104:107]
    v_max3_u32 v17, v17, v99, v100
    v_mfma_f32_16x16x32_bf16 v[108:111], v[200:203], v[84:87], v[108:111]
    v_max3_u32 v17, v17, v101, v102
    v_mfma_f32_16x16x32_bf16 v[112:115], v[204:207], v[84:87], v[112:115]
    v_max_u32 v17, v17, v103
    v_mfma_f32_16x16x32_bf16 v[116:119], v[208:211], v[84:87], v[116:119]
    v_cmp_eq_u32 vcc, -1, v17
    v_mfma_f32_16x16x32_bf16 v[120:123], v[212:215], v[84:87], v[120:123]
    s_waitcnt lgkmcnt(15)
    s_cbranch_vccnz concat_heads__mha_block__spectral_fnet__prompt_kernel_cs4
concat_heads__mha_block__spectral_fnet__prompt_kernel_cb4:
    v_mfma_f32_16x16x32_bf16 v[104:107], v[216:219], v[88:91], v[104:107]
    v_mfma_f32_16x16x32_bf16 v[108:111], v[220:223], v[88:91], v[108:111]
    v_mfma_f32_16x16x32_bf16 v[112:115], v[224:227], v[88:91], v[112:115]
    v_mfma_f32_16x16x32_bf16 v[116:119], v[228:231], v[88:91], v[116:119]
    v_mfma_f32_16x16x32_bf16 v[120:123], v[232:235], v[88:91], v[120:123]
    s_waitcnt lgkmcnt(15)
    v_mfma_f32_16x16x32_bf16 v[104:107], v[236:239], v[92:95], v[104:107]
    v_mfma_f32_16x16x32_bf16 v[108:111], v[240:243], v[92:95], v[108:111]
    v_mfma_f32_16x16x32_bf16 v[112:115], v[244:247], v[92:95], v[112:115]
    v_mfma_f32_16x16x32_bf16 v[116:119], v[248:251], v[92:95], v[116:119]
    v_mfma_f32_16x16x32_bf16 v[120:123], v[252:255], v[92:95], v[120:123]
    s_waitcnt lgkmcnt(10)
    v_mfma_f32_16x16x32_bf16 v[104:107], v[136:139], v[96:99], v[104:107]
    v_mfma_f32_16x16x32_bf16 v[108:111], v[140:143], v[96:99], v[108:111]
    v_mfma_f32_16x16x32_bf16 v[112:115], v[144:147], v[96:99], v[112:115]
    v_mfma_f32_16x16x32_bf16 v[116:119], v[148:151], v[96:99], v[116:119]
    v_mfma_f32_16x16x32_bf16 v[120:123], v[152:155], v[96:99], v[120:123]
    s_waitcnt lgkmcnt(0)
    v_mfma_f32_16x16x32_bf16 v[104:107], v[156:159], v[100:103], v[104:107]
    v_mfma_f32_16x16x32_bf16 v[108:111], v[160:163], v[100:103], v[108:111]
    v_mfma_f32_16x16x32_bf16 v[112:115], v[164:167], v[100:103], v[112:115]
    v_mfma_f32_16x16x32_bf16 v[116:119], v[168:171], v[100:103], v[116:119]
    v_mfma_f32_16x16x32_bf16 v[120:123], v[172:175], v[100:103], v[120:123]
    s_nop 4
    v_cvt_pk_bf16_f32 v104, v104, v105
    v_cvt_pk_bf16_f32 v105, v106, v107
    ds_write_b64 v16, v[104:105] offset:0
    v_cvt_pk_bf16_f32 v108, v108, v109
    v_cvt_pk_bf16_f32 v109, v110, v111
    ds_write_b64 v16, v[108:109] offset:32
    v_cvt_pk_bf16_f32 v112, v112, v113
    v_cvt_pk_bf16_f32 v113, v114, v115
    ds_write_b64 v16, v[112:113] offset:64
    v_cvt_pk_bf16_f32 v116, v116, v117
    v_cvt_pk_bf16_f32 v117, v118, v119
    ds_write_b64 v16, v[116:117] offset:96
    v_cvt_pk_bf16_f32 v120, v120, v121
    v_cvt_pk_bf16_f32 v121, v122, v123
    ds_write_b64 v16, v[120:121] offset:128
    s_waitcnt lgkmcnt(0)
    ds_read_b128 v[136:139], v9
    ds_read_b128 v[140:143], v10
    ds_read_b128 v[144:147], v11
    s_waitcnt lgkmcnt(2)
    buffer_store_dwordx4 v[136:139], v5, s[8:11], s41 offen
    s_waitcnt lgkmcnt(1)
    buffer_store_dwordx4 v[140:143], v6, s[8:11], s41 offen
    s_waitcnt lgkmcnt(0)
    buffer_store_dwordx4 v[144:147], v7, s[8:11], s41 offen
    s_endpgm
concat_heads__mha_block__spectral_fnet__prompt_kernel_cs0:
    s_mov_b32 s58, 0x4000
concat_heads__mha_block__spectral_fnet__prompt_kernel_csl0:
    s_waitcnt vmcnt(0)
    s_sleep 2
    buffer_load_dwordx4 v[24:27], v8, s[12:15], s48 offen offset:0 sc1
    buffer_load_dwordx4 v[28:31], v8, s[12:15], s48 offen offset:1024 sc1
    buffer_load_dwordx4 v[32:35], v8, s[12:15], s48 offen offset:2048 sc1
    buffer_load_dwordx4 v[36:39], v8, s[12:15], s48 offen offset:3072 sc1
    buffer_load_dwordx4 v[40:43], v8, s[12:15], s49 offen offset:0 sc1
    buffer_load_dwordx4 v[44:47], v8, s[12:15], s49 offen offset:1024 sc1
    buffer_load_dwordx4 v[48:51], v8, s[12:15], s49 offen offset:2048 sc1
    buffer_load_dwordx4 v[52:55], v8, s[12:15], s49 offen offset:3072 sc1
    buffer_load_dwordx4 v[56:59], v8, s[12:15], s50 offen offset:0 sc1
    buffer_load_dwordx4 v[60:63], v8, s[12:15], s50 offen offset:1024 sc1
    buffer_load_dwordx4 v[64:67], v8, s[12:15], s50 offen offset:2048 sc1
    buffer_load_dwordx4 v[68:71], v8, s[12:15], s50 offen offset:3072 sc1
    buffer_load_dwordx4 v[72:75], v8, s[12:15], s51 offen offset:0 sc1
    buffer_load_dwordx4 v[76:79], v8, s[12:15], s51 offen offset:1024 sc1
    buffer_load_dwordx4 v[80:83], v8, s[12:15], s51 offen offset:2048 sc1
    buffer_load_dwordx4 v[84:87], v8, s[12:15], s51 offen offset:3072 sc1
    buffer_load_dwordx4 v[88:91], v8, s[12:15], s52 offen offset:0 sc1
    buffer_load_dwordx4 v[92:95], v8, s[12:15], s52 offen offset:1024 sc1
    buffer_load_dwordx4 v[96:99], v8, s[12:15], s52 offen offset:2048 sc1
    buffer_load_dwordx4 v[100:103], v8, s[12:15], s52 offen offset:3072 sc1
    s_waitcnt vmcnt(16)
    v_max3_u32 v17, v24, v25, v26
    v_max3_u32 v17, v17, v27, v28
    v_max3_u32 v17, v17, v29, v30
    v_max3_u32 v17, v17, v31, v32
    v_max3_u32 v17, v17, v33, v34
    v_max3_u32 v17, v17, v35, v36
    v_max3_u32 v17, v17, v37, v38
    v_max_u32 v17, v17, v39
    v_cmp_eq_u32 vcc, -1, v17
    s_sub_u32 s58, s58, 1
    s_cbranch_scc1 concat_heads__mha_block__spectral_fnet__prompt_kernel_cb0
    s_cbranch_vccnz concat_heads__mha_block__spectral_fnet__prompt_kernel_csl0
    s_branch concat_heads__mha_block__spectral_fnet__prompt_kernel_cb0
concat_heads__mha_block__spectral_fnet__prompt_kernel_cs1:
    s_mov_b32 s58, 0x4000
concat_heads__mha_block__spectral_fnet__prompt_kernel_csl1:
    s_waitcnt vmcnt(0)
    s_sleep 2
    buffer_load_dwordx4 v[40:43], v8, s[12:15], s49 offen offset:0 sc1
    buffer_load_dwordx4 v[44:47], v8, s[12:15], s49 offen offset:1024 sc1
    buffer_load_dwordx4 v[48:51], v8, s[12:15], s49 offen offset:2048 sc1
    buffer_load_dwordx4 v[52:55], v8, s[12:15], s49 offen offset:3072 sc1
    buffer_load_dwordx4 v[56:59], v8, s[12:15], s50 offen offset:0 sc1
    buffer_load_dwordx4 v[60:63], v8, s[12:15], s50 offen offset:1024 sc1
    buffer_load_dwordx4 v[64:67], v8, s[12:15], s50 offen offset:2048 sc1
    buffer_load_dwordx4 v[68:71], v8, s[12:15], s50 offen offset:3072 sc1
    buffer_load_dwordx4 v[72:75], v8, s[12:15], s51 offen offset:0 sc1
    buffer_load_dwordx4 v[76:79], v8, s[12:15], s51 offen offset:1024 sc1
    buffer_load_dwordx4 v[80:83], v8, s[12:15], s51 offen offset:2048 sc1
    buffer_load_dwordx4 v[84:87], v8, s[12:15], s51 offen offset:3072 sc1
    buffer_load_dwordx4 v[88:91], v8, s[12:15], s52 offen offset:0 sc1
    buffer_load_dwordx4 v[92:95], v8, s[12:15], s52 offen offset:1024 sc1
    buffer_load_dwordx4 v[96:99], v8, s[12:15], s52 offen offset:2048 sc1
    buffer_load_dwordx4 v[100:103], v8, s[12:15], s52 offen offset:3072 sc1
    s_waitcnt vmcnt(12)
    v_max3_u32 v17, v40, v41, v42
    v_max3_u32 v17, v17, v43, v44
    v_max3_u32 v17, v17, v45, v46
    v_max3_u32 v17, v17, v47, v48
    v_max3_u32 v17, v17, v49, v50
    v_max3_u32 v17, v17, v51, v52
    v_max3_u32 v17, v17, v53, v54
    v_max_u32 v17, v17, v55
    v_cmp_eq_u32 vcc, -1, v17
    s_sub_u32 s58, s58, 1
    s_cbranch_scc1 concat_heads__mha_block__spectral_fnet__prompt_kernel_cb1
    s_cbranch_vccnz concat_heads__mha_block__spectral_fnet__prompt_kernel_csl1
    s_branch concat_heads__mha_block__spectral_fnet__prompt_kernel_cb1
concat_heads__mha_block__spectral_fnet__prompt_kernel_cs2:
    s_mov_b32 s58, 0x4000
concat_heads__mha_block__spectral_fnet__prompt_kernel_csl2:
    s_waitcnt vmcnt(0)
    s_sleep 2
    buffer_load_dwordx4 v[56:59], v8, s[12:15], s50 offen offset:0 sc1
    buffer_load_dwordx4 v[60:63], v8, s[12:15], s50 offen offset:1024 sc1
    buffer_load_dwordx4 v[64:67], v8, s[12:15], s50 offen offset:2048 sc1
    buffer_load_dwordx4 v[68:71], v8, s[12:15], s50 offen offset:3072 sc1
    buffer_load_dwordx4 v[72:75], v8, s[12:15], s51 offen offset:0 sc1
    buffer_load_dwordx4 v[76:79], v8, s[12:15], s51 offen offset:1024 sc1
    buffer_load_dwordx4 v[80:83], v8, s[12:15], s51 offen offset:2048 sc1
    buffer_load_dwordx4 v[84:87], v8, s[12:15], s51 offen offset:3072 sc1
    buffer_load_dwordx4 v[88:91], v8, s[12:15], s52 offen offset:0 sc1
    buffer_load_dwordx4 v[92:95], v8, s[12:15], s52 offen offset:1024 sc1
    buffer_load_dwordx4 v[96:99], v8, s[12:15], s52 offen offset:2048 sc1
    buffer_load_dwordx4 v[100:103], v8, s[12:15], s52 offen offset:3072 sc1
    s_waitcnt vmcnt(8)
    v_max3_u32 v17, v56, v57, v58
    v_max3_u32 v17, v17, v59, v60
    v_max3_u32 v17, v17, v61, v62
    v_max3_u32 v17, v17, v63, v64
    v_max3_u32 v17, v17, v65, v66
    v_max3_u32 v17, v17, v67, v68
    v_max3_u32 v17, v17, v69, v70
    v_max_u32 v17, v17, v71
    v_cmp_eq_u32 vcc, -1, v17
    s_sub_u32 s58, s58, 1
    s_cbranch_scc1 concat_heads__mha_block__spectral_fnet__prompt_kernel_cb2
    s_cbranch_vccnz concat_heads__mha_block__spectral_fnet__prompt_kernel_csl2
    s_branch concat_heads__mha_block__spectral_fnet__prompt_kernel_cb2
concat_heads__mha_block__spectral_fnet__prompt_kernel_cs3:
    s_mov_b32 s58, 0x4000
concat_heads__mha_block__spectral_fnet__prompt_kernel_csl3:
    s_waitcnt vmcnt(0)
    s_sleep 2
    buffer_load_dwordx4 v[72:75], v8, s[12:15], s51 offen offset:0 sc1
    buffer_load_dwordx4 v[76:79], v8, s[12:15], s51 offen offset:1024 sc1
    buffer_load_dwordx4 v[80:83], v8, s[12:15], s51 offen offset:2048 sc1
    buffer_load_dwordx4 v[84:87], v8, s[12:15], s51 offen offset:3072 sc1
    buffer_load_dwordx4 v[88:91], v8, s[12:15], s52 offen offset:0 sc1
    buffer_load_dwordx4 v[92:95], v8, s[12:15], s52 offen offset:1024 sc1
    buffer_load_dwordx4 v[96:99], v8, s[12:15], s52 offen offset:2048 sc1
    buffer_load_dwordx4 v[100:103], v8, s[12:15], s52 offen offset:3072 sc1
    s_waitcnt vmcnt(4)
    v_max3_u32 v17, v72, v73, v74
    v_max3_u32 v17, v17, v75, v76
    v_max3_u32 v17, v17, v77, v78
    v_max3_u32 v17, v17, v79, v80
    v_max3_u32 v17, v17, v81, v82
    v_max3_u32 v17, v17, v83, v84
    v_max3_u32 v17, v17, v85, v86
    v_max_u32 v17, v17, v87
    v_cmp_eq_u32 vcc, -1, v17
    s_sub_u32 s58, s58, 1
    s_cbranch_scc1 concat_heads__mha_block__spectral_fnet__prompt_kernel_cb3
    s_cbranch_vccnz concat_heads__mha_block__spectral_fnet__prompt_kernel_csl3
    s_branch concat_heads__mha_block__spectral_fnet__prompt_kernel_cb3
concat_heads__mha_block__spectral_fnet__prompt_kernel_cs4:
    s_mov_b32 s58, 0x4000
concat_heads__mha_block__spectral_fnet__prompt_kernel_csl4:
    s_waitcnt vmcnt(0)
    s_sleep 2
    buffer_load_dwordx4 v[88:91], v8, s[12:15], s52 offen offset:0 sc1
    buffer_load_dwordx4 v[92:95], v8, s[12:15], s52 offen offset:1024 sc1
    buffer_load_dwordx4 v[96:99], v8, s[12:15], s52 offen offset:2048 sc1
    buffer_load_dwordx4 v[100:103], v8, s[12:15], s52 offen offset:3072 sc1
    s_waitcnt vmcnt(0)
    v_max3_u32 v17, v88, v89, v90
    v_max3_u32 v17, v17, v91, v92
    v_max3_u32 v17, v17, v93, v94
    v_max3_u32 v17, v17, v95, v96
    v_max3_u32 v17, v17, v97, v98
    v_max3_u32 v17, v17, v99, v100
    v_max3_u32 v17, v17, v101, v102
    v_max_u32 v17, v17, v103
    v_cmp_eq_u32 vcc, -1, v17
    s_sub_u32 s58, s58, 1
    s_cbranch_scc1 concat_heads__mha_block__spectral_fnet__prompt_kernel_cb4
    s_cbranch_vccnz concat_heads__mha_block__spectral_fnet__prompt_kernel_csl4
    s_branch concat_heads__mha_block__spectral_fnet__prompt_kernel_cb4
concat_heads__mha_block__spectral_fnet__prompt_kernel_slow0:
    s_mov_b32 s58, 0x40000
concat_heads__mha_block__spectral_fnet__prompt_kernel_sw0:
    ds_read_b32 v8, v7 offset:1112
    s_waitcnt lgkmcnt(0)
    v_readfirstlane_b32 s17, v8
    s_sub_u32 s58, s58, 1
    s_cbranch_scc1 concat_heads__mha_block__spectral_fnet__prompt_kernel_sw0_x
    s_and_b32 s59, s17, 0xff
    s_cmp_lg_u32 s59, 0
    s_cbranch_scc0 concat_heads__mha_block__spectral_fnet__prompt_kernel_sw0
concat_heads__mha_block__spectral_fnet__prompt_kernel_sw0_x:
    s_branch concat_heads__mha_block__spectral_fnet__prompt_kernel_back0
concat_heads__mha_block__spectral_fnet__prompt_kernel_slow4:
    s_mov_b32 s58, 0x40000
concat_heads__mha_block__spectral_fnet__prompt_kernel_sw4:
    ds_read_b32 v8, v7 offset:1120
    s_waitcnt lgkmcnt(0)
    v_readfirstlane_b32 s17, v8
    s_sub_u32 s58, s58, 1
    s_cbranch_scc1 concat_heads__mha_block__spectral_fnet__prompt_kernel_sw4_x
    s_and_b32 s59, s17, 0xff
    s_cmp_lg_u32 s59, 0
    s_cbranch_scc0 concat_heads__mha_block__spectral_fnet__prompt_kernel_sw4
concat_heads__mha_block__spectral_fnet__prompt_kernel_sw4_x:
    s_branch concat_heads__mha_block__spectral_fnet__prompt_kernel_back4
concat_heads__mha_block__spectral_fnet__prompt_kernel_slow8:
    s_mov_b32 s58, 0x40000
concat_heads__mha_block__spectral_fnet__prompt_kernel_sw8:
    ds_read_b32 v8, v7 offset:1128
    s_waitcnt lgkmcnt(0)
    v_readfirstlane_b32 s17, v8
    s_sub_u32 s58, s58, 1
    s_cbranch_scc1 concat_heads__mha_block__spectral_fnet__prompt_kernel_sw8_x
    s_and_b32 s59, s17, 0xff
    s_cmp_lg_u32 s59, 0
    s_cbranch_scc0 concat_heads__mha_block__spectral_fnet__prompt_kernel_sw8
concat_heads__mha_block__spectral_fnet__prompt_kernel_sw8_x:
    s_branch concat_heads__mha_block__spectral_fnet__prompt_kernel_back8
concat_heads__mha_block__spectral_fnet__prompt_kernel_slow12:
    s_mov_b32 s58, 0x40000
concat_heads__mha_block__spectral_fnet__prompt_kernel_sw12:
    ds_read_b32 v8, v7 offset:1136
    s_waitcnt lgkmcnt(0)
    v_readfirstlane_b32 s17, v8
    s_sub_u32 s58, s58, 1
    s_cbranch_scc1 concat_heads__mha_block__spectral_fnet__prompt_kernel_sw12_x
    s_and_b32 s59, s17, 0xff
    s_cmp_lg_u32 s59, 0
    s_cbranch_scc0 concat_heads__mha_block__spectral_fnet__prompt_kernel_sw12
concat_heads__mha_block__spectral_fnet__prompt_kernel_sw12_x:
    s_branch concat_heads__mha_block__spectral_fnet__prompt_kernel_back12
concat_heads__mha_block__spectral_fnet__prompt_kernel_fallback:
    s_mov_b32 s26, 2
    s_mov_b32 s29, 0
    s_waitcnt vmcnt(0)
    s_mov_b64 exec, s[30:31]
    v_mov_b32 v32, 0
    v_mov_b32 v34, 0
    v_mov_b32 v36, 0
    v_mov_b32 v38, 0
    s_mov_b64 exec, -1
    v_mov_b32 v136, 0xff800000
    v_mov_b32 v137, 0xff800000
    v_mov_b32 v138, 0xff800000
    v_mov_b32 v139, 0xff800000
    s_and_b32 s18, s3, 1
    s_lshl_b32 s18, s18, 2
    v_mov_b32 v7, s18
    s_mov_b32 s11, 32
concat_heads__mha_block__spectral_fnet__prompt_kernel_fbloop:
    s_and_b32 s17, s11, 3
    s_cbranch_scc1 concat_heads__mha_block__spectral_fnet__prompt_kernel_fbsame
    ds_read_b32 v8, v7 offset:1104
    v_add_u32 v7, 8, v7
    s_waitcnt lgkmcnt(0)
    v_readfirstlane_b32 s10, v8
    s_nop 0
    s_sub_u32 s10, s10, 1
    s_nop 3
concat_heads__mha_block__spectral_fnet__prompt_kernel_fbsame:
    buffer_load_dwordx4 v[144:147], v1, s[12:15], s10 offen sc1
    buffer_load_dwordx2 v[160:161], v2, s[12:15], s10 offen sc1
    s_add_u32 s10, s10, 82048
    s_waitcnt vmcnt(0)
    v_mfma_f32_32x32x16_bf16 v[104:119], v[144:147], v[16:19], 0
    v_mfma_f32_32x32x8_bf16 v[104:119], v[160:161], v[32:33], v[104:119]
    s_nop 7
    s_nop 3
    v_max3_f32 v136, v136, v104, v105
    v_max3_f32 v136, v136, v106, v107
    v_max3_f32 v136, v136, v108, v109
    v_max3_f32 v136, v136, v110, v111
    v_max3_f32 v136, v136, v112, v113
    v_max3_f32 v136, v136, v114, v115
    v_max3_f32 v136, v136, v116, v117
    v_max3_f32 v136, v136, v118, v119
    v_mfma_f32_32x32x16_bf16 v[104:119], v[144:147], v[20:23], 0
    v_mfma_f32_32x32x8_bf16 v[104:119], v[160:161], v[34:35], v[104:119]
    s_nop 7
    s_nop 3
    v_max3_f32 v137, v137, v104, v105
    v_max3_f32 v137, v137, v106, v107
    v_max3_f32 v137, v137, v108, v109
    v_max3_f32 v137, v137, v110, v111
    v_max3_f32 v137, v137, v112, v113
    v_max3_f32 v137, v137, v114, v115
    v_max3_f32 v137, v137, v116, v117
    v_max3_f32 v137, v137, v118, v119
    v_mfma_f32_32x32x16_bf16 v[104:119], v[144:147], v[24:27], 0
    v_mfma_f32_32x32x8_bf16 v[104:119], v[160:161], v[36:37], v[104:119]
    s_nop 7
    s_nop 3
    v_max3_f32 v138, v138, v104, v105
    v_max3_f32 v138, v138, v106, v107
    v_max3_f32 v138, v138, v108, v109
    v_max3_f32 v138, v138, v110, v111
    v_max3_f32 v138, v138, v112, v113
    v_max3_f32 v138, v138, v114, v115
    v_max3_f32 v138, v138, v116, v117
    v_max3_f32 v138, v138, v118, v119
    v_mfma_f32_32x32x16_bf16 v[104:119], v[144:147], v[28:31], 0
    v_mfma_f32_32x32x8_bf16 v[104:119], v[160:161], v[38:39], v[104:119]
    s_nop 7
    s_nop 3
    v_max3_f32 v139, v139, v104, v105
    v_max3_f32 v139, v139, v106, v107
    v_max3_f32 v139, v139, v108, v109
    v_max3_f32 v139, v139, v110, v111
    v_max3_f32 v139, v139, v112, v113
    v_max3_f32 v139, v139, v114, v115
    v_max3_f32 v139, v139, v116, v117
    v_max3_f32 v139, v139, v118, v119
    s_sub_u32 s11, s11, 1
    s_cmp_lg_u32 s11, 0
    s_cbranch_scc1 concat_heads__mha_block__spectral_fnet__prompt_kernel_fbloop
    s_lshl_b32 s17, s3, 9
    v_add_u32 v13, s17, v6
    v_mov_b32 v10, v136
    s_nop 1
    v_permlane32_swap_b32 v136, v10
    v_max_f32 v136, v136, v10
    ds_write_b32 v13, v136 offset:2048
    v_mov_b32 v10, v137
    s_nop 1
    v_permlane32_swap_b32 v137, v10
    v_max_f32 v137, v137, v10
    ds_write_b32 v13, v137 offset:2176
    v_mov_b32 v10, v138
    s_nop 1
    v_permlane32_swap_b32 v138, v10
    v_max_f32 v138, v138, v10
    ds_write_b32 v13, v138 offset:2304
    v_mov_b32 v10, v139
    s_nop 1
    v_permlane32_swap_b32 v139, v10
    v_max_f32 v139, v139, v10
    ds_write_b32 v13, v139 offset:2432
    s_lshl_b32 s17, s3, 2
    v_mov_b32 v14, s17
    v_mov_b32 v15, 1
    s_waitcnt lgkmcnt(0)
    ds_write_b32 v14, v15 offset:1072
    v_xor_b32 v14, 4, v14
    v_xor_b32 v13, 512, v13
    s_mov_b32 s58, 0x40000
concat_heads__mha_block__spectral_fnet__prompt_kernel_fbw:
    ds_read_b32 v10, v14 offset:1072
    s_waitcnt lgkmcnt(0)
    v_readfirstlane_b32 s17, v10
    s_sub_u32 s58, s58, 1
    s_cbranch_scc1 concat_heads__mha_block__spectral_fnet__prompt_kernel_fbw_x
    s_and_b32 s59, s17, 0xff
    s_cmp_eq_u32 s59, 1
    s_cbranch_scc0 concat_heads__mha_block__spectral_fnet__prompt_kernel_fbw
concat_heads__mha_block__spectral_fnet__prompt_kernel_fbw_x:
    ds_read_b32 v140, v13 offset:2048
    ds_read_b32 v141, v13 offset:2176
    ds_read_b32 v142, v13 offset:2304
    ds_read_b32 v143, v13 offset:2432
    s_waitcnt lgkmcnt(0)
    v_max_f32 v136, v136, v140
    v_sub_f32 v136, s29, v136
    v_cvt_pk_bf16_f32 v10, v136, v136
    v_and_b32 v10, 0xffff0000, v10
    v_sub_f32 v10, v136, v10
    v_cvt_pk_bf16_f32 v136, v136, v10
    v_cndmask_b32 v32, v32, v136, s[30:31]
    v_max_f32 v137, v137, v141
    v_sub_f32 v137, s29, v137
    v_cvt_pk_bf16_f32 v10, v137, v137
    v_and_b32 v10, 0xffff0000, v10
    v_sub_f32 v10, v137, v10
    v_cvt_pk_bf16_f32 v137, v137, v10
    v_cndmask_b32 v34, v34, v137, s[30:31]
    v_max_f32 v138, v138, v142
    v_sub_f32 v138, s29, v138
    v_cvt_pk_bf16_f32 v10, v138, v138
    v_and_b32 v10, 0xffff0000, v10
    v_sub_f32 v10, v138, v10
    v_cvt_pk_bf16_f32 v138, v138, v10
    v_cndmask_b32 v36, v36, v138, s[30:31]
    v_max_f32 v139, v139, v143
    v_sub_f32 v139, s29, v139
    v_cvt_pk_bf16_f32 v10, v139, v139
    v_and_b32 v10, 0xffff0000, v10
    v_sub_f32 v10, v139, v10
    v_cvt_pk_bf16_f32 v139, v139, v10
    v_cndmask_b32 v38, v38, v139, s[30:31]
    v_mov_b32 v7, s18
    s_mov_b32 s10, s9
    buffer_load_dwordx4 v[144:147], v1, s[12:15], s10 offen sc1
    buffer_load_dwordx2 v[160:161], v2, s[12:15], s10 offen sc1
    buffer_load_dwordx4 v[168:171], v3, s[12:15], s10 offen sc1
    buffer_load_dwordx4 v[184:187], v4, s[12:15], s10 offen sc1
    s_add_u32 s10, s10, 82048
    buffer_load_dwordx4 v[148:151], v1, s[12:15], s10 offen sc1
    buffer_load_dwordx2 v[162:163], v2, s[12:15], s10 offen sc1
    buffer_load_dwordx4 v[172:175], v3, s[12:15], s10 offen sc1
    buffer_load_dwordx4 v[188:191], v4, s[12:15], s10 offen sc1
    s_add_u32 s10, s10, 82048
    buffer_load_dwordx4 v[152:155], v1, s[12:15], s10 offen sc1
    buffer_load_dwordx2 v[164:165], v2, s[12:15], s10 offen sc1
    buffer_load_dwordx4 v[176:179], v3, s[12:15], s10 offen sc1
    buffer_load_dwordx4 v[192:195], v4, s[12:15], s10 offen sc1
    s_add_u32 s10, s10, 82048
    v_mov_b32 v40, 0
    v_mov_b32 v41, 0
    v_mov_b32 v42, 0
    v_mov_b32 v43, 0
    v_mov_b32 v44, 0
    v_mov_b32 v45, 0
    v_mov_b32 v46, 0
    v_mov_b32 v47, 0
    v_mov_b32 v48, 0
    v_mov_b32 v49, 0
    v_mov_b32 v50, 0
    v_mov_b32 v51, 0
    v_mov_b32 v52, 0
    v_mov_b32 v53, 0
    v_mov_b32 v54, 0
    v_mov_b32 v55, 0
    v_mov_b32 v56, 0
    v_mov_b32 v57, 0
    v_mov_b32 v58, 0
    v_mov_b32 v59, 0
    v_mov_b32 v60, 0
    v_mov_b32 v61, 0
    v_mov_b32 v62, 0
    v_mov_b32 v63, 0
    v_mov_b32 v64, 0
    v_mov_b32 v65, 0
    v_mov_b32 v66, 0
    v_mov_b32 v67, 0
    v_mov_b32 v68, 0
    v_mov_b32 v69, 0
    v_mov_b32 v70, 0
    v_mov_b32 v71, 0
    v_mov_b32 v72, 0
    v_mov_b32 v73, 0
    v_mov_b32 v74, 0
    v_mov_b32 v75, 0
    v_mov_b32 v76, 0
    v_mov_b32 v77, 0
    v_mov_b32 v78, 0
    v_mov_b32 v79, 0
    v_mov_b32 v80, 0
    v_mov_b32 v81, 0
    v_mov_b32 v82, 0
    v_mov_b32 v83, 0
    v_mov_b32 v84, 0
    v_mov_b32 v85, 0
    v_mov_b32 v86, 0
    v_mov_b32 v87, 0
    v_mov_b32 v88, 0
    v_mov_b32 v89, 0
    v_mov_b32 v90, 0
    v_mov_b32 v91, 0
    v_mov_b32 v92, 0
    v_mov_b32 v93, 0
    v_mov_b32 v94, 0
    v_mov_b32 v95, 0
    v_mov_b32 v96, 0
    v_mov_b32 v97, 0
    v_mov_b32 v98, 0
    v_mov_b32 v99, 0
    v_mov_b32 v100, 0
    v_mov_b32 v101, 0
    v_mov_b32 v102, 0
    v_mov_b32 v103, 0
    v_mov_b32 v140, 0
    v_mov_b32 v141, 0
    v_mov_b32 v142, 0
    v_mov_b32 v143, 0
    v_mov_b32 v196, 0
    v_mov_b32 v197, 0
    v_mov_b32 v198, 0
    v_mov_b32 v199, 0
    s_branch concat_heads__mha_block__spectral_fnet__prompt_kernel_start
concat_heads__mha_block__spectral_fnet__prompt_kernel_helper:
    s_load_dwordx2 s[48:49], s[0:1], 64
    s_load_dwordx2 s[4:5], s[0:1], 16
    s_sub_u32 s9, s3, 4
    v_lshlrev_b32 v9, 4, v0
    v_mov_b32 v245, 0x80000000
    s_mov_b32 s50, 5242880
    s_mov_b32 s51, 0x00020000
    s_mov_b32 s6, 819200
    s_mov_b32 s7, 0x00020000
    s_cmp_lg_u32 s3, 5
    s_cbranch_scc1 concat_heads__mha_block__spectral_fnet__prompt_kernel_h_nodoor
    s_and_b32 s16, s2, 7
    s_bfe_u32 s17, s2, 0x10003
    s_lshl_b32 s16, s16, 15
    s_lshl_b32 s17, s17, 14
    s_add_u32 s16, s16, s17
    s_add_u32 s16, s16, 0x2000000
    s_lshr_b32 s17, s2, 4
    s_lshl_b32 s17, s17, 8
    v_min_u32 v1, 48, v0
    v_lshlrev_b32 v1, 8, v1
    v_mov_b32 v2, s17
    v_cmp_gt_u32 vcc, 16, v0
    s_mov_b32 s18, 0
    s_mov_b32 s19, 1104
    v_cndmask_b32 v1, v1, v2, vcc
    s_mov_b32 s58, 0x4000
concat_heads__mha_block__spectral_fnet__prompt_kernel_h_door:
    buffer_load_dword v10, v1, s[12:15], s16 offen sc0 sc1
    buffer_load_dword v11, v1, s[12:15], s16 offen offset:128 sc0 sc1
    s_waitcnt vmcnt(0)
    v_cmp_eq_u32 vcc, s96, v10
    v_cmp_eq_u32 s[56:57], s96, v11
    s_nop 0
    s_and_b64 s[56:57], s[56:57], vcc
    s_lshr_b32 s20, s57, 16
    s_and_b32 s20, s20, s56
    s_bitcmp1_b32 s20, 0
    s_cbranch_scc0 concat_heads__mha_block__spectral_fnet__prompt_kernel_h_doorz
    s_lshr_b32 s20, s56, 16
    s_and_b32 s20, s20, s57
    s_andn2_b32 s21, s20, s18
    s_cbranch_scc0 concat_heads__mha_block__spectral_fnet__prompt_kernel_h_doorz
    s_or_b32 s18, s18, s20
concat_heads__mha_block__spectral_fnet__prompt_kernel_h_doorn:
    s_ff1_i32_b32 s20, s21
    s_bitset0_b32 s21, s20
    s_mul_i32 s20, s20, 328192
    s_add_u32 s20, s20, 0x300001
    v_mov_b32 v3, s19
    v_mov_b32 v4, s20
    ds_write_b32 v3, v4
    s_cmp_lg_u32 s19, 1104
    s_cbranch_scc1 concat_heads__mha_block__spectral_fnet__prompt_kernel_h_doorm
    ds_write_b32 v3, v4 offset:64
    ds_write_b32 v3, v4 offset:68
concat_heads__mha_block__spectral_fnet__prompt_kernel_h_doorm:
    s_add_u32 s19, s19, 4
    s_cmp_lg_u32 s21, 0
    s_cbranch_scc1 concat_heads__mha_block__spectral_fnet__prompt_kernel_h_doorn
    s_cmp_eq_u32 s18, 0xffff
    s_cbranch_scc1 concat_heads__mha_block__spectral_fnet__prompt_kernel_h_nodoor
concat_heads__mha_block__spectral_fnet__prompt_kernel_h_doorz:
    s_sleep 10
    s_sub_u32 s58, s58, 1
    s_cbranch_scc0 concat_heads__mha_block__spectral_fnet__prompt_kernel_h_door
concat_heads__mha_block__spectral_fnet__prompt_kernel_h_nodoor:
    v_mov_b32 v12, s96
    v_mov_b32 v13, s96
    v_mov_b32 v14, s96
    v_mov_b32 v15, s96
    s_cmp_ge_u32 s38, 340
    s_cbranch_scc1 concat_heads__mha_block__spectral_fnet__prompt_kernel_h_nof0
    s_waitcnt vmcnt(0)
    ds_read_b128 v[16:19], v204 offset:0
    ds_read_b128 v[20:23], v204 offset:1024
    ds_read_b128 v[24:27], v204 offset:2048
    ds_read_b128 v[28:31], v204 offset:3072
    ds_read_b128 v[32:35], v204 offset:4096
    ds_read_b128 v[36:39], v204 offset:5120
    ds_read_b128 v[40:43], v204 offset:6144
    ds_read_b128 v[44:47], v204 offset:7168
    s_waitcnt lgkmcnt(0)
    v_lshlrev_b32 v48, 16, v16
    v_and_b32 v49, 0xffff0000, v16
    v_lshlrev_b32 v50, 16, v20
    v_and_b32 v51, 0xffff0000, v20
    v_lshlrev_b32 v52, 16, v24
    v_and_b32 v53, 0xffff0000, v24
    v_lshlrev_b32 v54, 16, v28
    v_and_b32 v55, 0xffff0000, v28
    v_lshlrev_b32 v56, 16, v32
    v_and_b32 v57, 0xffff0000, v32
    v_lshlrev_b32 v58, 16, v36
    v_and_b32 v59, 0xffff0000, v36
    v_lshlrev_b32 v60, 16, v40
    v_and_b32 v61, 0xffff0000, v40
    v_lshlrev_b32 v62, 16, v44
    v_and_b32 v63, 0xffff0000, v44
    v_pk_add_f32 v[64:65], v[48:49], v[50:51]
    v_pk_add_f32 v[66:67], v[48:49], v[50:51] neg_lo:[0,1] neg_hi:[0,1]
    v_pk_add_f32 v[68:69], v[52:53], v[54:55]
    v_pk_add_f32 v[70:71], v[52:53], v[54:55] neg_lo:[0,1] neg_hi:[0,1]
    v_pk_add_f32 v[72:73], v[56:57], v[58:59]
    v_pk_add_f32 v[74:75], v[56:57], v[58:59] neg_lo:[0,1] neg_hi:[0,1]
    v_pk_add_f32 v[76:77], v[60:61], v[62:63]
    v_pk_add_f32 v[78:79], v[60:61], v[62:63] neg_lo:[0,1] neg_hi:[0,1]
    v_pk_add_f32 v[48:49], v[64:65], v[68:69]
    v_pk_add_f32 v[50:51], v[72:73], v[76:77]
    v_pk_add_f32 v[52:53], v[64:65], v[68:69] neg_lo:[0,1] neg_hi:[0,1]
    v_pk_add_f32 v[54:55], v[72:73], v[76:77] neg_lo:[0,1] neg_hi:[0,1]
    v_pk_add_f32 v[56:57], v[66:67], v[70:71]
    v_pk_add_f32 v[58:59], v[74:75], v[78:79]
    v_pk_add_f32 v[60:61], v[66:67], v[70:71] neg_lo:[0,1] neg_hi:[0,1]
    v_pk_add_f32 v[62:63], v[74:75], v[78:79] neg_lo:[0,1] neg_hi:[0,1]
    v_pk_add_f32 v[64:65], v[48:49], v[50:51]
    v_pk_add_f32 v[68:69], v[48:49], v[50:51] neg_lo:[0,1] neg_hi:[0,1]
    v_pk_add_f32 v[72:73], v[52:53], v[54:55] neg_lo:[0,1] neg_hi:[0,1]
    v_pk_add_f32 v[76:77], v[52:53], v[54:55]
    v_pk_add_f32 v[66:67], v[56:57], v[58:59]
    v_pk_add_f32 v[70:71], v[56:57], v[58:59] neg_lo:[0,1] neg_hi:[0,1]
    v_pk_add_f32 v[74:75], v[60:61], v[62:63] neg_lo:[0,1] neg_hi:[0,1]
    v_pk_add_f32 v[78:79], v[60:61], v[62:63]
    v_cvt_pk_bf16_f32 v80, v64, v65
    v_cvt_pk_bf16_f32 v84, v66, v67
    v_cvt_pk_bf16_f32 v88, v68, v69
    v_cvt_pk_bf16_f32 v92, v70, v71
    v_cvt_pk_bf16_f32 v96, v72, v73
    v_cvt_pk_bf16_f32 v100, v74, v75
    v_cvt_pk_bf16_f32 v104, v76, v77
    v_cvt_pk_bf16_f32 v108, v78, v79
    v_lshlrev_b32 v48, 16, v17
    v_and_b32 v49, 0xffff0000, v17
    v_lshlrev_b32 v50, 16, v21
    v_and_b32 v51, 0xffff0000, v21
    v_lshlrev_b32 v52, 16, v25
    v_and_b32 v53, 0xffff0000, v25
    v_lshlrev_b32 v54, 16, v29
    v_and_b32 v55, 0xffff0000, v29
    v_lshlrev_b32 v56, 16, v33
    v_and_b32 v57, 0xffff0000, v33
    v_lshlrev_b32 v58, 16, v37
    v_and_b32 v59, 0xffff0000, v37
    v_lshlrev_b32 v60, 16, v41
    v_and_b32 v61, 0xffff0000, v41
    v_lshlrev_b32 v62, 16, v45
    v_and_b32 v63, 0xffff0000, v45
    v_pk_add_f32 v[64:65], v[48:49], v[50:51]
    v_pk_add_f32 v[66:67], v[48:49], v[50:51] neg_lo:[0,1] neg_hi:[0,1]
    v_pk_add_f32 v[68:69], v[52:53], v[54:55]
    v_pk_add_f32 v[70:71], v[52:53], v[54:55] neg_lo:[0,1] neg_hi:[0,1]
    v_pk_add_f32 v[72:73], v[56:57], v[58:59]
    v_pk_add_f32 v[74:75], v[56:57], v[58:59] neg_lo:[0,1] neg_hi:[0,1]
    v_pk_add_f32 v[76:77], v[60:61], v[62:63]
    v_pk_add_f32 v[78:79], v[60:61], v[62:63] neg_lo:[0,1] neg_hi:[0,1]
    v_pk_add_f32 v[48:49], v[64:65], v[68:69]
    v_pk_add_f32 v[50:51], v[72:73], v[76:77]
    v_pk_add_f32 v[52:53], v[64:65], v[68:69] neg_lo:[0,1] neg_hi:[0,1]
    v_pk_add_f32 v[54:55], v[72:73], v[76:77] neg_lo:[0,1] neg_hi:[0,1]
    v_pk_add_f32 v[56:57], v[66:67], v[70:71]
    v_pk_add_f32 v[58:59], v[74:75], v[78:79]
    v_pk_add_f32 v[60:61], v[66:67], v[70:71] neg_lo:[0,1] neg_hi:[0,1]
    v_pk_add_f32 v[62:63], v[74:75], v[78:79] neg_lo:[0,1] neg_hi:[0,1]
    v_pk_add_f32 v[64:65], v[48:49], v[50:51]
    v_pk_add_f32 v[68:69], v[48:49], v[50:51] neg_lo:[0,1] neg_hi:[0,1]
    v_pk_add_f32 v[72:73], v[52:53], v[54:55] neg_lo:[0,1] neg_hi:[0,1]
    v_pk_add_f32 v[76:77], v[52:53], v[54:55]
    v_pk_add_f32 v[66:67], v[56:57], v[58:59]
    v_pk_add_f32 v[70:71], v[56:57], v[58:59] neg_lo:[0,1] neg_hi:[0,1]
    v_pk_add_f32 v[74:75], v[60:61], v[62:63] neg_lo:[0,1] neg_hi:[0,1]
    v_pk_add_f32 v[78:79], v[60:61], v[62:63]
    v_cvt_pk_bf16_f32 v81, v64, v65
    v_cvt_pk_bf16_f32 v85, v66, v67
    v_cvt_pk_bf16_f32 v89, v68, v69
    v_cvt_pk_bf16_f32 v93, v70, v71
    v_cvt_pk_bf16_f32 v97, v72, v73
    v_cvt_pk_bf16_f32 v101, v74, v75
    v_cvt_pk_bf16_f32 v105, v76, v77
    v_cvt_pk_bf16_f32 v109, v78, v79
    v_lshlrev_b32 v48, 16, v18
    v_and_b32 v49, 0xffff0000, v18
    v_lshlrev_b32 v50, 16, v22
    v_and_b32 v51, 0xffff0000, v22
    v_lshlrev_b32 v52, 16, v26
    v_and_b32 v53, 0xffff0000, v26
    v_lshlrev_b32 v54, 16, v30
    v_and_b32 v55, 0xffff0000, v30
    v_lshlrev_b32 v56, 16, v34
    v_and_b32 v57, 0xffff0000, v34
    v_lshlrev_b32 v58, 16, v38
    v_and_b32 v59, 0xffff0000, v38
    v_lshlrev_b32 v60, 16, v42
    v_and_b32 v61, 0xffff0000, v42
    v_lshlrev_b32 v62, 16, v46
    v_and_b32 v63, 0xffff0000, v46
    v_pk_add_f32 v[64:65], v[48:49], v[50:51]
    v_pk_add_f32 v[66:67], v[48:49], v[50:51] neg_lo:[0,1] neg_hi:[0,1]
    v_pk_add_f32 v[68:69], v[52:53], v[54:55]
    v_pk_add_f32 v[70:71], v[52:53], v[54:55] neg_lo:[0,1] neg_hi:[0,1]
    v_pk_add_f32 v[72:73], v[56:57], v[58:59]
    v_pk_add_f32 v[74:75], v[56:57], v[58:59] neg_lo:[0,1] neg_hi:[0,1]
    v_pk_add_f32 v[76:77], v[60:61], v[62:63]
    v_pk_add_f32 v[78:79], v[60:61], v[62:63] neg_lo:[0,1] neg_hi:[0,1]
    v_pk_add_f32 v[48:49], v[64:65], v[68:69]
    v_pk_add_f32 v[50:51], v[72:73], v[76:77]
    v_pk_add_f32 v[52:53], v[64:65], v[68:69] neg_lo:[0,1] neg_hi:[0,1]
    v_pk_add_f32 v[54:55], v[72:73], v[76:77] neg_lo:[0,1] neg_hi:[0,1]
    v_pk_add_f32 v[56:57], v[66:67], v[70:71]
    v_pk_add_f32 v[58:59], v[74:75], v[78:79]
    v_pk_add_f32 v[60:61], v[66:67], v[70:71] neg_lo:[0,1] neg_hi:[0,1]
    v_pk_add_f32 v[62:63], v[74:75], v[78:79] neg_lo:[0,1] neg_hi:[0,1]
    v_pk_add_f32 v[64:65], v[48:49], v[50:51]
    v_pk_add_f32 v[68:69], v[48:49], v[50:51] neg_lo:[0,1] neg_hi:[0,1]
    v_pk_add_f32 v[72:73], v[52:53], v[54:55] neg_lo:[0,1] neg_hi:[0,1]
    v_pk_add_f32 v[76:77], v[52:53], v[54:55]
    v_pk_add_f32 v[66:67], v[56:57], v[58:59]
    v_pk_add_f32 v[70:71], v[56:57], v[58:59] neg_lo:[0,1] neg_hi:[0,1]
    v_pk_add_f32 v[74:75], v[60:61], v[62:63] neg_lo:[0,1] neg_hi:[0,1]
    v_pk_add_f32 v[78:79], v[60:61], v[62:63]
    v_cvt_pk_bf16_f32 v82, v64, v65
    v_cvt_pk_bf16_f32 v86, v66, v67
    v_cvt_pk_bf16_f32 v90, v68, v69
    v_cvt_pk_bf16_f32 v94, v70, v71
    v_cvt_pk_bf16_f32 v98, v72, v73
    v_cvt_pk_bf16_f32 v102, v74, v75
    v_cvt_pk_bf16_f32 v106, v76, v77
    v_cvt_pk_bf16_f32 v110, v78, v79
    v_lshlrev_b32 v48, 16, v19
    v_and_b32 v49, 0xffff0000, v19
    v_lshlrev_b32 v50, 16, v23
    v_and_b32 v51, 0xffff0000, v23
    v_lshlrev_b32 v52, 16, v27
    v_and_b32 v53, 0xffff0000, v27
    v_lshlrev_b32 v54, 16, v31
    v_and_b32 v55, 0xffff0000, v31
    v_lshlrev_b32 v56, 16, v35
    v_and_b32 v57, 0xffff0000, v35
    v_lshlrev_b32 v58, 16, v39
    v_and_b32 v59, 0xffff0000, v39
    v_lshlrev_b32 v60, 16, v43
    v_and_b32 v61, 0xffff0000, v43
    v_lshlrev_b32 v62, 16, v47
    v_and_b32 v63, 0xffff0000, v47
    v_pk_add_f32 v[64:65], v[48:49], v[50:51]
    v_pk_add_f32 v[66:67], v[48:49], v[50:51] neg_lo:[0,1] neg_hi:[0,1]
    v_pk_add_f32 v[68:69], v[52:53], v[54:55]
    v_pk_add_f32 v[70:71], v[52:53], v[54:55] neg_lo:[0,1] neg_hi:[0,1]
    v_pk_add_f32 v[72:73], v[56:57], v[58:59]
    v_pk_add_f32 v[74:75], v[56:57], v[58:59] neg_lo:[0,1] neg_hi:[0,1]
    v_pk_add_f32 v[76:77], v[60:61], v[62:63]
    v_pk_add_f32 v[78:79], v[60:61], v[62:63] neg_lo:[0,1] neg_hi:[0,1]
    v_pk_add_f32 v[48:49], v[64:65], v[68:69]
    v_pk_add_f32 v[50:51], v[72:73], v[76:77]
    v_pk_add_f32 v[52:53], v[64:65], v[68:69] neg_lo:[0,1] neg_hi:[0,1]
    v_pk_add_f32 v[54:55], v[72:73], v[76:77] neg_lo:[0,1] neg_hi:[0,1]
    v_pk_add_f32 v[56:57], v[66:67], v[70:71]
    v_pk_add_f32 v[58:59], v[74:75], v[78:79]
    v_pk_add_f32 v[60:61], v[66:67], v[70:71] neg_lo:[0,1] neg_hi:[0,1]
    v_pk_add_f32 v[62:63], v[74:75], v[78:79] neg_lo:[0,1] neg_hi:[0,1]
    v_pk_add_f32 v[64:65], v[48:49], v[50:51]
    v_pk_add_f32 v[68:69], v[48:49], v[50:51] neg_lo:[0,1] neg_hi:[0,1]
    v_pk_add_f32 v[72:73], v[52:53], v[54:55] neg_lo:[0,1] neg_hi:[0,1]
    v_pk_add_f32 v[76:77], v[52:53], v[54:55]
    v_pk_add_f32 v[66:67], v[56:57], v[58:59]
    v_pk_add_f32 v[70:71], v[56:57], v[58:59] neg_lo:[0,1] neg_hi:[0,1]
    v_pk_add_f32 v[74:75], v[60:61], v[62:63] neg_lo:[0,1] neg_hi:[0,1]
    v_pk_add_f32 v[78:79], v[60:61], v[62:63]
    v_cvt_pk_bf16_f32 v83, v64, v65
    v_cvt_pk_bf16_f32 v87, v66, v67
    v_cvt_pk_bf16_f32 v91, v68, v69
    v_cvt_pk_bf16_f32 v95, v70, v71
    v_cvt_pk_bf16_f32 v99, v72, v73
    v_cvt_pk_bf16_f32 v103, v74, v75
    v_cvt_pk_bf16_f32 v107, v76, v77
    v_cvt_pk_bf16_f32 v111, v78, v79
    s_sub_u32 s57, s3, 4
    s_lshl_b32 s57, s57, 2
    v_mov_b32 v6, s57
    s_mov_b32 s58, 0x20000
concat_heads__mha_block__spectral_fnet__prompt_kernel_h_h0:
    s_sleep 4
    ds_read_b32 v7, v6 offset:1040
    s_waitcnt lgkmcnt(0)
    v_readfirstlane_b32 s57, v7
    s_sub_u32 s58, s58, 1
    s_cbranch_scc1 concat_heads__mha_block__spectral_fnet__prompt_kernel_h_h0_x
    s_cmp_eq_u32 s57, 0
    s_cbranch_scc1 concat_heads__mha_block__spectral_fnet__prompt_kernel_h_h0
concat_heads__mha_block__spectral_fnet__prompt_kernel_h_h0_x:
    buffer_store_dwordx4 v[80:83], v205, s[12:15], s55 offen sc1
    s_add_u32 s55, s55, 348160
    buffer_store_dwordx4 v[84:87], v205, s[12:15], s55 offen sc1
    s_add_u32 s55, s55, 348160
    buffer_store_dwordx4 v[88:91], v205, s[12:15], s55 offen sc1
    s_add_u32 s55, s55, 348160
    buffer_store_dwordx4 v[92:95], v205, s[12:15], s55 offen sc1
    s_add_u32 s55, s55, 348160
    buffer_store_dwordx4 v[96:99], v205, s[12:15], s55 offen sc1
    s_add_u32 s55, s55, 348160
    buffer_store_dwordx4 v[100:103], v205, s[12:15], s55 offen sc1
    s_add_u32 s55, s55, 348160
    buffer_store_dwordx4 v[104:107], v205, s[12:15], s55 offen sc1
    s_add_u32 s55, s55, 348160
    buffer_store_dwordx4 v[108:111], v205, s[12:15], s55 offen sc1
    s_waitcnt vmcnt(0)
    s_mov_b64 exec, 0xff
    buffer_store_dwordx4 v[12:15], v9, s[12:15], s54 offen offset:0 sc1
    s_mov_b64 exec, -1
concat_heads__mha_block__spectral_fnet__prompt_kernel_h_nof0:
    s_sub_u32 s57, s3, 4
    s_lshl_b32 s57, s57, 2
    v_mov_b32 v6, s57
    s_mov_b32 s58, 0x20000
concat_heads__mha_block__spectral_fnet__prompt_kernel_h_h3:
    s_sleep 4
    ds_read_b32 v7, v6 offset:1040
    s_waitcnt lgkmcnt(0)
    v_readfirstlane_b32 s57, v7
    s_sub_u32 s58, s58, 1
    s_cbranch_scc1 concat_heads__mha_block__spectral_fnet__prompt_kernel_h_h3_x
    s_cmp_eq_u32 s57, 0
    s_cbranch_scc1 concat_heads__mha_block__spectral_fnet__prompt_kernel_h_h3
concat_heads__mha_block__spectral_fnet__prompt_kernel_h_h3_x:
    s_cmp_ge_u32 s52, 1089
    s_cbranch_scc1 concat_heads__mha_block__spectral_fnet__prompt_kernel_h_not
    buffer_store_dwordx4 v[208:211], v9, s[12:15], s53 offen sc1
    buffer_store_dwordx4 v[212:215], v9, s[12:15], s53 offen offset:1024 sc1
    s_lshl_b32 s16, s52, 7
    s_add_u32 s16, s16, 0x2090000
    s_waitcnt vmcnt(0)
    s_mov_b64 exec, 0xff
    buffer_store_dwordx4 v[12:15], v9, s[12:15], s16 offen offset:0 sc1
    s_mov_b64 exec, -1
concat_heads__mha_block__spectral_fnet__prompt_kernel_h_not:
    s_mov_b64 exec, -1
    s_waitcnt lgkmcnt(0)
    s_and_b32 s16, s2, 7
    s_lshr_b32 s17, s2, 3
    s_cmp_ge_u32 s9, 2
    s_cbranch_scc1 concat_heads__mha_block__spectral_fnet__prompt_kernel_h_g2
    s_lshl_b32 s18, s9, 5
    s_add_u32 s17, s17, s18
    v_add_u32 v1, 0, v0
    v_mul_u32_u24 v2, 6554, v1
    v_lshrrev_b32 v2, 16, v2
    v_mul_u32_u24 v2, 1120, v2
    v_lshl_add_u32 v216, v1, 4, v2
    v_add_u32 v1, 64, v0
    v_mul_u32_u24 v2, 6554, v1
    v_lshrrev_b32 v2, 16, v2
    v_mul_u32_u24 v2, 1120, v2
    v_lshl_add_u32 v217, v1, 4, v2
    v_add_u32 v1, 128, v0
    v_mul_u32_u24 v2, 6554, v1
    v_lshrrev_b32 v2, 16, v2
    v_mul_u32_u24 v2, 1120, v2
    v_lshl_add_u32 v218, v1, 4, v2
    v_add_u32 v1, 192, v0
    v_mul_u32_u24 v2, 6554, v1
    v_lshrrev_b32 v2, 16, v2
    v_mul_u32_u24 v2, 1120, v2
    v_lshl_add_u32 v219, v1, 4, v2
    v_add_u32 v1, 256, v0
    v_mul_u32_u24 v2, 6554, v1
    v_lshrrev_b32 v2, 16, v2
    v_mul_u32_u24 v2, 1120, v2
    v_lshl_add_u32 v220, v1, 4, v2
    s_lshl_b32 s18, s9, 16
    s_add_u32 s18, s18, 28672
    v_add_u32 v221, s18, v9
    s_lshl_b32 s18, s9, 2
    v_mov_b32 v222, s18
    v_mov_b32 v223, 1
    v_and_b32 v224, 31, v0
    v_lshlrev_b32 v224, 7, v224
    v_mov_b32 v225, 0
    s_bitcmp1_b32 s16, 0
    s_cselect_b32 s18, 51, 51
    s_cselect_b32 s19, 51, 0
    s_cmp_ge_u32 s17, s18
    s_cbranch_scc1 concat_heads__mha_block__spectral_fnet__prompt_kernel_h_wr0
    s_lshr_b32 s53, s16, 1
    s_mul_i32 s53, s53, 102
    s_add_u32 s53, s53, s19
    s_add_u32 s53, s53, s17
    s_mul_i32 s32, s53, 643
    s_lshr_b32 s32, s32, 16
    s_mul_i32 s17, s32, 102
    s_sub_u32 s17, s53, s17
    s_mul_i32 s33, s17, 10923
    s_lshr_b32 s33, s33, 16
    s_mul_i32 s19, s33, 6
    s_sub_u32 s34, s17, s19
    s_mul_i32 s20, s32, 34
    s_add_u32 s20, s20, s33
    s_mul_i32 s20, s20, 20480
    s_add_u32 s20, s20, 0xc00000
    s_mul_i32 s21, s34, 40960
    s_lshr_b32 s22, s32, 1
    s_lshl_b32 s22, s22, 10
    s_add_u32 s21, s21, s22
    s_add_u32 s21, s21, 0x1c00000
    v_and_b32 v1, 15, v0
    v_lshlrev_b32 v1, 5, v1
    v_bfe_u32 v2, v0, 4, 1
    v_lshl_add_u32 v1, v2, 10, v1
    v_lshrrev_b32 v2, 5, v0
    v_lshl_add_u32 v1, v2, 9, v1
    s_lshl_b32 s22, s9, 11
    s_add_u32 s22, s22, 159744
    v_add_u32 v1, s22, v1
    v_add_u32 v2, s22, v9
    v_min_u32 v5, 35, v0
    v_lshlrev_b32 v5, 7, v5
    s_lshl_b32 s16, s33, 13
    s_add_u32 s16, s16, 0x2060000
    v_lshrrev_b32 v244, 4, v0
    v_mul_u32_u24 v244, 20480, v244
    v_and_b32 v245, 15, v0
    v_lshl_add_u32 v244, v245, 4, v244
    v_lshlrev_b32 v245, 7, v245
    v_mov_b32 v240, -1
    v_mov_b32 v241, -1
    v_mov_b32 v242, -1
    v_mov_b32 v243, -1
    v_mov_b32 v246, 0
    v_mov_b32 v247, 1
    s_sub_u32 s57, s3, 4
    s_lshl_b32 s57, s57, 2
    v_mov_b32 v6, s57
    s_mov_b32 s58, 0x20000
concat_heads__mha_block__spectral_fnet__prompt_kernel_h_h1:
    s_sleep 4
    ds_read_b32 v7, v6 offset:1040
    s_waitcnt lgkmcnt(0)
    v_readfirstlane_b32 s57, v7
    s_sub_u32 s58, s58, 1
    s_cbranch_scc1 concat_heads__mha_block__spectral_fnet__prompt_kernel_h_h1_x
    s_cmp_eq_u32 s57, 0
    s_cbranch_scc1 concat_heads__mha_block__spectral_fnet__prompt_kernel_h_h1
concat_heads__mha_block__spectral_fnet__prompt_kernel_h_h1_x:
    s_mov_b32 s58, 0x4000
concat_heads__mha_block__spectral_fnet__prompt_kernel_h_pF:
    buffer_load_dword v6, v5, s[12:15], s16 offen sc1
    s_waitcnt vmcnt(0)
    v_cmp_ne_u32 vcc, s96, v6
    s_sub_u32 s58, s58, 1
    s_cbranch_scc1 concat_heads__mha_block__spectral_fnet__prompt_kernel_h_pF_x
    s_cbranch_vccz concat_heads__mha_block__spectral_fnet__prompt_kernel_h_pF_x
    s_sleep 64
    s_branch concat_heads__mha_block__spectral_fnet__prompt_kernel_h_pF
concat_heads__mha_block__spectral_fnet__prompt_kernel_h_pF_x:
    s_add_u32 s40, s20, 348160
    s_add_u32 s41, s21, 245760
    buffer_load_dwordx4 v[48:51], v9, s[12:15], s20 offen offset:0 sc1
    buffer_load_dwordx4 v[72:75], v9, s[12:15], s21 offen offset:0 sc1
    buffer_load_dwordx4 v[52:55], v9, s[12:15], s40 offen offset:0 sc1
    buffer_load_dwordx4 v[76:79], v9, s[12:15], s41 offen offset:0 sc1
    buffer_load_dwordx4 v[56:59], v9, s[12:15], s20 offen offset:1024 sc1
    buffer_load_dwordx4 v[80:83], v9, s[12:15], s21 offen offset:2048 sc1
    buffer_load_dwordx4 v[60:63], v9, s[12:15], s40 offen offset:1024 sc1
    buffer_load_dwordx4 v[84:87], v9, s[12:15], s41 offen offset:2048 sc1
    s_add_u32 s21, s21, 4096
    buffer_load_dwordx4 v[64:67], v9, s[12:15], s20 offen offset:2048 sc1
    buffer_load_dwordx4 v[88:91], v9, s[12:15], s21 offen offset:0 sc1
    s_add_u32 s41, s41, 4096
    buffer_load_dwordx4 v[68:71], v9, s[12:15], s40 offen offset:2048 sc1
    buffer_load_dwordx4 v[92:95], v9, s[12:15], s41 offen offset:0 sc1
    s_waitcnt vmcnt(10)
    v_mfma_f32_32x32x16_bf16 v[16:31], v[48:51], v[72:75], 0
    buffer_load_dwordx4 v[48:51], v9, s[12:15], s20 offen offset:3072 sc1
    buffer_load_dwordx4 v[72:75], v9, s[12:15], s21 offen offset:2048 sc1
    s_waitcnt vmcnt(10)
    v_mfma_f32_32x32x16_bf16 v[32:47], v[52:55], v[76:79], 0
    buffer_load_dwordx4 v[52:55], v9, s[12:15], s40 offen offset:3072 sc1
    buffer_load_dwordx4 v[76:79], v9, s[12:15], s41 offen offset:2048 sc1
    s_waitcnt vmcnt(10)
    v_mfma_f32_32x32x16_bf16 v[16:31], v[56:59], v[80:83], v[16:31]
    s_add_u32 s20, s20, 4096
    s_add_u32 s21, s21, 4096
    buffer_load_dwordx4 v[56:59], v9, s[12:15], s20 offen offset:0 sc1
    buffer_load_dwordx4 v[80:83], v9, s[12:15], s21 offen offset:0 sc1
    s_waitcnt vmcnt(10)
    v_mfma_f32_32x32x16_bf16 v[32:47], v[60:63], v[84:87], v[32:47]
    s_add_u32 s40, s40, 4096
    s_add_u32 s41, s41, 4096
    buffer_load_dwordx4 v[60:63], v9, s[12:15], s40 offen offset:0 sc1
    buffer_load_dwordx4 v[84:87], v9, s[12:15], s41 offen offset:0 sc1
    s_waitcnt vmcnt(10)
    v_mfma_f32_32x32x16_bf16 v[16:31], v[64:67], v[88:91], v[16:31]
    buffer_load_dwordx4 v[64:67], v9, s[12:15], s20 offen offset:1024 sc1
    buffer_load_dwordx4 v[88:91], v9, s[12:15], s21 offen offset:2048 sc1
    s_waitcnt vmcnt(10)
    v_mfma_f32_32x32x16_bf16 v[32:47], v[68:71], v[92:95], v[32:47]
    buffer_load_dwordx4 v[68:71], v9, s[12:15], s40 offen offset:1024 sc1
    buffer_load_dwordx4 v[92:95], v9, s[12:15], s41 offen offset:2048 sc1
    s_waitcnt vmcnt(10)
    v_mfma_f32_32x32x16_bf16 v[16:31], v[48:51], v[72:75], v[16:31]
    s_add_u32 s21, s21, 4096
    buffer_load_dwordx4 v[48:51], v9, s[12:15], s20 offen offset:2048 sc1
    buffer_load_dwordx4 v[72:75], v9, s[12:15], s21 offen offset:0 sc1
    s_waitcnt vmcnt(10)
    v_mfma_f32_32x32x16_bf16 v[32:47], v[52:55], v[76:79], v[32:47]
    s_add_u32 s41, s41, 4096
    buffer_load_dwordx4 v[52:55], v9, s[12:15], s40 offen offset:2048 sc1
    buffer_load_dwordx4 v[76:79], v9, s[12:15], s41 offen offset:0 sc1
    s_waitcnt vmcnt(10)
    v_mfma_f32_32x32x16_bf16 v[16:31], v[56:59], v[80:83], v[16:31]
    buffer_load_dwordx4 v[56:59], v9, s[12:15], s20 offen offset:3072 sc1
    buffer_load_dwordx4 v[80:83], v9, s[12:15], s21 offen offset:2048 sc1
    s_waitcnt vmcnt(10)
    v_mfma_f32_32x32x16_bf16 v[32:47], v[60:63], v[84:87], v[32:47]
    buffer_load_dwordx4 v[60:63], v9, s[12:15], s40 offen offset:3072 sc1
    buffer_load_dwordx4 v[84:87], v9, s[12:15], s41 offen offset:2048 sc1
    s_waitcnt vmcnt(10)
    v_mfma_f32_32x32x16_bf16 v[16:31], v[64:67], v[88:91], v[16:31]
    s_add_u32 s20, s20, 4096
    s_add_u32 s21, s21, 4096
    buffer_load_dwordx4 v[64:67], v9, s[12:15], s20 offen offset:0 sc1
    buffer_load_dwordx4 v[88:91], v9, s[12:15], s21 offen offset:0 sc1
    s_waitcnt vmcnt(10)
    v_mfma_f32_32x32x16_bf16 v[32:47], v[68:71], v[92:95], v[32:47]
    s_add_u32 s40, s40, 4096
    s_add_u32 s41, s41, 4096
    buffer_load_dwordx4 v[68:71], v9, s[12:15], s40 offen offset:0 sc1
    buffer_load_dwordx4 v[92:95], v9, s[12:15], s41 offen offset:0 sc1
    s_waitcnt vmcnt(10)
    v_mfma_f32_32x32x16_bf16 v[16:31], v[48:51], v[72:75], v[16:31]
    buffer_load_dwordx4 v[48:51], v9, s[12:15], s20 offen offset:1024 sc1
    buffer_load_dwordx4 v[72:75], v9, s[12:15], s21 offen offset:2048 sc1
    s_waitcnt vmcnt(10)
    v_mfma_f32_32x32x16_bf16 v[32:47], v[52:55], v[76:79], v[32:47]
    buffer_load_dwordx4 v[52:55], v9, s[12:15], s40 offen offset:1024 sc1
    buffer_load_dwordx4 v[76:79], v9, s[12:15], s41 offen offset:2048 sc1
    s_waitcnt vmcnt(10)
    v_mfma_f32_32x32x16_bf16 v[16:31], v[56:59], v[80:83], v[16:31]
    s_add_u32 s21, s21, 4096
    buffer_load_dwordx4 v[56:59], v9, s[12:15], s20 offen offset:2048 sc1
    buffer_load_dwordx4 v[80:83], v9, s[12:15], s21 offen offset:0 sc1
    s_waitcnt vmcnt(10)
    v_mfma_f32_32x32x16_bf16 v[32:47], v[60:63], v[84:87], v[32:47]
    s_add_u32 s41, s41, 4096
    buffer_load_dwordx4 v[60:63], v9, s[12:15], s40 offen offset:2048 sc1
    buffer_load_dwordx4 v[84:87], v9, s[12:15], s41 offen offset:0 sc1
    s_waitcnt vmcnt(10)
    v_mfma_f32_32x32x16_bf16 v[16:31], v[64:67], v[88:91], v[16:31]
    buffer_load_dwordx4 v[64:67], v9, s[12:15], s20 offen offset:3072 sc1
    buffer_load_dwordx4 v[88:91], v9, s[12:15], s21 offen offset:2048 sc1
    s_waitcnt vmcnt(10)
    v_mfma_f32_32x32x16_bf16 v[32:47], v[68:71], v[92:95], v[32:47]
    buffer_load_dwordx4 v[68:71], v9, s[12:15], s40 offen offset:3072 sc1
    buffer_load_dwordx4 v[92:95], v9, s[12:15], s41 offen offset:2048 sc1
    s_waitcnt vmcnt(10)
    v_mfma_f32_32x32x16_bf16 v[16:31], v[48:51], v[72:75], v[16:31]
    s_add_u32 s20, s20, 4096
    s_add_u32 s21, s21, 4096
    buffer_load_dwordx4 v[48:51], v9, s[12:15], s20 offen offset:0 sc1
    buffer_load_dwordx4 v[72:75], v9, s[12:15], s21 offen offset:0 sc1
    s_waitcnt vmcnt(10)
    v_mfma_f32_32x32x16_bf16 v[32:47], v[52:55], v[76:79], v[32:47]
    s_add_u32 s40, s40, 4096
    s_add_u32 s41, s41, 4096
    buffer_load_dwordx4 v[52:55], v9, s[12:15], s40 offen offset:0 sc1
    buffer_load_dwordx4 v[76:79], v9, s[12:15], s41 offen offset:0 sc1
    s_waitcnt vmcnt(10)
    v_mfma_f32_32x32x16_bf16 v[16:31], v[56:59], v[80:83], v[16:31]
    buffer_load_dwordx4 v[56:59], v9, s[12:15], s20 offen offset:1024 sc1
    buffer_load_dwordx4 v[80:83], v9, s[12:15], s21 offen offset:2048 sc1
    s_waitcnt vmcnt(10)
    v_mfma_f32_32x32x16_bf16 v[32:47], v[60:63], v[84:87], v[32:47]
    buffer_load_dwordx4 v[60:63], v9, s[12:15], s40 offen offset:1024 sc1
    buffer_load_dwordx4 v[84:87], v9, s[12:15], s41 offen offset:2048 sc1
    s_waitcnt vmcnt(10)
    v_mfma_f32_32x32x16_bf16 v[16:31], v[64:67], v[88:91], v[16:31]
    s_add_u32 s21, s21, 4096
    buffer_load_dwordx4 v[64:67], v9, s[12:15], s20 offen offset:2048 sc1
    buffer_load_dwordx4 v[88:91], v9, s[12:15], s21 offen offset:0 sc1
    s_waitcnt vmcnt(10)
    v_mfma_f32_32x32x16_bf16 v[32:47], v[68:71], v[92:95], v[32:47]
    s_add_u32 s41, s41, 4096
    buffer_load_dwordx4 v[68:71], v9, s[12:15], s40 offen offset:2048 sc1
    buffer_load_dwordx4 v[92:95], v9, s[12:15], s41 offen offset:0 sc1
    s_waitcnt vmcnt(10)
    v_mfma_f32_32x32x16_bf16 v[16:31], v[48:51], v[72:75], v[16:31]
    buffer_load_dwordx4 v[48:51], v9, s[12:15], s20 offen offset:3072 sc1
    buffer_load_dwordx4 v[72:75], v9, s[12:15], s21 offen offset:2048 sc1
    s_waitcnt vmcnt(10)
    v_mfma_f32_32x32x16_bf16 v[32:47], v[52:55], v[76:79], v[32:47]
    buffer_load_dwordx4 v[52:55], v9, s[12:15], s40 offen offset:3072 sc1
    buffer_load_dwordx4 v[76:79], v9, s[12:15], s41 offen offset:2048 sc1
    s_waitcnt vmcnt(10)
    v_mfma_f32_32x32x16_bf16 v[16:31], v[56:59], v[80:83], v[16:31]
    s_add_u32 s20, s20, 4096
    s_add_u32 s21, s21, 4096
    buffer_load_dwordx4 v[56:59], v9, s[12:15], s20 offen offset:0 sc1
    buffer_load_dwordx4 v[80:83], v9, s[12:15], s21 offen offset:0 sc1
    s_waitcnt vmcnt(10)
    v_mfma_f32_32x32x16_bf16 v[32:47], v[60:63], v[84:87], v[32:47]
    s_add_u32 s40, s40, 4096
    s_add_u32 s41, s41, 4096
    buffer_load_dwordx4 v[60:63], v9, s[12:15], s40 offen offset:0 sc1
    buffer_load_dwordx4 v[84:87], v9, s[12:15], s41 offen offset:0 sc1
    s_waitcnt vmcnt(10)
    v_mfma_f32_32x32x16_bf16 v[16:31], v[64:67], v[88:91], v[16:31]
    buffer_load_dwordx4 v[64:67], v9, s[12:15], s20 offen offset:1024 sc1
    buffer_load_dwordx4 v[88:91], v9, s[12:15], s21 offen offset:2048 sc1
    s_waitcnt vmcnt(10)
    v_mfma_f32_32x32x16_bf16 v[32:47], v[68:71], v[92:95], v[32:47]
    buffer_load_dwordx4 v[68:71], v9, s[12:15], s40 offen offset:1024 sc1
    buffer_load_dwordx4 v[92:95], v9, s[12:15], s41 offen offset:2048 sc1
    s_waitcnt vmcnt(10)
    v_mfma_f32_32x32x16_bf16 v[16:31], v[48:51], v[72:75], v[16:31]
    s_add_u32 s21, s21, 4096
    buffer_load_dwordx4 v[48:51], v9, s[12:15], s20 offen offset:2048 sc1
    buffer_load_dwordx4 v[72:75], v9, s[12:15], s21 offen offset:0 sc1
    s_waitcnt vmcnt(10)
    v_mfma_f32_32x32x16_bf16 v[32:47], v[52:55], v[76:79], v[32:47]
    s_add_u32 s41, s41, 4096
    buffer_load_dwordx4 v[52:55], v9, s[12:15], s40 offen offset:2048 sc1
    buffer_load_dwordx4 v[76:79], v9, s[12:15], s41 offen offset:0 sc1
    s_waitcnt vmcnt(10)
    v_mfma_f32_32x32x16_bf16 v[16:31], v[56:59], v[80:83], v[16:31]
    buffer_load_dwordx4 v[56:59], v9, s[12:15], s20 offen offset:3072 sc1
    buffer_load_dwordx4 v[80:83], v9, s[12:15], s21 offen offset:2048 sc1
    s_waitcnt vmcnt(10)
    v_mfma_f32_32x32x16_bf16 v[32:47], v[60:63], v[84:87], v[32:47]
    buffer_load_dwordx4 v[60:63], v9, s[12:15], s40 offen offset:3072 sc1
    buffer_load_dwordx4 v[84:87], v9, s[12:15], s41 offen offset:2048 sc1
    s_waitcnt vmcnt(10)
    v_mfma_f32_32x32x16_bf16 v[16:31], v[64:67], v[88:91], v[16:31]
    s_waitcnt vmcnt(8)
    v_mfma_f32_32x32x16_bf16 v[32:47], v[68:71], v[92:95], v[32:47]
    s_waitcnt vmcnt(6)
    v_mfma_f32_32x32x16_bf16 v[16:31], v[48:51], v[72:75], v[16:31]
    s_waitcnt vmcnt(4)
    v_mfma_f32_32x32x16_bf16 v[32:47], v[52:55], v[76:79], v[32:47]
    s_waitcnt vmcnt(2)
    v_mfma_f32_32x32x16_bf16 v[16:31], v[56:59], v[80:83], v[16:31]
    s_waitcnt vmcnt(0)
    v_mfma_f32_32x32x16_bf16 v[32:47], v[60:63], v[84:87], v[32:47]
    s_mul_i32 s20, s32, 6
    s_add_u32 s20, s20, s34
    s_mul_i32 s20, s20, 34
    s_add_u32 s20, s20, s33
    s_lshl_b32 s20, s20, 11
    s_add_u32 s20, s20, 0x1000000
    s_add_u32 s21, s20, 34816
    s_and_b32 s16, s32, 1
    s_mul_i32 s16, s16, 6
    s_add_u32 s16, s16, s34
    s_lshl_b32 s16, s16, 6
    s_lshr_b32 s17, s32, 1
    s_mul_i32 s17, s17, 17
    s_add_u32 s16, s16, s17
    s_add_u32 s16, s16, s33
    s_lshl_b32 s16, s16, 7
    s_add_u32 s16, s16, 0x20c0000
    v_cvt_pk_bf16_f32 v16, v16, v17
    v_cvt_pk_bf16_f32 v17, v18, v19
    v_cvt_pk_bf16_f32 v18, v20, v21
    v_cvt_pk_bf16_f32 v19, v22, v23
    v_cvt_pk_bf16_f32 v20, v24, v25
    v_cvt_pk_bf16_f32 v21, v26, v27
    v_cvt_pk_bf16_f32 v22, v28, v29
    v_cvt_pk_bf16_f32 v23, v30, v31
    v_cvt_pk_bf16_f32 v32, v32, v33
    v_cvt_pk_bf16_f32 v33, v34, v35
    v_cvt_pk_bf16_f32 v34, v36, v37
    v_cvt_pk_bf16_f32 v35, v38, v39
    v_cvt_pk_bf16_f32 v36, v40, v41
    v_cvt_pk_bf16_f32 v37, v42, v43
    v_cvt_pk_bf16_f32 v38, v44, v45
    v_cvt_pk_bf16_f32 v39, v46, v47
    ds_write_b128 v1, v[16:19] offset:0
    ds_write_b128 v1, v[32:35] offset:16
    s_waitcnt lgkmcnt(0)
    ds_read_b128 v[48:51], v2 offset:0
    ds_read_b128 v[52:55], v2 offset:1024
    s_waitcnt lgkmcnt(0)
    buffer_store_dwordx4 v[48:51], v9, s[12:15], s20 offen offset:0 sc1
    buffer_store_dwordx4 v[52:55], v9, s[12:15], s21 offen offset:0 sc1
    ds_write_b128 v1, v[20:23] offset:0
    ds_write_b128 v1, v[36:39] offset:16
    s_waitcnt lgkmcnt(0)
    ds_read_b128 v[56:59], v2 offset:0
    ds_read_b128 v[60:63], v2 offset:1024
    s_waitcnt lgkmcnt(0)
    buffer_store_dwordx4 v[56:59], v9, s[12:15], s20 offen offset:1024 sc1
    buffer_store_dwordx4 v[60:63], v9, s[12:15], s21 offen offset:1024 sc1
    s_waitcnt vmcnt(0)
    s_mov_b64 exec, 0xff
    buffer_store_dwordx4 v[12:15], v9, s[12:15], s16 offen offset:0 sc1
    s_mov_b64 exec, -1
    s_cmp_lg_u32 s9, 0
    s_cbranch_scc1 concat_heads__mha_block__spectral_fnet__prompt_kernel_h_noarm
    s_and_b32 s24, s2, 7
    s_bfe_u32 s25, s2, 0x10003
    s_lshl_b32 s28, s24, 1
    s_add_u32 s28, s28, s25
    s_lshr_b32 s29, s2, 4
    s_mul_i32 s25, s29, 163840
    s_add_u32 s25, s25, 0x900000
    s_lshl_b32 s26, s28, 10
    s_add_u32 s26, s26, s25
    s_lshl_b32 s27, s28, 8
    s_add_u32 s27, s27, s25
    s_add_u32 s27, s27, 16384
    s_lshl_b32 s29, s29, 4
    s_add_u32 s29, s29, s28
    s_lshl_b32 s29, s29, 7
    s_add_u32 s29, s29, 0x20e0000
    s_bfe_u32 s30, s2, 0x10004
    s_lshl_b32 s24, s24, 1
    s_add_u32 s24, s24, s30
    s_lshl_b32 s24, s24, 11
    s_add_u32 s24, s24, 0x20e0000
    buffer_store_dwordx4 v[240:243], v9, s[12:15], s26 offen sc1
    s_add_u32 s26, s26, 20480
    buffer_store_dwordx4 v[240:243], v9, s[12:15], s26 offen sc1
    s_add_u32 s26, s26, 20480
    buffer_store_dwordx4 v[240:243], v9, s[12:15], s26 offen sc1
    s_add_u32 s26, s26, 20480
    buffer_store_dwordx4 v[240:243], v9, s[12:15], s26 offen sc1
    s_add_u32 s26, s26, 20480
    buffer_store_dwordx4 v[240:243], v9, s[12:15], s26 offen sc1
    s_add_u32 s26, s26, 20480
    s_waitcnt vmcnt(0)
    buffer_store_dwordx4 v[240:243], v9, s[12:15], s26 offen sc1
    s_add_u32 s26, s26, 20480
    buffer_store_dwordx4 v[240:243], v9, s[12:15], s26 offen sc1
    s_add_u32 s26, s26, 20480
    buffer_store_dwordx4 v[240:243], v9, s[12:15], s26 offen sc1
    s_add_u32 s26, s26, 20480
    buffer_store_dwordx4 v[240:243], v244, s[12:15], s27 offen sc1
    s_add_u32 s27, s27, 81920
    buffer_store_dwordx4 v[240:243], v244, s[12:15], s27 offen sc1
    s_waitcnt vmcnt(0)
    ds_write_b32 v246, v247 offset:1216
    s_mov_b64 exec, 0xff
    buffer_store_dwordx4 v[12:15], v9, s[12:15], s29 offen offset:0 sc1
    s_mov_b64 exec, -1
concat_heads__mha_block__spectral_fnet__prompt_kernel_h_noarm:
    s_branch concat_heads__mha_block__spectral_fnet__prompt_kernel_h_wr
concat_heads__mha_block__spectral_fnet__prompt_kernel_h_wr0:
    s_sub_u32 s57, s3, 4
    s_lshl_b32 s57, s57, 2
    v_mov_b32 v6, s57
    s_mov_b32 s58, 0x20000
concat_heads__mha_block__spectral_fnet__prompt_kernel_h_h6:
    s_sleep 4
    ds_read_b32 v7, v6 offset:1040
    s_waitcnt lgkmcnt(0)
    v_readfirstlane_b32 s57, v7
    s_sub_u32 s58, s58, 1
    s_cbranch_scc1 concat_heads__mha_block__spectral_fnet__prompt_kernel_h_h6_x
    s_cmp_eq_u32 s57, 0
    s_cbranch_scc1 concat_heads__mha_block__spectral_fnet__prompt_kernel_h_h6
concat_heads__mha_block__spectral_fnet__prompt_kernel_h_h6_x:
concat_heads__mha_block__spectral_fnet__prompt_kernel_h_wr:
    s_lshr_b32 s16, s2, 5
    s_mul_i32 s16, s16, 160
    s_mul_i32 s17, s9, 409600
    s_add_u32 s16, s16, s17
    buffer_load_dwordx4 v[16:19], v216, s[4:7], s16 offen
    buffer_load_dwordx4 v[20:23], v217, s[4:7], s16 offen
    buffer_load_dwordx4 v[24:27], v218, s[4:7], s16 offen
    buffer_load_dwordx4 v[28:31], v219, s[4:7], s16 offen
    buffer_load_dwordx4 v[32:35], v220, s[4:7], s16 offen
    s_add_u32 s16, s16, 40960
    s_waitcnt vmcnt(5)
    buffer_load_dwordx4 v[36:39], v216, s[4:7], s16 offen
    buffer_load_dwordx4 v[40:43], v217, s[4:7], s16 offen
    buffer_load_dwordx4 v[44:47], v218, s[4:7], s16 offen
    buffer_load_dwordx4 v[48:51], v219, s[4:7], s16 offen
    buffer_load_dwordx4 v[52:55], v220, s[4:7], s16 offen
    s_add_u32 s16, s16, 40960
    s_waitcnt vmcnt(5)
    buffer_load_dwordx4 v[56:59], v216, s[4:7], s16 offen
    buffer_load_dwordx4 v[60:63], v217, s[4:7], s16 offen
    buffer_load_dwordx4 v[64:67], v218, s[4:7], s16 offen
    buffer_load_dwordx4 v[68:71], v219, s[4:7], s16 offen
    buffer_load_dwordx4 v[72:75], v220, s[4:7], s16 offen
    s_add_u32 s16, s16, 40960
    s_waitcnt vmcnt(5)
    buffer_load_dwordx4 v[76:79], v216, s[4:7], s16 offen
    buffer_load_dwordx4 v[80:83], v217, s[4:7], s16 offen
    buffer_load_dwordx4 v[84:87], v218, s[4:7], s16 offen
    buffer_load_dwordx4 v[88:91], v219, s[4:7], s16 offen
    buffer_load_dwordx4 v[92:95], v220, s[4:7], s16 offen
    s_add_u32 s16, s16, 40960
    s_waitcnt vmcnt(5)
    buffer_load_dwordx4 v[96:99], v216, s[4:7], s16 offen
    buffer_load_dwordx4 v[100:103], v217, s[4:7], s16 offen
    buffer_load_dwordx4 v[104:107], v218, s[4:7], s16 offen
    buffer_load_dwordx4 v[108:111], v219, s[4:7], s16 offen
    buffer_load_dwordx4 v[112:115], v220, s[4:7], s16 offen
    s_add_u32 s16, s16, 40960
    s_waitcnt vmcnt(5)
    buffer_load_dwordx4 v[116:119], v216, s[4:7], s16 offen
    buffer_load_dwordx4 v[120:123], v217, s[4:7], s16 offen
    buffer_load_dwordx4 v[124:127], v218, s[4:7], s16 offen
    buffer_load_dwordx4 v[128:131], v219, s[4:7], s16 offen
    buffer_load_dwordx4 v[132:135], v220, s[4:7], s16 offen
    s_add_u32 s16, s16, 40960
    s_waitcnt vmcnt(5)
    buffer_load_dwordx4 v[136:139], v216, s[4:7], s16 offen
    buffer_load_dwordx4 v[140:143], v217, s[4:7], s16 offen
    buffer_load_dwordx4 v[144:147], v218, s[4:7], s16 offen
    buffer_load_dwordx4 v[148:151], v219, s[4:7], s16 offen
    buffer_load_dwordx4 v[152:155], v220, s[4:7], s16 offen
    s_add_u32 s16, s16, 40960
    s_waitcnt vmcnt(5)
    buffer_load_dwordx4 v[156:159], v216, s[4:7], s16 offen
    buffer_load_dwordx4 v[160:163], v217, s[4:7], s16 offen
    buffer_load_dwordx4 v[164:167], v218, s[4:7], s16 offen
    buffer_load_dwordx4 v[168:171], v219, s[4:7], s16 offen
    buffer_load_dwordx4 v[172:175], v220, s[4:7], s16 offen
    s_add_u32 s16, s16, 40960
    s_waitcnt vmcnt(5)
    buffer_load_dwordx4 v[176:179], v216, s[4:7], s16 offen
    buffer_load_dwordx4 v[180:183], v217, s[4:7], s16 offen
    buffer_load_dwordx4 v[184:187], v218, s[4:7], s16 offen
    buffer_load_dwordx4 v[188:191], v219, s[4:7], s16 offen
    buffer_load_dwordx4 v[192:195], v220, s[4:7], s16 offen
    s_add_u32 s16, s16, 40960
    s_waitcnt vmcnt(5)
    buffer_load_dwordx4 v[196:199], v216, s[4:7], s16 offen
    buffer_load_dwordx4 v[200:203], v217, s[4:7], s16 offen
    buffer_load_dwordx4 v[204:207], v218, s[4:7], s16 offen
    buffer_load_dwordx4 v[208:211], v219, s[4:7], s16 offen
    buffer_load_dwordx4 v[212:215], v220, s[4:7], s16 offen
    s_add_u32 s16, s16, 40960
    s_waitcnt vmcnt(0)
    s_cmp_lg_u32 s9, 0
    s_cbranch_scc1 concat_heads__mha_block__spectral_fnet__prompt_kernel_h_nowatch
    s_mov_b32 s58, 0x4000
concat_heads__mha_block__spectral_fnet__prompt_kernel_h_pM:
    buffer_load_dword v248, v245, s[12:15], s24 offen sc1
    s_waitcnt vmcnt(0)
    v_cmp_ne_u32 vcc, s96, v248
    s_sub_u32 s58, s58, 1
    s_cbranch_scc1 concat_heads__mha_block__spectral_fnet__prompt_kernel_h_pM_x
    s_cbranch_vccz concat_heads__mha_block__spectral_fnet__prompt_kernel_h_pM_x
    s_sleep 16
    s_branch concat_heads__mha_block__spectral_fnet__prompt_kernel_h_pM
concat_heads__mha_block__spectral_fnet__prompt_kernel_h_pM_x:
    ds_write_b32 v246, v247 offset:1220
concat_heads__mha_block__spectral_fnet__prompt_kernel_h_nowatch:
    s_mov_b32 s58, 0x20000
concat_heads__mha_block__spectral_fnet__prompt_kernel_h_wrw:
    s_sleep 2
    ds_read_b32 v1, v222 offset:1200
    s_waitcnt lgkmcnt(0)
    v_readfirstlane_b32 s57, v1
    s_sub_u32 s58, s58, 1
    s_cbranch_scc1 concat_heads__mha_block__spectral_fnet__prompt_kernel_h_wrx
    s_cmp_eq_u32 s57, 0
    s_cbranch_scc1 concat_heads__mha_block__spectral_fnet__prompt_kernel_h_wrw
concat_heads__mha_block__spectral_fnet__prompt_kernel_h_wrx:
    ds_write_b128 v221, v[16:19] offset:0
    ds_write_b128 v221, v[20:23] offset:1024
    ds_write_b128 v221, v[24:27] offset:2048
    ds_write_b128 v221, v[28:31] offset:3072
    ds_write_b128 v221, v[32:35] offset:4096
    ds_write_b128 v221, v[36:39] offset:5120
    ds_write_b128 v221, v[40:43] offset:6144
    ds_write_b128 v221, v[44:47] offset:7168
    ds_write_b128 v221, v[48:51] offset:8192
    ds_write_b128 v221, v[52:55] offset:9216
    ds_write_b128 v221, v[56:59] offset:10240
    ds_write_b128 v221, v[60:63] offset:11264
    ds_write_b128 v221, v[64:67] offset:12288
    ds_write_b128 v221, v[68:71] offset:13312
    ds_write_b128 v221, v[72:75] offset:14336
    ds_write_b128 v221, v[76:79] offset:15360
    ds_write_b128 v221, v[80:83] offset:16384
    ds_write_b128 v221, v[84:87] offset:17408
    ds_write_b128 v221, v[88:91] offset:18432
    ds_write_b128 v221, v[92:95] offset:19456
    ds_write_b128 v221, v[96:99] offset:20480
    ds_write_b128 v221, v[100:103] offset:21504
    ds_write_b128 v221, v[104:107] offset:22528
    ds_write_b128 v221, v[108:111] offset:23552
    ds_write_b128 v221, v[112:115] offset:24576
    ds_write_b128 v221, v[116:119] offset:25600
    ds_write_b128 v221, v[120:123] offset:26624
    ds_write_b128 v221, v[124:127] offset:27648
    ds_write_b128 v221, v[128:131] offset:28672
    ds_write_b128 v221, v[132:135] offset:29696
    ds_write_b128 v221, v[136:139] offset:30720
    ds_write_b128 v221, v[140:143] offset:31744
    ds_write_b128 v221, v[144:147] offset:32768
    ds_write_b128 v221, v[148:151] offset:33792
    ds_write_b128 v221, v[152:155] offset:34816
    ds_write_b128 v221, v[156:159] offset:35840
    ds_write_b128 v221, v[160:163] offset:36864
    ds_write_b128 v221, v[164:167] offset:37888
    ds_write_b128 v221, v[168:171] offset:38912
    ds_write_b128 v221, v[172:175] offset:39936
    ds_write_b128 v221, v[176:179] offset:40960
    ds_write_b128 v221, v[180:183] offset:41984
    ds_write_b128 v221, v[184:187] offset:43008
    ds_write_b128 v221, v[188:191] offset:44032
    ds_write_b128 v221, v[192:195] offset:45056
    ds_write_b128 v221, v[196:199] offset:46080
    ds_write_b128 v221, v[200:203] offset:47104
    ds_write_b128 v221, v[204:207] offset:48128
    ds_write_b128 v221, v[208:211] offset:49152
    ds_write_b128 v221, v[212:215] offset:50176
    s_waitcnt lgkmcnt(0)
    ds_write_b32 v222, v223 offset:1088
    s_branch concat_heads__mha_block__spectral_fnet__prompt_kernel_h_end
concat_heads__mha_block__spectral_fnet__prompt_kernel_h_g2:
    s_and_b32 s36, s9, 1
    s_lshl_b32 s36, s36, 16
    s_add_u32 s36, s36, 28672
    s_sub_u32 s18, 63, s17
    s_cmp_eq_u32 s9, 3
    s_cselect_b32 s17, s17, s18
    s_bitcmp1_b32 s16, 0
    s_cselect_b32 s18, 46, 46
    s_cselect_b32 s19, 46, 0
    s_lshr_b32 s37, s16, 1
    s_mul_i32 s37, s37, 92
    s_add_u32 s37, s37, s19
    s_add_u32 s37, s37, s17
    s_cmp_ge_u32 s17, s18
    s_cselect_b32 s37, 0x4000, s37
    v_add_u32 v1, 0, v0
    v_mul_u32_u24 v2, 6554, v1
    v_lshrrev_b32 v2, 16, v2
    v_mul_u32_u24 v2, 1120, v2
    v_add_u32 v55, v2, v9
    v_add_u32 v1, 64, v0
    v_mul_u32_u24 v2, 6554, v1
    v_lshrrev_b32 v2, 16, v2
    v_mul_u32_u24 v2, 1120, v2
    v_add_u32 v56, v2, v9
    v_add_u32 v1, 128, v0
    v_mul_u32_u24 v2, 6554, v1
    v_lshrrev_b32 v2, 16, v2
    v_mul_u32_u24 v2, 1120, v2
    v_add_u32 v57, v2, v9
    v_add_u32 v1, 192, v0
    v_mul_u32_u24 v2, 6554, v1
    v_lshrrev_b32 v2, 16, v2
    v_mul_u32_u24 v2, 1120, v2
    v_add_u32 v58, v2, v9
    v_add_u32 v1, 256, v0
    v_mul_u32_u24 v2, 6554, v1
    v_lshrrev_b32 v2, 16, v2
    v_mul_u32_u24 v2, 1120, v2
    v_lshl_add_u32 v59, v1, 4, v2
    s_mul_i32 s32, s37, 5958
    s_lshr_b32 s32, s32, 16
    s_mul_i32 s17, s32, 11
    s_sub_u32 s33, s37, s17
    s_mul_i32 s16, s32, 67584
    s_add_u32 s16, s16, 0x1800000
    s_cmp_ge_u32 s32, 17
    s_cselect_b32 s34, 1, 0
    s_cselect_b32 s19, 17, 0
    s_sub_u32 s32, s32, s19
    s_lshl_b32 s35, s32, 6
    s_add_u32 s35, s35, s34
    s_mov_b32 s17, s36
    s_mov_b32 s18, 16
    v_add_u32 v54, s36, v9
    s_and_b32 s20, s9, 1
    s_lshl_b32 s20, s20, 2
    v_mov_b32 v52, s20
    v_mov_b32 v53, 1
    v_and_b32 v5, 31, v0
    v_lshrrev_b32 v6, 5, v0
    s_lshl_b32 s20, s33, 5
    v_add_u32 v1, s20, v5
    v_mul_u32_u24 v2, 20480, v6
    v_sub_u32 v3, 20480, v2
    v_sub_u32 v4, 640, v1
    v_lshl_add_u32 v48, v1, 1, v2
    v_lshl_add_u32 v49, v4, 1, v2
    v_lshl_add_u32 v50, v1, 1, v3
    v_lshl_add_u32 v51, v4, 1, v3
    v_mov_b32 v2, 0x80000000
    v_cmp_lt_u32 vcc, 320, v1
    v_subrev_u32 v1, 1, v1
    s_nop 0
    v_cndmask_b32 v48, v48, v2, vcc
    v_cndmask_b32 v50, v50, v2, vcc
    v_cmp_le_u32 vcc, 319, v1
    v_min_u32 v1, 33, v0
    v_lshlrev_b32 v1, 7, v1
    v_cndmask_b32 v49, v49, v2, vcc
    v_cndmask_b32 v51, v51, v2, vcc
    v_min_u32 v3, 32, v0
    v_lshlrev_b32 v3, 7, v3
    s_sub_u32 s57, s3, 4
    s_lshl_b32 s57, s57, 2
    v_mov_b32 v6, s57
    s_mov_b32 s58, 0x20000
concat_heads__mha_block__spectral_fnet__prompt_kernel_h_h2:
    s_sleep 4
    ds_read_b32 v7, v6 offset:1040
    s_waitcnt lgkmcnt(0)
    v_readfirstlane_b32 s57, v7
    s_sub_u32 s58, s58, 1
    s_cbranch_scc1 concat_heads__mha_block__spectral_fnet__prompt_kernel_h_h2_x
    s_cmp_eq_u32 s57, 0
    s_cbranch_scc1 concat_heads__mha_block__spectral_fnet__prompt_kernel_h_h2
concat_heads__mha_block__spectral_fnet__prompt_kernel_h_h2_x:
    s_cmp_ge_u32 s37, 363
    s_cbranch_scc1 concat_heads__mha_block__spectral_fnet__prompt_kernel_h_wo
    s_mul_i32 s39, s34, 6
    s_lshr_b32 s19, s33, 1
    s_add_u32 s39, s39, s19
    s_lshl_b32 s39, s39, 13
    s_add_u32 s39, s39, 0x20c0000
    s_sub_u32 s19, s16, 0x1800000
    s_lshr_b32 s19, s19, 4
    s_add_u32 s19, s19, 0x2090000
    s_mov_b32 s58, 0x4000
concat_heads__mha_block__spectral_fnet__prompt_kernel_h_pT:
    buffer_load_dword v2, v3, s[12:15], s19 offen sc1
    s_waitcnt vmcnt(0)
    v_cmp_ne_u32 vcc, s96, v2
    s_sub_u32 s58, s58, 1
    s_cbranch_scc1 concat_heads__mha_block__spectral_fnet__prompt_kernel_h_pT_x
    s_cbranch_vccz concat_heads__mha_block__spectral_fnet__prompt_kernel_h_pT_x
    s_sleep 64
    s_branch concat_heads__mha_block__spectral_fnet__prompt_kernel_h_pT
concat_heads__mha_block__spectral_fnet__prompt_kernel_h_pT_x:
concat_heads__mha_block__spectral_fnet__prompt_kernel_h_dma:
    s_mov_b32 m0, s17
    s_add_u32 s17, s17, 4096
    buffer_load_dwordx4 v9, s[12:15], s16 offen offset:0 sc1 lds
    buffer_load_dwordx4 v9, s[12:15], s16 offen offset:1024 sc1 lds
    buffer_load_dwordx4 v9, s[12:15], s16 offen offset:2048 sc1 lds
    buffer_load_dwordx4 v9, s[12:15], s16 offen offset:3072 sc1 lds
    s_add_u32 s16, s16, 4096
    s_waitcnt vmcnt(4)
    s_sub_u32 s18, s18, 1
    s_cmp_lg_u32 s18, 0
    s_cbranch_scc1 concat_heads__mha_block__spectral_fnet__prompt_kernel_h_dma
    buffer_load_dwordx4 v[60:63], v9, s[12:15], s16 offen sc1
    buffer_load_dwordx4 v[64:67], v9, s[12:15], s16 offen offset:1024 sc1
    s_mov_b32 s58, 0x4000
concat_heads__mha_block__spectral_fnet__prompt_kernel_h_p1:
    buffer_load_dword v2, v1, s[12:15], s39 offen sc1
    s_waitcnt vmcnt(0)
    v_cmp_ne_u32 vcc, s96, v2
    s_sub_u32 s58, s58, 1
    s_cbranch_scc1 concat_heads__mha_block__spectral_fnet__prompt_kernel_h_p1_x
    s_cbranch_vccz concat_heads__mha_block__spectral_fnet__prompt_kernel_h_p1_x
    s_sleep 64
    s_branch concat_heads__mha_block__spectral_fnet__prompt_kernel_h_p1
concat_heads__mha_block__spectral_fnet__prompt_kernel_h_p1_x:
    s_mul_i32 s20, s34, 12
    s_add_u32 s20, s20, s33
    s_mul_i32 s20, s20, 34816
    s_add_u32 s20, s20, 0x1000000
    s_add_u32 s21, s20, 835584
    buffer_load_dwordx4 v[84:87], v9, s[12:15], s20 offen offset:0 sc1
    buffer_load_dwordx4 v[88:91], v9, s[12:15], s21 offen offset:0 sc1
    buffer_load_dwordx4 v[92:95], v9, s[12:15], s20 offen offset:1024 sc1
    buffer_load_dwordx4 v[96:99], v9, s[12:15], s21 offen offset:1024 sc1
    buffer_load_dwordx4 v[100:103], v9, s[12:15], s20 offen offset:2048 sc1
    buffer_load_dwordx4 v[104:107], v9, s[12:15], s21 offen offset:2048 sc1
    buffer_load_dwordx4 v[108:111], v9, s[12:15], s20 offen offset:3072 sc1
    buffer_load_dwordx4 v[112:115], v9, s[12:15], s21 offen offset:3072 sc1
    s_add_u32 s20, s20, 4096
    s_add_u32 s21, s21, 4096
    buffer_load_dwordx4 v[116:119], v9, s[12:15], s20 offen offset:0 sc1
    buffer_load_dwordx4 v[120:123], v9, s[12:15], s21 offen offset:0 sc1
    buffer_load_dwordx4 v[124:127], v9, s[12:15], s20 offen offset:1024 sc1
    buffer_load_dwordx4 v[128:131], v9, s[12:15], s21 offen offset:1024 sc1
    ds_read_b128 v[68:71], v54 offset:0
    ds_read_b128 v[72:75], v54 offset:1024
    ds_read_b128 v[76:79], v54 offset:2048
    ds_read_b128 v[80:83], v54 offset:3072
    s_waitcnt vmcnt(10) lgkmcnt(2)
    v_mfma_f32_32x32x16_bf16 v[16:31], v[68:71], v[84:87], 0
    v_mfma_f32_32x32x16_bf16 v[32:47], v[72:75], v[88:91], 0
    buffer_load_dwordx4 v[84:87], v9, s[12:15], s20 offen offset:2048 sc1
    buffer_load_dwordx4 v[88:91], v9, s[12:15], s21 offen offset:2048 sc1
    ds_read_b128 v[68:71], v54 offset:4096
    ds_read_b128 v[72:75], v54 offset:5120
    s_waitcnt vmcnt(10) lgkmcnt(2)
    v_mfma_f32_32x32x16_bf16 v[16:31], v[76:79], v[92:95], v[16:31]
    v_mfma_f32_32x32x16_bf16 v[32:47], v[80:83], v[96:99], v[32:47]
    buffer_load_dwordx4 v[92:95], v9, s[12:15], s20 offen offset:3072 sc1
    buffer_load_dwordx4 v[96:99], v9, s[12:15], s21 offen offset:3072 sc1
    ds_read_b128 v[76:79], v54 offset:6144
    ds_read_b128 v[80:83], v54 offset:7168
    s_waitcnt vmcnt(10) lgkmcnt(2)
    v_mfma_f32_32x32x16_bf16 v[16:31], v[68:71], v[100:103], v[16:31]
    v_mfma_f32_32x32x16_bf16 v[32:47], v[72:75], v[104:107], v[32:47]
    s_add_u32 s20, s20, 4096
    s_add_u32 s21, s21, 4096
    buffer_load_dwordx4 v[100:103], v9, s[12:15], s20 offen offset:0 sc1
    buffer_load_dwordx4 v[104:107], v9, s[12:15], s21 offen offset:0 sc1
    ds_read_b128 v[68:71], v54 offset:8192
    ds_read_b128 v[72:75], v54 offset:9216
    s_waitcnt vmcnt(10) lgkmcnt(2)
    v_mfma_f32_32x32x16_bf16 v[16:31], v[76:79], v[108:111], v[16:31]
    v_mfma_f32_32x32x16_bf16 v[32:47], v[80:83], v[112:115], v[32:47]
    buffer_load_dwordx4 v[108:111], v9, s[12:15], s20 offen offset:1024 sc1
    buffer_load_dwordx4 v[112:115], v9, s[12:15], s21 offen offset:1024 sc1
    ds_read_b128 v[76:79], v54 offset:10240
    ds_read_b128 v[80:83], v54 offset:11264
    s_waitcnt vmcnt(10) lgkmcnt(2)
    v_mfma_f32_32x32x16_bf16 v[16:31], v[68:71], v[116:119], v[16:31]
    v_mfma_f32_32x32x16_bf16 v[32:47], v[72:75], v[120:123], v[32:47]
    buffer_load_dwordx4 v[116:119], v9, s[12:15], s20 offen offset:2048 sc1
    buffer_load_dwordx4 v[120:123], v9, s[12:15], s21 offen offset:2048 sc1
    ds_read_b128 v[68:71], v54 offset:12288
    ds_read_b128 v[72:75], v54 offset:13312
    s_waitcnt vmcnt(10) lgkmcnt(2)
    v_mfma_f32_32x32x16_bf16 v[16:31], v[76:79], v[124:127], v[16:31]
    v_mfma_f32_32x32x16_bf16 v[32:47], v[80:83], v[128:131], v[32:47]
    buffer_load_dwordx4 v[124:127], v9, s[12:15], s20 offen offset:3072 sc1
    buffer_load_dwordx4 v[128:131], v9, s[12:15], s21 offen offset:3072 sc1
    ds_read_b128 v[76:79], v54 offset:14336
    ds_read_b128 v[80:83], v54 offset:15360
    s_waitcnt vmcnt(10) lgkmcnt(2)
    v_mfma_f32_32x32x16_bf16 v[16:31], v[68:71], v[84:87], v[16:31]
    v_mfma_f32_32x32x16_bf16 v[32:47], v[72:75], v[88:91], v[32:47]
    s_add_u32 s20, s20, 4096
    s_add_u32 s21, s21, 4096
    buffer_load_dwordx4 v[84:87], v9, s[12:15], s20 offen offset:0 sc1
    buffer_load_dwordx4 v[88:91], v9, s[12:15], s21 offen offset:0 sc1
    ds_read_b128 v[68:71], v54 offset:16384
    ds_read_b128 v[72:75], v54 offset:17408
    s_waitcnt vmcnt(10) lgkmcnt(2)
    v_mfma_f32_32x32x16_bf16 v[16:31], v[76:79], v[92:95], v[16:31]
    v_mfma_f32_32x32x16_bf16 v[32:47], v[80:83], v[96:99], v[32:47]
    buffer_load_dwordx4 v[92:95], v9, s[12:15], s20 offen offset:1024 sc1
    buffer_load_dwordx4 v[96:99], v9, s[12:15], s21 offen offset:1024 sc1
    ds_read_b128 v[76:79], v54 offset:18432
    ds_read_b128 v[80:83], v54 offset:19456
    s_waitcnt vmcnt(10) lgkmcnt(2)
    v_mfma_f32_32x32x16_bf16 v[16:31], v[68:71], v[100:103], v[16:31]
    v_mfma_f32_32x32x16_bf16 v[32:47], v[72:75], v[104:107], v[32:47]
    buffer_load_dwordx4 v[100:103], v9, s[12:15], s20 offen offset:2048 sc1
    buffer_load_dwordx4 v[104:107], v9, s[12:15], s21 offen offset:2048 sc1
    ds_read_b128 v[68:71], v54 offset:20480
    ds_read_b128 v[72:75], v54 offset:21504
    s_waitcnt vmcnt(10) lgkmcnt(2)
    v_mfma_f32_32x32x16_bf16 v[16:31], v[76:79], v[108:111], v[16:31]
    v_mfma_f32_32x32x16_bf16 v[32:47], v[80:83], v[112:115], v[32:47]
    buffer_load_dwordx4 v[108:111], v9, s[12:15], s20 offen offset:3072 sc1
    buffer_load_dwordx4 v[112:115], v9, s[12:15], s21 offen offset:3072 sc1
    ds_read_b128 v[76:79], v54 offset:22528
    ds_read_b128 v[80:83], v54 offset:23552
    s_waitcnt vmcnt(10) lgkmcnt(2)
    v_mfma_f32_32x32x16_bf16 v[16:31], v[68:71], v[116:119], v[16:31]
    v_mfma_f32_32x32x16_bf16 v[32:47], v[72:75], v[120:123], v[32:47]
    s_add_u32 s20, s20, 4096
    s_add_u32 s21, s21, 4096
    buffer_load_dwordx4 v[116:119], v9, s[12:15], s20 offen offset:0 sc1
    buffer_load_dwordx4 v[120:123], v9, s[12:15], s21 offen offset:0 sc1
    ds_read_b128 v[68:71], v54 offset:24576
    ds_read_b128 v[72:75], v54 offset:25600
    s_waitcnt vmcnt(10) lgkmcnt(2)
    v_mfma_f32_32x32x16_bf16 v[16:31], v[76:79], v[124:127], v[16:31]
    v_mfma_f32_32x32x16_bf16 v[32:47], v[80:83], v[128:131], v[32:47]
    buffer_load_dwordx4 v[124:127], v9, s[12:15], s20 offen offset:1024 sc1
    buffer_load_dwordx4 v[128:131], v9, s[12:15], s21 offen offset:1024 sc1
    ds_read_b128 v[76:79], v54 offset:26624
    ds_read_b128 v[80:83], v54 offset:27648
    s_waitcnt vmcnt(10) lgkmcnt(2)
    v_mfma_f32_32x32x16_bf16 v[16:31], v[68:71], v[84:87], v[16:31]
    v_mfma_f32_32x32x16_bf16 v[32:47], v[72:75], v[88:91], v[32:47]
    buffer_load_dwordx4 v[84:87], v9, s[12:15], s20 offen offset:2048 sc1
    buffer_load_dwordx4 v[88:91], v9, s[12:15], s21 offen offset:2048 sc1
    ds_read_b128 v[68:71], v54 offset:28672
    ds_read_b128 v[72:75], v54 offset:29696
    s_waitcnt vmcnt(10) lgkmcnt(2)
    v_mfma_f32_32x32x16_bf16 v[16:31], v[76:79], v[92:95], v[16:31]
    v_mfma_f32_32x32x16_bf16 v[32:47], v[80:83], v[96:99], v[32:47]
    buffer_load_dwordx4 v[92:95], v9, s[12:15], s20 offen offset:3072 sc1
    buffer_load_dwordx4 v[96:99], v9, s[12:15], s21 offen offset:3072 sc1
    ds_read_b128 v[76:79], v54 offset:30720
    ds_read_b128 v[80:83], v54 offset:31744
    s_waitcnt vmcnt(10) lgkmcnt(2)
    v_mfma_f32_32x32x16_bf16 v[16:31], v[68:71], v[100:103], v[16:31]
    v_mfma_f32_32x32x16_bf16 v[32:47], v[72:75], v[104:107], v[32:47]
    s_add_u32 s20, s20, 4096
    s_add_u32 s21, s21, 4096
    buffer_load_dwordx4 v[100:103], v9, s[12:15], s20 offen offset:0 sc1
    buffer_load_dwordx4 v[104:107], v9, s[12:15], s21 offen offset:0 sc1
    ds_read_b128 v[68:71], v54 offset:32768
    ds_read_b128 v[72:75], v54 offset:33792
    s_waitcnt vmcnt(10) lgkmcnt(2)
    v_mfma_f32_32x32x16_bf16 v[16:31], v[76:79], v[108:111], v[16:31]
    v_mfma_f32_32x32x16_bf16 v[32:47], v[80:83], v[112:115], v[32:47]
    buffer_load_dwordx4 v[108:111], v9, s[12:15], s20 offen offset:1024 sc1
    buffer_load_dwordx4 v[112:115], v9, s[12:15], s21 offen offset:1024 sc1
    ds_read_b128 v[76:79], v54 offset:34816
    ds_read_b128 v[80:83], v54 offset:35840
    s_waitcnt vmcnt(10) lgkmcnt(2)
    v_mfma_f32_32x32x16_bf16 v[16:31], v[68:71], v[116:119], v[16:31]
    v_mfma_f32_32x32x16_bf16 v[32:47], v[72:75], v[120:123], v[32:47]
    buffer_load_dwordx4 v[116:119], v9, s[12:15], s20 offen offset:2048 sc1
    buffer_load_dwordx4 v[120:123], v9, s[12:15], s21 offen offset:2048 sc1
    ds_read_b128 v[68:71], v54 offset:36864
    ds_read_b128 v[72:75], v54 offset:37888
    s_waitcnt vmcnt(10) lgkmcnt(2)
    v_mfma_f32_32x32x16_bf16 v[16:31], v[76:79], v[124:127], v[16:31]
    v_mfma_f32_32x32x16_bf16 v[32:47], v[80:83], v[128:131], v[32:47]
    buffer_load_dwordx4 v[124:127], v9, s[12:15], s20 offen offset:3072 sc1
    buffer_load_dwordx4 v[128:131], v9, s[12:15], s21 offen offset:3072 sc1
    ds_read_b128 v[76:79], v54 offset:38912
    ds_read_b128 v[80:83], v54 offset:39936
    s_waitcnt vmcnt(10) lgkmcnt(2)
    v_mfma_f32_32x32x16_bf16 v[16:31], v[68:71], v[84:87], v[16:31]
    v_mfma_f32_32x32x16_bf16 v[32:47], v[72:75], v[88:91], v[32:47]
    s_add_u32 s20, s20, 4096
    s_add_u32 s21, s21, 4096
    buffer_load_dwordx4 v[84:87], v9, s[12:15], s20 offen offset:0 sc1
    buffer_load_dwordx4 v[88:91], v9, s[12:15], s21 offen offset:0 sc1
    ds_read_b128 v[68:71], v54 offset:40960
    ds_read_b128 v[72:75], v54 offset:41984
    s_waitcnt vmcnt(10) lgkmcnt(2)
    v_mfma_f32_32x32x16_bf16 v[16:31], v[76:79], v[92:95], v[16:31]
    v_mfma_f32_32x32x16_bf16 v[32:47], v[80:83], v[96:99], v[32:47]
    buffer_load_dwordx4 v[92:95], v9, s[12:15], s20 offen offset:1024 sc1
    buffer_load_dwordx4 v[96:99], v9, s[12:15], s21 offen offset:1024 sc1
    ds_read_b128 v[76:79], v54 offset:43008
    ds_read_b128 v[80:83], v54 offset:44032
    s_waitcnt vmcnt(10) lgkmcnt(2)
    v_mfma_f32_32x32x16_bf16 v[16:31], v[68:71], v[100:103], v[16:31]
    v_mfma_f32_32x32x16_bf16 v[32:47], v[72:75], v[104:107], v[32:47]
    buffer_load_dwordx4 v[100:103], v9, s[12:15], s20 offen offset:2048 sc1
    buffer_load_dwordx4 v[104:107], v9, s[12:15], s21 offen offset:2048 sc1
    ds_read_b128 v[68:71], v54 offset:45056
    ds_read_b128 v[72:75], v54 offset:46080
    s_waitcnt vmcnt(10) lgkmcnt(2)
    v_mfma_f32_32x32x16_bf16 v[16:31], v[76:79], v[108:111], v[16:31]
    v_mfma_f32_32x32x16_bf16 v[32:47], v[80:83], v[112:115], v[32:47]
    buffer_load_dwordx4 v[108:111], v9, s[12:15], s20 offen offset:3072 sc1
    buffer_load_dwordx4 v[112:115], v9, s[12:15], s21 offen offset:3072 sc1
    ds_read_b128 v[76:79], v54 offset:47104
    ds_read_b128 v[80:83], v54 offset:48128
    s_waitcnt vmcnt(10) lgkmcnt(2)
    v_mfma_f32_32x32x16_bf16 v[16:31], v[68:71], v[116:119], v[16:31]
    v_mfma_f32_32x32x16_bf16 v[32:47], v[72:75], v[120:123], v[32:47]
    s_add_u32 s20, s20, 4096
    s_add_u32 s21, s21, 4096
    buffer_load_dwordx4 v[116:119], v9, s[12:15], s20 offen offset:0 sc1
    buffer_load_dwordx4 v[120:123], v9, s[12:15], s21 offen offset:0 sc1
    ds_read_b128 v[68:71], v54 offset:49152
    ds_read_b128 v[72:75], v54 offset:50176
    s_waitcnt vmcnt(10) lgkmcnt(2)
    v_mfma_f32_32x32x16_bf16 v[16:31], v[76:79], v[124:127], v[16:31]
    v_mfma_f32_32x32x16_bf16 v[32:47], v[80:83], v[128:131], v[32:47]
    buffer_load_dwordx4 v[124:127], v9, s[12:15], s20 offen offset:1024 sc1
    buffer_load_dwordx4 v[128:131], v9, s[12:15], s21 offen offset:1024 sc1
    ds_read_b128 v[76:79], v54 offset:51200
    ds_read_b128 v[80:83], v54 offset:52224
    s_waitcnt vmcnt(10) lgkmcnt(2)
    v_mfma_f32_32x32x16_bf16 v[16:31], v[68:71], v[84:87], v[16:31]
    v_mfma_f32_32x32x16_bf16 v[32:47], v[72:75], v[88:91], v[32:47]
    buffer_load_dwordx4 v[84:87], v9, s[12:15], s20 offen offset:2048 sc1
    buffer_load_dwordx4 v[88:91], v9, s[12:15], s21 offen offset:2048 sc1
    ds_read_b128 v[68:71], v54 offset:53248
    ds_read_b128 v[72:75], v54 offset:54272
    s_waitcnt vmcnt(10) lgkmcnt(2)
    v_mfma_f32_32x32x16_bf16 v[16:31], v[76:79], v[92:95], v[16:31]
    v_mfma_f32_32x32x16_bf16 v[32:47], v[80:83], v[96:99], v[32:47]
    buffer_load_dwordx4 v[92:95], v9, s[12:15], s20 offen offset:3072 sc1
    buffer_load_dwordx4 v[96:99], v9, s[12:15], s21 offen offset:3072 sc1
    ds_read_b128 v[76:79], v54 offset:55296
    ds_read_b128 v[80:83], v54 offset:56320
    s_waitcnt vmcnt(10) lgkmcnt(2)
    v_mfma_f32_32x32x16_bf16 v[16:31], v[68:71], v[100:103], v[16:31]
    v_mfma_f32_32x32x16_bf16 v[32:47], v[72:75], v[104:107], v[32:47]
    s_add_u32 s20, s20, 4096
    s_add_u32 s21, s21, 4096
    buffer_load_dwordx4 v[100:103], v9, s[12:15], s20 offen offset:0 sc1
    buffer_load_dwordx4 v[104:107], v9, s[12:15], s21 offen offset:0 sc1
    ds_read_b128 v[68:71], v54 offset:57344
    ds_read_b128 v[72:75], v54 offset:58368
    s_waitcnt vmcnt(10) lgkmcnt(2)
    v_mfma_f32_32x32x16_bf16 v[16:31], v[76:79], v[108:111], v[16:31]
    v_mfma_f32_32x32x16_bf16 v[32:47], v[80:83], v[112:115], v[32:47]
    ds_read_b128 v[76:79], v54 offset:59392
    ds_read_b128 v[80:83], v54 offset:60416
    s_waitcnt vmcnt(8) lgkmcnt(2)
    v_mfma_f32_32x32x16_bf16 v[16:31], v[68:71], v[116:119], v[16:31]
    v_mfma_f32_32x32x16_bf16 v[32:47], v[72:75], v[120:123], v[32:47]
    ds_read_b128 v[68:71], v54 offset:61440
    ds_read_b128 v[72:75], v54 offset:62464
    s_waitcnt vmcnt(6) lgkmcnt(2)
    v_mfma_f32_32x32x16_bf16 v[16:31], v[76:79], v[124:127], v[16:31]
    v_mfma_f32_32x32x16_bf16 v[32:47], v[80:83], v[128:131], v[32:47]
    ds_read_b128 v[76:79], v54 offset:63488
    ds_read_b128 v[80:83], v54 offset:64512
    s_waitcnt vmcnt(4) lgkmcnt(2)
    v_mfma_f32_32x32x16_bf16 v[16:31], v[68:71], v[84:87], v[16:31]
    v_mfma_f32_32x32x16_bf16 v[32:47], v[72:75], v[88:91], v[32:47]
    s_waitcnt vmcnt(2) lgkmcnt(0)
    v_mfma_f32_32x32x16_bf16 v[16:31], v[76:79], v[92:95], v[16:31]
    v_mfma_f32_32x32x16_bf16 v[32:47], v[80:83], v[96:99], v[32:47]
    s_waitcnt vmcnt(0) lgkmcnt(0)
    v_mfma_f32_32x32x16_bf16 v[16:31], v[60:63], v[100:103], v[16:31]
    v_mfma_f32_32x32x16_bf16 v[32:47], v[64:67], v[104:107], v[32:47]
    ds_write_b32 v52, v53 offset:1200
    s_mul_i32 s20, s35, 2560
    s_sub_u32 s21, 5223680, s20
    s_add_u32 s20, s20, 1280
    s_nop 7
    s_cmp_eq_u32 s35, 1024
    s_cbranch_scc1 concat_heads__mha_block__spectral_fnet__prompt_kernel_h_last
    v_pk_add_f32 v[68:69], v[16:17], v[32:33] neg_lo:[0,1] neg_hi:[0,1]
    v_pk_add_f32 v[70:71], v[16:17], v[32:33]
    s_add_u32 s16, s20, 0
    s_sub_u32 s17, s21, 0
    v_cvt_pk_bf16_f32 v16, v68, v70
    buffer_store_short v16, v48, s[48:51], s16 offen nt
    buffer_store_short_d16_hi v16, v49, s[48:51], s16 offen nt
    buffer_store_short_d16_hi v16, v50, s[48:51], s17 offen nt
    buffer_store_short v16, v51, s[48:51], s17 offen nt
    s_add_u32 s16, s20, 5120
    s_sub_u32 s17, s21, 5120
    v_cvt_pk_bf16_f32 v17, v69, v71
    buffer_store_short v17, v48, s[48:51], s16 offen nt
    buffer_store_short_d16_hi v17, v49, s[48:51], s16 offen nt
    buffer_store_short_d16_hi v17, v50, s[48:51], s17 offen nt
    buffer_store_short v17, v51, s[48:51], s17 offen nt
    v_pk_add_f32 v[68:69], v[18:19], v[34:35] neg_lo:[0,1] neg_hi:[0,1]
    v_pk_add_f32 v[70:71], v[18:19], v[34:35]
    s_add_u32 s16, s20, 10240
    s_sub_u32 s17, s21, 10240
    v_cvt_pk_bf16_f32 v18, v68, v70
    buffer_store_short v18, v48, s[48:51], s16 offen nt
    buffer_store_short_d16_hi v18, v49, s[48:51], s16 offen nt
    buffer_store_short_d16_hi v18, v50, s[48:51], s17 offen nt
    buffer_store_short v18, v51, s[48:51], s17 offen nt
    s_add_u32 s16, s20, 15360
    s_sub_u32 s17, s21, 15360
    v_cvt_pk_bf16_f32 v19, v69, v71
    buffer_store_short v19, v48, s[48:51], s16 offen nt
    buffer_store_short_d16_hi v19, v49, s[48:51], s16 offen nt
    buffer_store_short_d16_hi v19, v50, s[48:51], s17 offen nt
    buffer_store_short v19, v51, s[48:51], s17 offen nt
    v_pk_add_f32 v[68:69], v[20:21], v[36:37] neg_lo:[0,1] neg_hi:[0,1]
    v_pk_add_f32 v[70:71], v[20:21], v[36:37]
    s_add_u32 s16, s20, 40960
    s_sub_u32 s17, s21, 40960
    v_cvt_pk_bf16_f32 v20, v68, v70
    buffer_store_short v20, v48, s[48:51], s16 offen nt
    buffer_store_short_d16_hi v20, v49, s[48:51], s16 offen nt
    buffer_store_short_d16_hi v20, v50, s[48:51], s17 offen nt
    buffer_store_short v20, v51, s[48:51], s17 offen nt
    s_add_u32 s16, s20, 46080
    s_sub_u32 s17, s21, 46080
    v_cvt_pk_bf16_f32 v21, v69, v71
    buffer_store_short v21, v48, s[48:51], s16 offen nt
    buffer_store_short_d16_hi v21, v49, s[48:51], s16 offen nt
    buffer_store_short_d16_hi v21, v50, s[48:51], s17 offen nt
    buffer_store_short v21, v51, s[48:51], s17 offen nt
    v_pk_add_f32 v[68:69], v[22:23], v[38:39] neg_lo:[0,1] neg_hi:[0,1]
    v_pk_add_f32 v[70:71], v[22:23], v[38:39]
    s_add_u32 s16, s20, 51200
    s_sub_u32 s17, s21, 51200
    v_cvt_pk_bf16_f32 v22, v68, v70
    buffer_store_short v22, v48, s[48:51], s16 offen nt
    buffer_store_short_d16_hi v22, v49, s[48:51], s16 offen nt
    buffer_store_short_d16_hi v22, v50, s[48:51], s17 offen nt
    buffer_store_short v22, v51, s[48:51], s17 offen nt
    s_add_u32 s16, s20, 56320
    s_sub_u32 s17, s21, 56320
    v_cvt_pk_bf16_f32 v23, v69, v71
    buffer_store_short v23, v48, s[48:51], s16 offen nt
    buffer_store_short_d16_hi v23, v49, s[48:51], s16 offen nt
    buffer_store_short_d16_hi v23, v50, s[48:51], s17 offen nt
    buffer_store_short v23, v51, s[48:51], s17 offen nt
    v_pk_add_f32 v[68:69], v[24:25], v[40:41] neg_lo:[0,1] neg_hi:[0,1]
    v_pk_add_f32 v[70:71], v[24:25], v[40:41]
    s_add_u32 s16, s20, 81920
    s_sub_u32 s17, s21, 81920
    v_cvt_pk_bf16_f32 v24, v68, v70
    buffer_store_short v24, v48, s[48:51], s16 offen nt
    buffer_store_short_d16_hi v24, v49, s[48:51], s16 offen nt
    buffer_store_short_d16_hi v24, v50, s[48:51], s17 offen nt
    buffer_store_short v24, v51, s[48:51], s17 offen nt
    s_add_u32 s16, s20, 87040
    s_sub_u32 s17, s21, 87040
    v_cvt_pk_bf16_f32 v25, v69, v71
    buffer_store_short v25, v48, s[48:51], s16 offen nt
    buffer_store_short_d16_hi v25, v49, s[48:51], s16 offen nt
    buffer_store_short_d16_hi v25, v50, s[48:51], s17 offen nt
    buffer_store_short v25, v51, s[48:51], s17 offen nt
    v_pk_add_f32 v[68:69], v[26:27], v[42:43] neg_lo:[0,1] neg_hi:[0,1]
    v_pk_add_f32 v[70:71], v[26:27], v[42:43]
    s_add_u32 s16, s20, 92160
    s_sub_u32 s17, s21, 92160
    v_cvt_pk_bf16_f32 v26, v68, v70
    buffer_store_short v26, v48, s[48:51], s16 offen nt
    buffer_store_short_d16_hi v26, v49, s[48:51], s16 offen nt
    buffer_store_short_d16_hi v26, v50, s[48:51], s17 offen nt
    buffer_store_short v26, v51, s[48:51], s17 offen nt
    s_add_u32 s16, s20, 97280
    s_sub_u32 s17, s21, 97280
    v_cvt_pk_bf16_f32 v27, v69, v71
    buffer_store_short v27, v48, s[48:51], s16 offen nt
    buffer_store_short_d16_hi v27, v49, s[48:51], s16 offen nt
    buffer_store_short_d16_hi v27, v50, s[48:51], s17 offen nt
    buffer_store_short v27, v51, s[48:51], s17 offen nt
    v_pk_add_f32 v[68:69], v[28:29], v[44:45] neg_lo:[0,1] neg_hi:[0,1]
    v_pk_add_f32 v[70:71], v[28:29], v[44:45]
    s_add_u32 s16, s20, 122880
    s_sub_u32 s17, s21, 122880
    v_cvt_pk_bf16_f32 v28, v68, v70
    buffer_store_short v28, v48, s[48:51], s16 offen nt
    buffer_store_short_d16_hi v28, v49, s[48:51], s16 offen nt
    buffer_store_short_d16_hi v28, v50, s[48:51], s17 offen nt
    buffer_store_short v28, v51, s[48:51], s17 offen nt
    s_add_u32 s16, s20, 128000
    s_sub_u32 s17, s21, 128000
    v_cvt_pk_bf16_f32 v29, v69, v71
    buffer_store_short v29, v48, s[48:51], s16 offen nt
    buffer_store_short_d16_hi v29, v49, s[48:51], s16 offen nt
    buffer_store_short_d16_hi v29, v50, s[48:51], s17 offen nt
    buffer_store_short v29, v51, s[48:51], s17 offen nt
    v_pk_add_f32 v[68:69], v[30:31], v[46:47] neg_lo:[0,1] neg_hi:[0,1]
    v_pk_add_f32 v[70:71], v[30:31], v[46:47]
    s_add_u32 s16, s20, 133120
    s_sub_u32 s17, s21, 133120
    v_cvt_pk_bf16_f32 v30, v68, v70
    buffer_store_short v30, v48, s[48:51], s16 offen nt
    buffer_store_short_d16_hi v30, v49, s[48:51], s16 offen nt
    buffer_store_short_d16_hi v30, v50, s[48:51], s17 offen nt
    buffer_store_short v30, v51, s[48:51], s17 offen nt
    s_add_u32 s16, s20, 138240
    s_sub_u32 s17, s21, 138240
    v_cvt_pk_bf16_f32 v31, v69, v71
    buffer_store_short v31, v48, s[48:51], s16 offen nt
    buffer_store_short_d16_hi v31, v49, s[48:51], s16 offen nt
    buffer_store_short_d16_hi v31, v50, s[48:51], s17 offen nt
    buffer_store_short v31, v51, s[48:51], s17 offen nt
    s_branch concat_heads__mha_block__spectral_fnet__prompt_kernel_h_wb
concat_heads__mha_block__spectral_fnet__prompt_kernel_h_last:
    v_sub_f32 v1, v16, v32
    v_add_f32 v2, v16, v32
    s_mov_b32 exec_hi, 0
    v_cvt_pk_bf16_f32 v16, v1, v2
    buffer_store_short v16, v48, s[48:51], s20 offen
    buffer_store_short_d16_hi v16, v49, s[48:51], s20 offen
    s_mov_b32 exec_hi, -1
    s_branch concat_heads__mha_block__spectral_fnet__prompt_kernel_h_wb
concat_heads__mha_block__spectral_fnet__prompt_kernel_h_wo:
    ds_write_b32 v52, v53 offset:1200
    s_branch concat_heads__mha_block__spectral_fnet__prompt_kernel_h_end
concat_heads__mha_block__spectral_fnet__prompt_kernel_h_wb:
concat_heads__mha_block__spectral_fnet__prompt_kernel_h_end:
    s_endpgm
concat_heads__mha_block__spectral_fnet__prompt_kernel_exit:
    s_endpgm
.section .rodata,"a"
.p2align 6
.amdhsa_kernel concat_heads__mha_block__spectral_fnet__prompt_kernel
  .amdhsa_next_free_vgpr 256
  .amdhsa_next_free_sgpr 102
  .amdhsa_accum_offset 256
  .amdhsa_group_segment_fixed_size 0
  .amdhsa_kernarg_size 88
  .amdhsa_user_sgpr_count 2
  .amdhsa_user_sgpr_kernarg_segment_ptr 1
  .amdhsa_system_sgpr_workgroup_id_x 1
.end_amdhsa_kernel
```
